```python
import torch

def _softmax(x, axis=-1):
    return torch.softmax(x, dim=axis)
def _gelu(x):
    return torch.nn.functional.gelu(x, approximate="tanh")
def _silu(x):
    return torch.nn.functional.silu(x)
def _sigmoid(x):
    return torch.sigmoid(x)
def _layernorm(x, axis=-1, eps=1e-5):
    m = x.mean(dim=axis, keepdim=True)
    v = x.var(dim=axis, keepdim=True, unbiased=False)
    return (x - m) / torch.sqrt(v + eps)
def _scatter_add(tgt, idx, src, axis=0):
    return tgt.clone().index_add_(axis, idx, src)
def _segment_sum(src, seg, n):
    out = torch.zeros((n,) + src.shape[1:], dtype=src.dtype)
    return out.index_add_(0, seg, src)
def _pad(x, pw):
    flat = tuple(v for pair in reversed(pw) for v in pair)
    return torch.nn.functional.pad(x, flat)

kernel_name = 'gated_mix__mha_block__swiglu_ffn__prompt'

def setup_inputs():

    _w = (lambda a: (lambda t: t.to(torch.bfloat16) if t.is_floating_point() else t)(torch.as_tensor(a)))
    def _A_setup():
        B, S, D, H = 1, 2048, 640, 32
        return {
            "x": _w((lambda *s: torch.randn(*s, dtype=torch.bfloat16) * 0.05)(B, S, D)),
            "wqkv": _w((lambda *s: torch.randn(*s, dtype=torch.bfloat16) * 0.8)(D, 3 * D)),
            "wo": _w((lambda *s: torch.randn(*s, dtype=torch.bfloat16) * 0.05)(D, D)),
        }
    _A_in = _A_setup()

    def _B_setup():
        B, S, D, F = 1, 2048, 640, 1728
        return {
            "x": _w((lambda *s: torch.randn(*s, dtype=torch.bfloat16) * 0.05)(B, S, D)),
            "w_gate": _w((lambda *s: torch.randn(*s, dtype=torch.bfloat16) * 0.1)(D, F)),
            "w_up": _w((lambda *s: torch.randn(*s, dtype=torch.bfloat16) * 0.1)(D, F)),
            "w_down": _w((lambda *s: torch.randn(*s, dtype=torch.bfloat16) * 0.1)(F, D)),
        }
    _B_in = _B_setup()

    return {
        "A_x": _A_in["x"],
        "A_wqkv": _A_in["wqkv"],
        "A_wo": _A_in["wo"],
        "B_x": _B_in["x"],
        "B_w_gate": _B_in["w_gate"],
        "B_w_up": _B_in["w_up"],
        "B_w_down": _B_in["w_down"],
        "gate_w": _w((lambda *s: torch.randn(*s, dtype=torch.bfloat16) * 0.05)(640) * 16.0),
    }

def reference(A_x, A_wqkv, A_wo, B_x, B_w_gate, B_w_up, B_w_down, gate_w):
    def _A_ref(x, wqkv, wo):
        B, S, D = x.shape
        H = 32
        Dh = D // H
        qkv = (lambda x, *d: x.permute(*d))((x @ wqkv).reshape(B, S, 3, H, Dh), 2, 0, 3, 1, 4)
        q, k, v = qkv[0], qkv[1], qkv[2]
        scores = torch.einsum("bhqd,bhkd->bhqk", q, k) * (Dh ** -0.5)
        p = _softmax(scores, axis=-1)
        o = torch.einsum("bhqk,bhkd->bhqd", p, v)
        return (lambda x, *d: x.permute(*d))(o, 0, 2, 1, 3).reshape(B, S, D) @ wo

    def _B_ref(x, w_gate, w_up, w_down):
        g = _silu(x @ w_gate)
        u = x @ w_up
        return (g * u) @ w_down

    x = A_x
    g = _sigmoid((x * gate_w).sum(-1, keepdims=True))
    a = _A_ref(x, A_wqkv, A_wo)
    b = _B_ref(x, B_w_gate, B_w_up, B_w_down)
    return g * a + (1 - g) * b
```

```asm
; @launch grid=(256,1,1) block=(512,1,1) lds=163840
.amdgcn_target "amdgcn-amd-amdhsa--gfx950"
.text
.globl gated_mix__mha_block__swiglu_ffn__prompt_kernel
.p2align 8
.type gated_mix__mha_block__swiglu_ffn__prompt_kernel,@function
gated_mix__mha_block__swiglu_ffn__prompt_kernel:
    s_cmp_ge_u32 s2, 256
    s_cbranch_scc1 gated_mix__mha_block__swiglu_ffn__prompt_kernel_end
    s_load_dwordx4 s[4:7], s[0:1], 0
    s_load_dwordx2 s[8:9], s[0:1], 16
    s_load_dwordx4 s[12:15], s[0:1], 40
    s_load_dwordx2 s[10:11], s[0:1], 32
    s_load_dwordx4 s[16:19], s[0:1], 56
    s_load_dwordx4 s[20:23], s[0:1], 72
    v_lshrrev_b32 v2, 6, v0
    v_and_b32 v1, 63, v0
    s_nop 0
    v_readfirstlane_b32 s3, v2
    s_and_b32 s60, s2, 7
    s_lshr_b32 s61, s2, 3
    s_and_b32 s44, s60, 1
    s_lshl_b32 s44, s44, 2
    s_and_b32 s62, s61, 3
    s_add_u32 s44, s44, s62
    s_lshr_b32 s60, s60, 1
    s_lshr_b32 s61, s61, 2
    s_cmp_ge_u32 s61, 3
    s_cbranch_scc1 p1_notqkv
    s_mul_i32 s45, s60, 3
    s_add_u32 s45, s45, s61
    s_cmp_lt_u32 s3, 4
    s_cbranch_scc1 p1_qc
    s_sub_u32 s51, s3, 4
    v_lshrrev_b32 v16, 3, v1
    v_and_b32 v17, 7, v1
    s_lshl_b32 s60, s44, 8
    s_lshl_b32 s61, s51, 6
    s_add_u32 s60, s60, s61
    v_add_u32 v18, s60, v16
    v_mul_u32_u24 v18, 1280, v18
    v_lshrrev_b32 v19, 4, v1
    v_xor_b32 v20, v19, v17
    v_lshl_add_u32 v4, v20, 4, v18
    v_xor_b32 v20, 4, v20
    v_lshl_add_u32 v5, v20, 4, v18
    v_add_u32 v5, 9216, v5
    v_add_u32 v6, 18432, v4
    v_add_u32 v7, 18432, v5
    v_add_u32 v8, 40960, v4
    v_add_u32 v9, 40960, v5
    v_add_u32 v10, 40960, v6
    v_add_u32 v11, 40960, v7
    s_lshl_b32 s52, s51, 13
    s_mov_b32 s47, 0
    s_mov_b32 s57, 0
    s_lshl_b32 s49, s57, 7
    s_mul_i32 s62, s45, 320
    s_add_u32 s60, s51, 0
    s_lshl_b32 s61, s60, 6
    v_add_u32 v16, s61, v1
    v_mul_u32_u24 v17, 3277, v16
    v_lshrrev_b32 v17, 16, v17
    v_mul_u32_u24 v18, 20, v17
    v_sub_u32 v18, v16, v18
    v_mul_u32_u24 v17, 3840, v17
    v_lshlrev_b32 v18, 4, v18
    v_add3_u32 v12, v17, v18, s62
    s_lshl_b32 s53, s60, 10
    s_add_u32 s53, s53, 98304
    s_add_u32 s60, s51, 4
    s_lshl_b32 s61, s60, 6
    v_add_u32 v16, s61, v1
    v_mul_u32_u24 v17, 3277, v16
    v_lshrrev_b32 v17, 16, v17
    v_mul_u32_u24 v18, 20, v17
    v_sub_u32 v18, v16, v18
    v_mul_u32_u24 v17, 3840, v17
    v_lshlrev_b32 v18, 4, v18
    v_add3_u32 v13, v17, v18, s62
    s_lshl_b32 s54, s60, 10
    s_add_u32 s54, s54, 98304
    s_add_u32 s60, s51, 8
    s_lshl_b32 s61, s60, 6
    v_add_u32 v16, s61, v1
    v_mul_u32_u24 v17, 3277, v16
    v_lshrrev_b32 v17, 16, v17
    v_mul_u32_u24 v18, 20, v17
    v_sub_u32 v18, v16, v18
    v_mul_u32_u24 v17, 3840, v17
    v_lshlrev_b32 v18, 4, v18
    v_add3_u32 v14, v17, v18, s62
    s_lshl_b32 s55, s60, 10
    s_add_u32 s55, s55, 98304
    s_mov_b32 s48, 0
    s_mul_i32 s50, s57, 245760
    s_waitcnt lgkmcnt(0)
    s_mov_b32 s28, s4
    s_mov_b32 s29, s5
    s_mov_b32 s30, 2621440
    s_mov_b32 s31, 0x20000
    s_mov_b32 s32, s6
    s_mov_b32 s33, s7
    s_mov_b32 s34, 2457600
    s_mov_b32 s35, 0x20000
    s_add_u32 m0, s47, s52
    s_nop 0
    buffer_load_dwordx4 v4, s[28:31], s49 offen offset:0  lds
    buffer_load_dwordx4 v5, s[28:31], s49 offen offset:1024  lds
    buffer_load_dwordx4 v6, s[28:31], s49 offen offset:2048  lds
    buffer_load_dwordx4 v7, s[28:31], s49 offen offset:3072  lds
    s_add_u32 m0, m0, 4096
    s_add_u32 s47, s47, 32768
    buffer_load_dwordx4 v8, s[28:31], s49 offen offset:0  lds
    buffer_load_dwordx4 v9, s[28:31], s49 offen offset:1024  lds
    buffer_load_dwordx4 v10, s[28:31], s49 offen offset:2048  lds
    buffer_load_dwordx4 v11, s[28:31], s49 offen offset:3072  lds
    s_add_u32 s49, s49, 128
    s_cmp_ge_u32 s47, 98304
    s_cselect_b32 s47, 0, s47
    s_cmp_ge_u32 s49, 1280
    s_cselect_b32 s49, 0, s49
    s_add_u32 m0, s48, s53
    s_nop 0
    buffer_load_dwordx4 v12, s[32:35], s50 offen  lds
    s_add_u32 m0, s48, s54
    s_nop 0
    buffer_load_dwordx4 v13, s[32:35], s50 offen  lds
    s_cmp_ge_u32 s51, 2
    s_cbranch_scc1 w3_1
    s_add_u32 m0, s48, s55
    s_nop 0
    buffer_load_dwordx4 v14, s[32:35], s50 offen  lds
w3_1:
    s_add_u32 s50, s50, 122880
    s_add_u32 s48, s48, 12352
    s_cmp_ge_u32 s48, 61760
    s_cselect_b32 s48, 0, s48
    s_cmp_ge_u32 s50, 2457600
    s_cselect_b32 s50, 0, s50
    s_add_u32 m0, s48, s53
    s_nop 0
    buffer_load_dwordx4 v12, s[32:35], s50 offen  lds
    s_add_u32 m0, s48, s54
    s_nop 0
    buffer_load_dwordx4 v13, s[32:35], s50 offen  lds
    s_cmp_ge_u32 s51, 2
    s_cbranch_scc1 w3_2
    s_add_u32 m0, s48, s55
    s_nop 0
    buffer_load_dwordx4 v14, s[32:35], s50 offen  lds
w3_2:
    s_add_u32 s50, s50, 122880
    s_add_u32 s48, s48, 12352
    s_cmp_ge_u32 s48, 61760
    s_cselect_b32 s48, 0, s48
    s_cmp_ge_u32 s50, 2457600
    s_cselect_b32 s50, 0, s50
    s_add_u32 m0, s47, s52
    s_nop 0
    buffer_load_dwordx4 v4, s[28:31], s49 offen offset:0  lds
    buffer_load_dwordx4 v5, s[28:31], s49 offen offset:1024  lds
    buffer_load_dwordx4 v6, s[28:31], s49 offen offset:2048  lds
    buffer_load_dwordx4 v7, s[28:31], s49 offen offset:3072  lds
    s_add_u32 m0, m0, 4096
    s_add_u32 s47, s47, 32768
    buffer_load_dwordx4 v8, s[28:31], s49 offen offset:0  lds
    buffer_load_dwordx4 v9, s[28:31], s49 offen offset:1024  lds
    buffer_load_dwordx4 v10, s[28:31], s49 offen offset:2048  lds
    buffer_load_dwordx4 v11, s[28:31], s49 offen offset:3072  lds
    s_add_u32 s49, s49, 128
    s_cmp_ge_u32 s47, 98304
    s_cselect_b32 s47, 0, s47
    s_cmp_ge_u32 s49, 1280
    s_cselect_b32 s49, 0, s49
    s_waitcnt vmcnt(10)
    s_barrier
    s_add_u32 m0, s48, s53
    s_nop 0
    buffer_load_dwordx4 v12, s[32:35], s50 offen  lds
    s_add_u32 m0, s48, s54
    s_nop 0
    buffer_load_dwordx4 v13, s[32:35], s50 offen  lds
    s_cmp_ge_u32 s51, 2
    s_cbranch_scc1 w3_3
    s_add_u32 m0, s48, s55
    s_nop 0
    buffer_load_dwordx4 v14, s[32:35], s50 offen  lds
w3_3:
    s_add_u32 s50, s50, 122880
    s_add_u32 s48, s48, 12352
    s_cmp_ge_u32 s48, 61760
    s_cselect_b32 s48, 0, s48
    s_cmp_ge_u32 s50, 2457600
    s_cselect_b32 s50, 0, s50
    s_add_u32 m0, s48, s53
    s_nop 0
    buffer_load_dwordx4 v12, s[32:35], s50 offen  lds
    s_add_u32 m0, s48, s54
    s_nop 0
    buffer_load_dwordx4 v13, s[32:35], s50 offen  lds
    s_cmp_ge_u32 s51, 2
    s_cbranch_scc1 w3_4
    s_add_u32 m0, s48, s55
    s_nop 0
    buffer_load_dwordx4 v14, s[32:35], s50 offen  lds
w3_4:
    s_add_u32 s50, s50, 122880
    s_add_u32 s48, s48, 12352
    s_cmp_ge_u32 s48, 61760
    s_cselect_b32 s48, 0, s48
    s_cmp_ge_u32 s50, 2457600
    s_cselect_b32 s50, 0, s50
    s_waitcnt vmcnt(12)
    s_barrier
    s_add_u32 m0, s47, s52
    s_nop 0
    buffer_load_dwordx4 v4, s[28:31], s49 offen offset:0  lds
    buffer_load_dwordx4 v5, s[28:31], s49 offen offset:1024  lds
    buffer_load_dwordx4 v6, s[28:31], s49 offen offset:2048  lds
    buffer_load_dwordx4 v7, s[28:31], s49 offen offset:3072  lds
    s_add_u32 m0, m0, 4096
    s_add_u32 s47, s47, 32768
    buffer_load_dwordx4 v8, s[28:31], s49 offen offset:0  lds
    buffer_load_dwordx4 v9, s[28:31], s49 offen offset:1024  lds
    buffer_load_dwordx4 v10, s[28:31], s49 offen offset:2048  lds
    buffer_load_dwordx4 v11, s[28:31], s49 offen offset:3072  lds
    s_add_u32 s49, s49, 128
    s_cmp_ge_u32 s47, 98304
    s_cselect_b32 s47, 0, s47
    s_cmp_ge_u32 s49, 1280
    s_cselect_b32 s49, 0, s49
    s_add_u32 m0, s48, s53
    s_nop 0
    buffer_load_dwordx4 v12, s[32:35], s50 offen  lds
    s_add_u32 m0, s48, s54
    s_nop 0
    buffer_load_dwordx4 v13, s[32:35], s50 offen  lds
    s_cmp_ge_u32 s51, 2
    s_cbranch_scc1 w3_5
    s_add_u32 m0, s48, s55
    s_nop 0
    buffer_load_dwordx4 v14, s[32:35], s50 offen  lds
w3_5:
    s_add_u32 s50, s50, 122880
    s_add_u32 s48, s48, 12352
    s_cmp_ge_u32 s48, 61760
    s_cselect_b32 s48, 0, s48
    s_cmp_ge_u32 s50, 2457600
    s_cselect_b32 s50, 0, s50
    s_waitcnt vmcnt(12)
    s_barrier
    s_add_u32 m0, s48, s53
    s_nop 0
    buffer_load_dwordx4 v12, s[32:35], s50 offen  lds
    s_add_u32 m0, s48, s54
    s_nop 0
    buffer_load_dwordx4 v13, s[32:35], s50 offen  lds
    s_cmp_ge_u32 s51, 2
    s_cbranch_scc1 w3_6
    s_add_u32 m0, s48, s55
    s_nop 0
    buffer_load_dwordx4 v14, s[32:35], s50 offen  lds
w3_6:
    s_add_u32 s50, s50, 122880
    s_add_u32 s48, s48, 12352
    s_cmp_ge_u32 s48, 61760
    s_cselect_b32 s48, 0, s48
    s_cmp_ge_u32 s50, 2457600
    s_cselect_b32 s50, 0, s50
    s_waitcnt vmcnt(12)
    s_barrier
    s_add_u32 m0, s47, s52
    s_nop 0
    buffer_load_dwordx4 v4, s[28:31], s49 offen offset:0  lds
    buffer_load_dwordx4 v5, s[28:31], s49 offen offset:1024  lds
    buffer_load_dwordx4 v6, s[28:31], s49 offen offset:2048  lds
    buffer_load_dwordx4 v7, s[28:31], s49 offen offset:3072  lds
    s_add_u32 m0, m0, 4096
    s_add_u32 s47, s47, 32768
    buffer_load_dwordx4 v8, s[28:31], s49 offen offset:0  lds
    buffer_load_dwordx4 v9, s[28:31], s49 offen offset:1024  lds
    buffer_load_dwordx4 v10, s[28:31], s49 offen offset:2048  lds
    buffer_load_dwordx4 v11, s[28:31], s49 offen offset:3072  lds
    s_add_u32 s49, s49, 128
    s_cmp_ge_u32 s47, 98304
    s_cselect_b32 s47, 0, s47
    s_cmp_ge_u32 s49, 1280
    s_cselect_b32 s49, 0, s49
    s_add_u32 m0, s48, s53
    s_nop 0
    buffer_load_dwordx4 v12, s[32:35], s50 offen  lds
    s_add_u32 m0, s48, s54
    s_nop 0
    buffer_load_dwordx4 v13, s[32:35], s50 offen  lds
    s_cmp_ge_u32 s51, 2
    s_cbranch_scc1 w3_7
    s_add_u32 m0, s48, s55
    s_nop 0
    buffer_load_dwordx4 v14, s[32:35], s50 offen  lds
w3_7:
    s_add_u32 s50, s50, 122880
    s_add_u32 s48, s48, 12352
    s_cmp_ge_u32 s48, 61760
    s_cselect_b32 s48, 0, s48
    s_cmp_ge_u32 s50, 2457600
    s_cselect_b32 s50, 0, s50
    s_waitcnt vmcnt(12)
    s_barrier
    s_add_u32 m0, s48, s53
    s_nop 0
    buffer_load_dwordx4 v12, s[32:35], s50 offen  lds
    s_add_u32 m0, s48, s54
    s_nop 0
    buffer_load_dwordx4 v13, s[32:35], s50 offen  lds
    s_cmp_ge_u32 s51, 2
    s_cbranch_scc1 w3_8
    s_add_u32 m0, s48, s55
    s_nop 0
    buffer_load_dwordx4 v14, s[32:35], s50 offen  lds
w3_8:
    s_add_u32 s50, s50, 122880
    s_add_u32 s48, s48, 12352
    s_cmp_ge_u32 s48, 61760
    s_cselect_b32 s48, 0, s48
    s_cmp_ge_u32 s50, 2457600
    s_cselect_b32 s50, 0, s50
    s_waitcnt vmcnt(12)
    s_barrier
    s_add_u32 m0, s47, s52
    s_nop 0
    buffer_load_dwordx4 v4, s[28:31], s49 offen offset:0  lds
    buffer_load_dwordx4 v5, s[28:31], s49 offen offset:1024  lds
    buffer_load_dwordx4 v6, s[28:31], s49 offen offset:2048  lds
    buffer_load_dwordx4 v7, s[28:31], s49 offen offset:3072  lds
    s_add_u32 m0, m0, 4096
    s_add_u32 s47, s47, 32768
    buffer_load_dwordx4 v8, s[28:31], s49 offen offset:0  lds
    buffer_load_dwordx4 v9, s[28:31], s49 offen offset:1024  lds
    buffer_load_dwordx4 v10, s[28:31], s49 offen offset:2048  lds
    buffer_load_dwordx4 v11, s[28:31], s49 offen offset:3072  lds
    s_add_u32 s49, s49, 128
    s_cmp_ge_u32 s47, 98304
    s_cselect_b32 s47, 0, s47
    s_cmp_ge_u32 s49, 1280
    s_cselect_b32 s49, 0, s49
    s_add_u32 m0, s48, s53
    s_nop 0
    buffer_load_dwordx4 v12, s[32:35], s50 offen  lds
    s_add_u32 m0, s48, s54
    s_nop 0
    buffer_load_dwordx4 v13, s[32:35], s50 offen  lds
    s_cmp_ge_u32 s51, 2
    s_cbranch_scc1 w3_9
    s_add_u32 m0, s48, s55
    s_nop 0
    buffer_load_dwordx4 v14, s[32:35], s50 offen  lds
w3_9:
    s_add_u32 s50, s50, 122880
    s_add_u32 s48, s48, 12352
    s_cmp_ge_u32 s48, 61760
    s_cselect_b32 s48, 0, s48
    s_cmp_ge_u32 s50, 2457600
    s_cselect_b32 s50, 0, s50
    s_waitcnt vmcnt(12)
    s_barrier
    s_add_u32 m0, s48, s53
    s_nop 0
    buffer_load_dwordx4 v12, s[32:35], s50 offen  lds
    s_add_u32 m0, s48, s54
    s_nop 0
    buffer_load_dwordx4 v13, s[32:35], s50 offen  lds
    s_cmp_ge_u32 s51, 2
    s_cbranch_scc1 w3_10
    s_add_u32 m0, s48, s55
    s_nop 0
    buffer_load_dwordx4 v14, s[32:35], s50 offen  lds
w3_10:
    s_add_u32 s50, s50, 122880
    s_add_u32 s48, s48, 12352
    s_cmp_ge_u32 s48, 61760
    s_cselect_b32 s48, 0, s48
    s_cmp_ge_u32 s50, 2457600
    s_cselect_b32 s50, 0, s50
    s_waitcnt vmcnt(12)
    s_barrier
    s_add_u32 m0, s47, s52
    s_nop 0
    buffer_load_dwordx4 v4, s[28:31], s49 offen offset:0  lds
    buffer_load_dwordx4 v5, s[28:31], s49 offen offset:1024  lds
    buffer_load_dwordx4 v6, s[28:31], s49 offen offset:2048  lds
    buffer_load_dwordx4 v7, s[28:31], s49 offen offset:3072  lds
    s_add_u32 m0, m0, 4096
    s_add_u32 s47, s47, 32768
    buffer_load_dwordx4 v8, s[28:31], s49 offen offset:0  lds
    buffer_load_dwordx4 v9, s[28:31], s49 offen offset:1024  lds
    buffer_load_dwordx4 v10, s[28:31], s49 offen offset:2048  lds
    buffer_load_dwordx4 v11, s[28:31], s49 offen offset:3072  lds
    s_add_u32 s49, s49, 128
    s_cmp_ge_u32 s47, 98304
    s_cselect_b32 s47, 0, s47
    s_cmp_ge_u32 s49, 1280
    s_cselect_b32 s49, 0, s49
    s_add_u32 m0, s48, s53
    s_nop 0
    buffer_load_dwordx4 v12, s[32:35], s50 offen  lds
    s_add_u32 m0, s48, s54
    s_nop 0
    buffer_load_dwordx4 v13, s[32:35], s50 offen  lds
    s_cmp_ge_u32 s51, 2
    s_cbranch_scc1 w3_11
    s_add_u32 m0, s48, s55
    s_nop 0
    buffer_load_dwordx4 v14, s[32:35], s50 offen  lds
w3_11:
    s_add_u32 s50, s50, 122880
    s_add_u32 s48, s48, 12352
    s_cmp_ge_u32 s48, 61760
    s_cselect_b32 s48, 0, s48
    s_cmp_ge_u32 s50, 2457600
    s_cselect_b32 s50, 0, s50
    s_waitcnt vmcnt(12)
    s_barrier
    s_add_u32 m0, s48, s53
    s_nop 0
    buffer_load_dwordx4 v12, s[32:35], s50 offen  lds
    s_add_u32 m0, s48, s54
    s_nop 0
    buffer_load_dwordx4 v13, s[32:35], s50 offen  lds
    s_cmp_ge_u32 s51, 2
    s_cbranch_scc1 w3_12
    s_add_u32 m0, s48, s55
    s_nop 0
    buffer_load_dwordx4 v14, s[32:35], s50 offen  lds
w3_12:
    s_add_u32 s50, s50, 122880
    s_add_u32 s48, s48, 12352
    s_cmp_ge_u32 s48, 61760
    s_cselect_b32 s48, 0, s48
    s_cmp_ge_u32 s50, 2457600
    s_cselect_b32 s50, 0, s50
    s_waitcnt vmcnt(12)
    s_barrier
    s_add_u32 m0, s47, s52
    s_nop 0
    buffer_load_dwordx4 v4, s[28:31], s49 offen offset:0  lds
    buffer_load_dwordx4 v5, s[28:31], s49 offen offset:1024  lds
    buffer_load_dwordx4 v6, s[28:31], s49 offen offset:2048  lds
    buffer_load_dwordx4 v7, s[28:31], s49 offen offset:3072  lds
    s_add_u32 m0, m0, 4096
    s_add_u32 s47, s47, 32768
    buffer_load_dwordx4 v8, s[28:31], s49 offen offset:0  lds
    buffer_load_dwordx4 v9, s[28:31], s49 offen offset:1024  lds
    buffer_load_dwordx4 v10, s[28:31], s49 offen offset:2048  lds
    buffer_load_dwordx4 v11, s[28:31], s49 offen offset:3072  lds
    s_add_u32 s49, s49, 128
    s_cmp_ge_u32 s47, 98304
    s_cselect_b32 s47, 0, s47
    s_cmp_ge_u32 s49, 1280
    s_cselect_b32 s49, 0, s49
    s_add_u32 m0, s48, s53
    s_nop 0
    buffer_load_dwordx4 v12, s[32:35], s50 offen  lds
    s_add_u32 m0, s48, s54
    s_nop 0
    buffer_load_dwordx4 v13, s[32:35], s50 offen  lds
    s_cmp_ge_u32 s51, 2
    s_cbranch_scc1 w3_13
    s_add_u32 m0, s48, s55
    s_nop 0
    buffer_load_dwordx4 v14, s[32:35], s50 offen  lds
w3_13:
    s_add_u32 s50, s50, 122880
    s_add_u32 s48, s48, 12352
    s_cmp_ge_u32 s48, 61760
    s_cselect_b32 s48, 0, s48
    s_cmp_ge_u32 s50, 2457600
    s_cselect_b32 s50, 0, s50
    s_waitcnt vmcnt(12)
    s_barrier
    s_add_u32 m0, s48, s53
    s_nop 0
    buffer_load_dwordx4 v12, s[32:35], s50 offen  lds
    s_add_u32 m0, s48, s54
    s_nop 0
    buffer_load_dwordx4 v13, s[32:35], s50 offen  lds
    s_cmp_ge_u32 s51, 2
    s_cbranch_scc1 w3_14
    s_add_u32 m0, s48, s55
    s_nop 0
    buffer_load_dwordx4 v14, s[32:35], s50 offen  lds
w3_14:
    s_add_u32 s50, s50, 122880
    s_add_u32 s48, s48, 12352
    s_cmp_ge_u32 s48, 61760
    s_cselect_b32 s48, 0, s48
    s_cmp_ge_u32 s50, 2457600
    s_cselect_b32 s50, 0, s50
    s_waitcnt vmcnt(12)
    s_barrier
    s_add_u32 m0, s47, s52
    s_nop 0
    buffer_load_dwordx4 v4, s[28:31], s49 offen offset:0  lds
    buffer_load_dwordx4 v5, s[28:31], s49 offen offset:1024  lds
    buffer_load_dwordx4 v6, s[28:31], s49 offen offset:2048  lds
    buffer_load_dwordx4 v7, s[28:31], s49 offen offset:3072  lds
    s_add_u32 m0, m0, 4096
    s_add_u32 s47, s47, 32768
    buffer_load_dwordx4 v8, s[28:31], s49 offen offset:0  lds
    buffer_load_dwordx4 v9, s[28:31], s49 offen offset:1024  lds
    buffer_load_dwordx4 v10, s[28:31], s49 offen offset:2048  lds
    buffer_load_dwordx4 v11, s[28:31], s49 offen offset:3072  lds
    s_add_u32 s49, s49, 128
    s_cmp_ge_u32 s47, 98304
    s_cselect_b32 s47, 0, s47
    s_cmp_ge_u32 s49, 1280
    s_cselect_b32 s49, 0, s49
    s_add_u32 m0, s48, s53
    s_nop 0
    buffer_load_dwordx4 v12, s[32:35], s50 offen  lds
    s_add_u32 m0, s48, s54
    s_nop 0
    buffer_load_dwordx4 v13, s[32:35], s50 offen  lds
    s_cmp_ge_u32 s51, 2
    s_cbranch_scc1 w3_15
    s_add_u32 m0, s48, s55
    s_nop 0
    buffer_load_dwordx4 v14, s[32:35], s50 offen  lds
w3_15:
    s_add_u32 s50, s50, 122880
    s_add_u32 s48, s48, 12352
    s_cmp_ge_u32 s48, 61760
    s_cselect_b32 s48, 0, s48
    s_cmp_ge_u32 s50, 2457600
    s_cselect_b32 s50, 0, s50
    s_waitcnt vmcnt(12)
    s_barrier
    s_add_u32 m0, s48, s53
    s_nop 0
    buffer_load_dwordx4 v12, s[32:35], s50 offen  lds
    s_add_u32 m0, s48, s54
    s_nop 0
    buffer_load_dwordx4 v13, s[32:35], s50 offen  lds
    s_cmp_ge_u32 s51, 2
    s_cbranch_scc1 w3_16
    s_add_u32 m0, s48, s55
    s_nop 0
    buffer_load_dwordx4 v14, s[32:35], s50 offen  lds
w3_16:
    s_add_u32 s50, s50, 122880
    s_add_u32 s48, s48, 12352
    s_cmp_ge_u32 s48, 61760
    s_cselect_b32 s48, 0, s48
    s_cmp_ge_u32 s50, 2457600
    s_cselect_b32 s50, 0, s50
    s_waitcnt vmcnt(12)
    s_barrier
    s_add_u32 m0, s47, s52
    s_nop 0
    buffer_load_dwordx4 v4, s[28:31], s49 offen offset:0  lds
    buffer_load_dwordx4 v5, s[28:31], s49 offen offset:1024  lds
    buffer_load_dwordx4 v6, s[28:31], s49 offen offset:2048  lds
    buffer_load_dwordx4 v7, s[28:31], s49 offen offset:3072  lds
    s_add_u32 m0, m0, 4096
    s_add_u32 s47, s47, 32768
    buffer_load_dwordx4 v8, s[28:31], s49 offen offset:0  lds
    buffer_load_dwordx4 v9, s[28:31], s49 offen offset:1024  lds
    buffer_load_dwordx4 v10, s[28:31], s49 offen offset:2048  lds
    buffer_load_dwordx4 v11, s[28:31], s49 offen offset:3072  lds
    s_add_u32 s49, s49, 128
    s_cmp_ge_u32 s47, 98304
    s_cselect_b32 s47, 0, s47
    s_cmp_ge_u32 s49, 1280
    s_cselect_b32 s49, 0, s49
    s_add_u32 m0, s48, s53
    s_nop 0
    buffer_load_dwordx4 v12, s[32:35], s50 offen  lds
    s_add_u32 m0, s48, s54
    s_nop 0
    buffer_load_dwordx4 v13, s[32:35], s50 offen  lds
    s_cmp_ge_u32 s51, 2
    s_cbranch_scc1 w3_17
    s_add_u32 m0, s48, s55
    s_nop 0
    buffer_load_dwordx4 v14, s[32:35], s50 offen  lds
w3_17:
    s_add_u32 s50, s50, 122880
    s_add_u32 s48, s48, 12352
    s_cmp_ge_u32 s48, 61760
    s_cselect_b32 s48, 0, s48
    s_cmp_ge_u32 s50, 2457600
    s_cselect_b32 s50, 0, s50
    s_waitcnt vmcnt(12)
    s_barrier
    s_add_u32 m0, s48, s53
    s_nop 0
    buffer_load_dwordx4 v12, s[32:35], s50 offen  lds
    s_add_u32 m0, s48, s54
    s_nop 0
    buffer_load_dwordx4 v13, s[32:35], s50 offen  lds
    s_cmp_ge_u32 s51, 2
    s_cbranch_scc1 w3_18
    s_add_u32 m0, s48, s55
    s_nop 0
    buffer_load_dwordx4 v14, s[32:35], s50 offen  lds
w3_18:
    s_add_u32 s50, s50, 122880
    s_add_u32 s48, s48, 12352
    s_cmp_ge_u32 s48, 61760
    s_cselect_b32 s48, 0, s48
    s_cmp_ge_u32 s50, 2457600
    s_cselect_b32 s50, 0, s50
    s_waitcnt vmcnt(12)
    s_barrier
    s_add_u32 m0, s47, s52
    s_nop 0
    buffer_load_dwordx4 v4, s[28:31], s49 offen offset:0  lds
    buffer_load_dwordx4 v5, s[28:31], s49 offen offset:1024  lds
    buffer_load_dwordx4 v6, s[28:31], s49 offen offset:2048  lds
    buffer_load_dwordx4 v7, s[28:31], s49 offen offset:3072  lds
    s_add_u32 m0, m0, 4096
    s_add_u32 s47, s47, 32768
    buffer_load_dwordx4 v8, s[28:31], s49 offen offset:0  lds
    buffer_load_dwordx4 v9, s[28:31], s49 offen offset:1024  lds
    buffer_load_dwordx4 v10, s[28:31], s49 offen offset:2048  lds
    buffer_load_dwordx4 v11, s[28:31], s49 offen offset:3072  lds
    s_add_u32 s49, s49, 128
    s_cmp_ge_u32 s47, 98304
    s_cselect_b32 s47, 0, s47
    s_cmp_ge_u32 s49, 1280
    s_cselect_b32 s49, 0, s49
    s_add_u32 m0, s48, s53
    s_nop 0
    buffer_load_dwordx4 v12, s[32:35], s50 offen  lds
    s_add_u32 m0, s48, s54
    s_nop 0
    buffer_load_dwordx4 v13, s[32:35], s50 offen  lds
    s_cmp_ge_u32 s51, 2
    s_cbranch_scc1 w3_19
    s_add_u32 m0, s48, s55
    s_nop 0
    buffer_load_dwordx4 v14, s[32:35], s50 offen  lds
w3_19:
    s_add_u32 s50, s50, 122880
    s_add_u32 s48, s48, 12352
    s_cmp_ge_u32 s48, 61760
    s_cselect_b32 s48, 0, s48
    s_cmp_ge_u32 s50, 2457600
    s_cselect_b32 s50, 0, s50
    s_waitcnt vmcnt(12)
    s_barrier
    s_add_u32 m0, s48, s53
    s_nop 0
    buffer_load_dwordx4 v12, s[32:35], s50 offen  lds
    s_add_u32 m0, s48, s54
    s_nop 0
    buffer_load_dwordx4 v13, s[32:35], s50 offen  lds
    s_cmp_ge_u32 s51, 2
    s_cbranch_scc1 w3_20
    s_add_u32 m0, s48, s55
    s_nop 0
    buffer_load_dwordx4 v14, s[32:35], s50 offen  lds
w3_20:
    s_add_u32 s50, s50, 122880
    s_add_u32 s48, s48, 12352
    s_cmp_ge_u32 s48, 61760
    s_cselect_b32 s48, 0, s48
    s_cmp_ge_u32 s50, 2457600
    s_cselect_b32 s50, 0, s50
    s_waitcnt vmcnt(12)
    s_barrier
    s_waitcnt vmcnt(2)
    s_barrier
    s_waitcnt vmcnt(0)
    s_barrier
    s_barrier
    s_setprio 3
    s_barrier
    s_mov_b32 s54, -1
    s_mov_b32 s47, 0
    s_branch after_p1
p1_qc:
    v_and_b32 v2, 31, v1
    v_lshrrev_b32 v3, 5, v1
    s_lshl_b32 s60, s3, 6
    v_add_u32 v10, s60, v2
    v_lshrrev_b32 v11, 1, v10
    v_and_b32 v11, 7, v11
    v_xor_b32 v11, v11, v3
    v_lshlrev_b32 v11, 4, v11
    v_lshlrev_b32 v10, 7, v10
    v_add_u32 v4, v10, v11
    v_xor_b32 v5, 32, v4
    v_xor_b32 v6, 64, v4
    v_xor_b32 v7, 96, v4
    v_lshrrev_b32 v10, 4, v1
    v_and_b32 v11, 15, v1
    v_lshrrev_b32 v12, 2, v11
    v_and_b32 v13, 3, v11
    v_and_b32 v14, 1, v10
    v_lshrrev_b32 v10, 1, v10
    v_lshlrev_b32 v10, 3, v10
    v_add_u32 v10, v10, v12
    s_waitcnt lgkmcnt(0)
    s_lshr_b32 s46, s45, 2
    v_mul_u32_u24 v10, 320, v10
    v_add_u32 v10, 98304, v10
    v_lshlrev_b32 v14, 2, v14
    v_add_u32 v13, v13, v14
    s_cmp_eq_u32 s46, 2
    s_cbranch_scc1 p1_v
    v_lshrrev_b32 v11, 2, v13
    v_mul_u32_u24 v11, 160, v11
    v_and_b32 v12, 1, v13
    v_lshlrev_b32 v12, 4, v12
    v_bfe_u32 v14, v13, 1, 1
    v_lshlrev_b32 v14, 3, v14
    v_add3_u32 v11, v11, v12, v14
    v_add_u32 v8, v11, v10
    v_mul_u32_u24 v11, 40, v13
    v_add_u32 v9, v11, v10
    s_mov_b32 s62, 12352
    s_mov_b32 s63, 32768
    s_mov_b32 s50, 0
    s_mov_b32 s51, 0
    v_mov_b32 v64, 0
    v_mov_b32 v65, 0
    v_mov_b32 v66, 0
    v_mov_b32 v67, 0
    v_mov_b32 v68, 0
    v_mov_b32 v69, 0
    v_mov_b32 v70, 0
    v_mov_b32 v71, 0
    v_mov_b32 v72, 0
    v_mov_b32 v73, 0
    v_mov_b32 v74, 0
    v_mov_b32 v75, 0
    v_mov_b32 v76, 0
    v_mov_b32 v77, 0
    v_mov_b32 v78, 0
    v_mov_b32 v79, 0
    v_mov_b32 v80, 0
    v_mov_b32 v81, 0
    v_mov_b32 v82, 0
    v_mov_b32 v83, 0
    v_mov_b32 v84, 0
    v_mov_b32 v85, 0
    v_mov_b32 v86, 0
    v_mov_b32 v87, 0
    v_mov_b32 v88, 0
    v_mov_b32 v89, 0
    v_mov_b32 v90, 0
    v_mov_b32 v91, 0
    v_mov_b32 v92, 0
    v_mov_b32 v93, 0
    v_mov_b32 v94, 0
    v_mov_b32 v95, 0
    v_mov_b32 v96, 0
    v_mov_b32 v97, 0
    v_mov_b32 v98, 0
    v_mov_b32 v99, 0
    v_mov_b32 v100, 0
    v_mov_b32 v101, 0
    v_mov_b32 v102, 0
    v_mov_b32 v103, 0
    v_mov_b32 v104, 0
    v_mov_b32 v105, 0
    v_mov_b32 v106, 0
    v_mov_b32 v107, 0
    v_mov_b32 v108, 0
    v_mov_b32 v109, 0
    v_mov_b32 v110, 0
    v_mov_b32 v111, 0
    v_mov_b32 v112, 0
    v_mov_b32 v113, 0
    v_mov_b32 v114, 0
    v_mov_b32 v115, 0
    v_mov_b32 v116, 0
    v_mov_b32 v117, 0
    v_mov_b32 v118, 0
    v_mov_b32 v119, 0
    v_mov_b32 v120, 0
    v_mov_b32 v121, 0
    v_mov_b32 v122, 0
    v_mov_b32 v123, 0
    v_mov_b32 v124, 0
    v_mov_b32 v125, 0
    v_mov_b32 v126, 0
    v_mov_b32 v127, 0
    v_mov_b32 v128, 0
    v_mov_b32 v129, 0
    v_mov_b32 v130, 0
    v_mov_b32 v131, 0
    v_mov_b32 v132, 0
    v_mov_b32 v133, 0
    v_mov_b32 v134, 0
    v_mov_b32 v135, 0
    v_mov_b32 v136, 0
    v_mov_b32 v137, 0
    v_mov_b32 v138, 0
    v_mov_b32 v139, 0
    v_mov_b32 v140, 0
    v_mov_b32 v141, 0
    v_mov_b32 v142, 0
    v_mov_b32 v143, 0
    v_mov_b32 v144, 0
    v_mov_b32 v145, 0
    v_mov_b32 v146, 0
    v_mov_b32 v147, 0
    v_mov_b32 v148, 0
    v_mov_b32 v149, 0
    v_mov_b32 v150, 0
    v_mov_b32 v151, 0
    v_mov_b32 v152, 0
    v_mov_b32 v153, 0
    v_mov_b32 v154, 0
    v_mov_b32 v155, 0
    v_mov_b32 v156, 0
    v_mov_b32 v157, 0
    v_mov_b32 v158, 0
    v_mov_b32 v159, 0
    v_mov_b32 v160, 0
    v_mov_b32 v161, 0
    v_mov_b32 v162, 0
    v_mov_b32 v163, 0
    v_mov_b32 v164, 0
    v_mov_b32 v165, 0
    v_mov_b32 v166, 0
    v_mov_b32 v167, 0
    v_mov_b32 v168, 0
    v_mov_b32 v169, 0
    v_mov_b32 v170, 0
    v_mov_b32 v171, 0
    v_mov_b32 v172, 0
    v_mov_b32 v173, 0
    v_mov_b32 v174, 0
    v_mov_b32 v175, 0
    v_mov_b32 v176, 0
    v_mov_b32 v177, 0
    v_mov_b32 v178, 0
    v_mov_b32 v179, 0
    v_mov_b32 v180, 0
    v_mov_b32 v181, 0
    v_mov_b32 v182, 0
    v_mov_b32 v183, 0
    v_mov_b32 v184, 0
    v_mov_b32 v185, 0
    v_mov_b32 v186, 0
    v_mov_b32 v187, 0
    v_mov_b32 v188, 0
    v_mov_b32 v189, 0
    v_mov_b32 v190, 0
    v_mov_b32 v191, 0
    v_mov_b32 v192, 0
    v_mov_b32 v193, 0
    v_mov_b32 v194, 0
    v_mov_b32 v195, 0
    v_mov_b32 v196, 0
    v_mov_b32 v197, 0
    v_mov_b32 v198, 0
    v_mov_b32 v199, 0
    v_mov_b32 v200, 0
    v_mov_b32 v201, 0
    v_mov_b32 v202, 0
    v_mov_b32 v203, 0
    v_mov_b32 v204, 0
    v_mov_b32 v205, 0
    v_mov_b32 v206, 0
    v_mov_b32 v207, 0
    v_mov_b32 v208, 0
    v_mov_b32 v209, 0
    v_mov_b32 v210, 0
    v_mov_b32 v211, 0
    v_mov_b32 v212, 0
    v_mov_b32 v213, 0
    v_mov_b32 v214, 0
    v_mov_b32 v215, 0
    v_mov_b32 v216, 0
    v_mov_b32 v217, 0
    v_mov_b32 v218, 0
    v_mov_b32 v219, 0
    v_mov_b32 v220, 0
    v_mov_b32 v221, 0
    v_mov_b32 v222, 0
    v_mov_b32 v223, 0
    s_barrier
    ds_read_b128 v[24:27], v4 offset:0
    ds_read_b128 v[28:31], v4 offset:4096
    ds_read_b64_tr_b16 v[40:41], v8 offset:0
    ds_read_b64_tr_b16 v[42:43], v8 offset:1280
    ds_read_b64_tr_b16 v[44:45], v8 offset:40
    ds_read_b64_tr_b16 v[46:47], v8 offset:1320
    ds_read_b64_tr_b16 v[48:49], v8 offset:80
    ds_read_b64_tr_b16 v[50:51], v8 offset:1360
    ds_read_b64_tr_b16 v[52:53], v8 offset:120
    ds_read_b64_tr_b16 v[54:55], v8 offset:1400
    ds_read_b64_tr_b16 v[56:57], v9 offset:32
    ds_read_b64_tr_b16 v[58:59], v9 offset:1312
    s_waitcnt lgkmcnt(8)
    v_mfma_f32_32x32x16_bf16 v[64:79], v[40:43], v[24:27], v[64:79]
    v_mfma_f32_32x32x16_bf16 v[80:95], v[40:43], v[28:31], v[80:95]
    ds_read_b64_tr_b16 v[40:41], v8 offset:5120
    s_waitcnt lgkmcnt(7)
    v_mfma_f32_32x32x16_bf16 v[96:111], v[44:47], v[24:27], v[96:111]
    ds_read_b64_tr_b16 v[42:43], v8 offset:6400
    v_mfma_f32_32x32x16_bf16 v[112:127], v[44:47], v[28:31], v[112:127]
    ds_read_b64_tr_b16 v[44:45], v8 offset:5160
    s_waitcnt lgkmcnt(7)
    v_mfma_f32_32x32x16_bf16 v[128:143], v[48:51], v[24:27], v[128:143]
    ds_read_b64_tr_b16 v[46:47], v8 offset:6440
    ds_read_b128 v[32:35], v5 offset:0
    v_mfma_f32_32x32x16_bf16 v[144:159], v[48:51], v[28:31], v[144:159]
    ds_read_b64_tr_b16 v[48:49], v8 offset:5200
    ds_read_b128 v[36:39], v5 offset:4096
    s_waitcnt lgkmcnt(9)
    v_mfma_f32_32x32x16_bf16 v[160:175], v[52:55], v[24:27], v[160:175]
    ds_read_b64_tr_b16 v[50:51], v8 offset:6480
    v_mfma_f32_32x32x16_bf16 v[176:191], v[52:55], v[28:31], v[176:191]
    ds_read_b64_tr_b16 v[52:53], v8 offset:5240
    s_waitcnt lgkmcnt(9)
    v_mfma_f32_32x32x16_bf16 v[192:207], v[56:59], v[24:27], v[192:207]
    ds_read_b64_tr_b16 v[54:55], v8 offset:6520
    v_mfma_f32_32x32x16_bf16 v[208:223], v[56:59], v[28:31], v[208:223]
    ds_read_b64_tr_b16 v[56:57], v9 offset:5152
    s_waitcnt lgkmcnt(4)
    v_mfma_f32_32x32x16_bf16 v[64:79], v[40:43], v[32:35], v[64:79]
    ds_read_b64_tr_b16 v[58:59], v9 offset:6432
    v_mfma_f32_32x32x16_bf16 v[80:95], v[40:43], v[36:39], v[80:95]
    s_barrier
    s_add_u32 s50, s50, 12352
    s_cmp_ge_u32 s50, 61760
    s_cselect_b32 s47, 4294917888, s62
    s_cselect_b32 s50, 0, s50
    v_add_u32 v8, s47, v8
    v_add_u32 v9, s47, v9
    ds_read_b64_tr_b16 v[40:41], v8 offset:0
    s_waitcnt lgkmcnt(6)
    v_mfma_f32_32x32x16_bf16 v[96:111], v[44:47], v[32:35], v[96:111]
    ds_read_b64_tr_b16 v[42:43], v8 offset:1280
    v_mfma_f32_32x32x16_bf16 v[112:127], v[44:47], v[36:39], v[112:127]
    ds_read_b64_tr_b16 v[44:45], v8 offset:40
    s_waitcnt lgkmcnt(7)
    v_mfma_f32_32x32x16_bf16 v[128:143], v[48:51], v[32:35], v[128:143]
    ds_read_b64_tr_b16 v[46:47], v8 offset:1320
    ds_read_b128 v[24:27], v6 offset:0
    v_mfma_f32_32x32x16_bf16 v[144:159], v[48:51], v[36:39], v[144:159]
    ds_read_b64_tr_b16 v[48:49], v8 offset:80
    ds_read_b128 v[28:31], v6 offset:4096
    s_waitcnt lgkmcnt(9)
    v_mfma_f32_32x32x16_bf16 v[160:175], v[52:55], v[32:35], v[160:175]
    ds_read_b64_tr_b16 v[50:51], v8 offset:1360
    v_mfma_f32_32x32x16_bf16 v[176:191], v[52:55], v[36:39], v[176:191]
    ds_read_b64_tr_b16 v[52:53], v8 offset:120
    s_waitcnt lgkmcnt(9)
    v_mfma_f32_32x32x16_bf16 v[192:207], v[56:59], v[32:35], v[192:207]
    ds_read_b64_tr_b16 v[54:55], v8 offset:1400
    v_mfma_f32_32x32x16_bf16 v[208:223], v[56:59], v[36:39], v[208:223]
    ds_read_b64_tr_b16 v[56:57], v9 offset:32
    s_waitcnt lgkmcnt(4)
    v_mfma_f32_32x32x16_bf16 v[64:79], v[40:43], v[24:27], v[64:79]
    ds_read_b64_tr_b16 v[58:59], v9 offset:1312
    v_mfma_f32_32x32x16_bf16 v[80:95], v[40:43], v[28:31], v[80:95]
    ds_read_b64_tr_b16 v[40:41], v8 offset:5120
    s_waitcnt lgkmcnt(6)
    v_mfma_f32_32x32x16_bf16 v[96:111], v[44:47], v[24:27], v[96:111]
    ds_read_b64_tr_b16 v[42:43], v8 offset:6400
    v_mfma_f32_32x32x16_bf16 v[112:127], v[44:47], v[28:31], v[112:127]
    ds_read_b64_tr_b16 v[44:45], v8 offset:5160
    s_waitcnt lgkmcnt(7)
    v_mfma_f32_32x32x16_bf16 v[128:143], v[48:51], v[24:27], v[128:143]
    ds_read_b64_tr_b16 v[46:47], v8 offset:6440
    ds_read_b128 v[32:35], v7 offset:0
    v_mfma_f32_32x32x16_bf16 v[144:159], v[48:51], v[28:31], v[144:159]
    ds_read_b64_tr_b16 v[48:49], v8 offset:5200
    ds_read_b128 v[36:39], v7 offset:4096
    s_waitcnt lgkmcnt(9)
    v_mfma_f32_32x32x16_bf16 v[160:175], v[52:55], v[24:27], v[160:175]
    ds_read_b64_tr_b16 v[50:51], v8 offset:6480
    v_mfma_f32_32x32x16_bf16 v[176:191], v[52:55], v[28:31], v[176:191]
    ds_read_b64_tr_b16 v[52:53], v8 offset:5240
    s_waitcnt lgkmcnt(9)
    v_mfma_f32_32x32x16_bf16 v[192:207], v[56:59], v[24:27], v[192:207]
    ds_read_b64_tr_b16 v[54:55], v8 offset:6520
    v_mfma_f32_32x32x16_bf16 v[208:223], v[56:59], v[28:31], v[208:223]
    ds_read_b64_tr_b16 v[56:57], v9 offset:5152
    s_waitcnt lgkmcnt(4)
    v_mfma_f32_32x32x16_bf16 v[64:79], v[40:43], v[32:35], v[64:79]
    ds_read_b64_tr_b16 v[58:59], v9 offset:6432
    v_mfma_f32_32x32x16_bf16 v[80:95], v[40:43], v[36:39], v[80:95]
    s_barrier
    s_add_u32 s50, s50, 12352
    s_cmp_ge_u32 s50, 61760
    s_cselect_b32 s47, 4294917888, s62
    s_cselect_b32 s50, 0, s50
    v_add_u32 v8, s47, v8
    v_add_u32 v9, s47, v9
    s_add_u32 s51, s51, 32768
    s_cmp_ge_u32 s51, 98304
    s_cselect_b32 s48, 4294901760, s63
    s_cselect_b32 s51, 0, s51
    v_add_u32 v4, s48, v4
    v_add_u32 v5, s48, v5
    v_add_u32 v6, s48, v6
    v_add_u32 v7, s48, v7
    ds_read_b64_tr_b16 v[40:41], v8 offset:0
    s_waitcnt lgkmcnt(6)
    v_mfma_f32_32x32x16_bf16 v[96:111], v[44:47], v[32:35], v[96:111]
    ds_read_b64_tr_b16 v[42:43], v8 offset:1280
    v_mfma_f32_32x32x16_bf16 v[112:127], v[44:47], v[36:39], v[112:127]
    ds_read_b64_tr_b16 v[44:45], v8 offset:40
    s_waitcnt lgkmcnt(7)
    v_mfma_f32_32x32x16_bf16 v[128:143], v[48:51], v[32:35], v[128:143]
    ds_read_b64_tr_b16 v[46:47], v8 offset:1320
    ds_read_b128 v[24:27], v4 offset:0
    v_mfma_f32_32x32x16_bf16 v[144:159], v[48:51], v[36:39], v[144:159]
    ds_read_b64_tr_b16 v[48:49], v8 offset:80
    ds_read_b128 v[28:31], v4 offset:4096
    s_waitcnt lgkmcnt(9)
    v_mfma_f32_32x32x16_bf16 v[160:175], v[52:55], v[32:35], v[160:175]
    ds_read_b64_tr_b16 v[50:51], v8 offset:1360
    v_mfma_f32_32x32x16_bf16 v[176:191], v[52:55], v[36:39], v[176:191]
    ds_read_b64_tr_b16 v[52:53], v8 offset:120
    s_waitcnt lgkmcnt(9)
    v_mfma_f32_32x32x16_bf16 v[192:207], v[56:59], v[32:35], v[192:207]
    ds_read_b64_tr_b16 v[54:55], v8 offset:1400
    v_mfma_f32_32x32x16_bf16 v[208:223], v[56:59], v[36:39], v[208:223]
    ds_read_b64_tr_b16 v[56:57], v9 offset:32
    s_mov_b32 s49, 8
p1c_21:
    s_waitcnt lgkmcnt(4)
    v_mfma_f32_32x32x16_bf16 v[64:79], v[40:43], v[24:27], v[64:79]
    ds_read_b64_tr_b16 v[58:59], v9 offset:1312
    v_mfma_f32_32x32x16_bf16 v[80:95], v[40:43], v[28:31], v[80:95]
    ds_read_b64_tr_b16 v[40:41], v8 offset:5120
    s_waitcnt lgkmcnt(6)
    v_mfma_f32_32x32x16_bf16 v[96:111], v[44:47], v[24:27], v[96:111]
    ds_read_b64_tr_b16 v[42:43], v8 offset:6400
    v_mfma_f32_32x32x16_bf16 v[112:127], v[44:47], v[28:31], v[112:127]
    ds_read_b64_tr_b16 v[44:45], v8 offset:5160
    s_waitcnt lgkmcnt(7)
    v_mfma_f32_32x32x16_bf16 v[128:143], v[48:51], v[24:27], v[128:143]
    ds_read_b64_tr_b16 v[46:47], v8 offset:6440
    ds_read_b128 v[32:35], v5 offset:0
    v_mfma_f32_32x32x16_bf16 v[144:159], v[48:51], v[28:31], v[144:159]
    ds_read_b64_tr_b16 v[48:49], v8 offset:5200
    ds_read_b128 v[36:39], v5 offset:4096
    s_waitcnt lgkmcnt(9)
    v_mfma_f32_32x32x16_bf16 v[160:175], v[52:55], v[24:27], v[160:175]
    ds_read_b64_tr_b16 v[50:51], v8 offset:6480
    v_mfma_f32_32x32x16_bf16 v[176:191], v[52:55], v[28:31], v[176:191]
    ds_read_b64_tr_b16 v[52:53], v8 offset:5240
    s_waitcnt lgkmcnt(9)
    v_mfma_f32_32x32x16_bf16 v[192:207], v[56:59], v[24:27], v[192:207]
    ds_read_b64_tr_b16 v[54:55], v8 offset:6520
    v_mfma_f32_32x32x16_bf16 v[208:223], v[56:59], v[28:31], v[208:223]
    ds_read_b64_tr_b16 v[56:57], v9 offset:5152
    s_waitcnt lgkmcnt(4)
    v_mfma_f32_32x32x16_bf16 v[64:79], v[40:43], v[32:35], v[64:79]
    ds_read_b64_tr_b16 v[58:59], v9 offset:6432
    v_mfma_f32_32x32x16_bf16 v[80:95], v[40:43], v[36:39], v[80:95]
    s_barrier
    s_add_u32 s50, s50, 12352
    s_cmp_ge_u32 s50, 61760
    s_cselect_b32 s47, 4294917888, s62
    s_cselect_b32 s50, 0, s50
    v_add_u32 v8, s47, v8
    v_add_u32 v9, s47, v9
    ds_read_b64_tr_b16 v[40:41], v8 offset:0
    s_waitcnt lgkmcnt(6)
    v_mfma_f32_32x32x16_bf16 v[96:111], v[44:47], v[32:35], v[96:111]
    ds_read_b64_tr_b16 v[42:43], v8 offset:1280
    v_mfma_f32_32x32x16_bf16 v[112:127], v[44:47], v[36:39], v[112:127]
    ds_read_b64_tr_b16 v[44:45], v8 offset:40
    s_waitcnt lgkmcnt(7)
    v_mfma_f32_32x32x16_bf16 v[128:143], v[48:51], v[32:35], v[128:143]
    ds_read_b64_tr_b16 v[46:47], v8 offset:1320
    ds_read_b128 v[24:27], v6 offset:0
    v_mfma_f32_32x32x16_bf16 v[144:159], v[48:51], v[36:39], v[144:159]
    ds_read_b64_tr_b16 v[48:49], v8 offset:80
    ds_read_b128 v[28:31], v6 offset:4096
    s_waitcnt lgkmcnt(9)
    v_mfma_f32_32x32x16_bf16 v[160:175], v[52:55], v[32:35], v[160:175]
    ds_read_b64_tr_b16 v[50:51], v8 offset:1360
    v_mfma_f32_32x32x16_bf16 v[176:191], v[52:55], v[36:39], v[176:191]
    ds_read_b64_tr_b16 v[52:53], v8 offset:120
    s_waitcnt lgkmcnt(9)
    v_mfma_f32_32x32x16_bf16 v[192:207], v[56:59], v[32:35], v[192:207]
    ds_read_b64_tr_b16 v[54:55], v8 offset:1400
    v_mfma_f32_32x32x16_bf16 v[208:223], v[56:59], v[36:39], v[208:223]
    ds_read_b64_tr_b16 v[56:57], v9 offset:32
    s_waitcnt lgkmcnt(4)
    v_mfma_f32_32x32x16_bf16 v[64:79], v[40:43], v[24:27], v[64:79]
    ds_read_b64_tr_b16 v[58:59], v9 offset:1312
    v_mfma_f32_32x32x16_bf16 v[80:95], v[40:43], v[28:31], v[80:95]
    ds_read_b64_tr_b16 v[40:41], v8 offset:5120
    s_waitcnt lgkmcnt(6)
    v_mfma_f32_32x32x16_bf16 v[96:111], v[44:47], v[24:27], v[96:111]
    ds_read_b64_tr_b16 v[42:43], v8 offset:6400
    v_mfma_f32_32x32x16_bf16 v[112:127], v[44:47], v[28:31], v[112:127]
    ds_read_b64_tr_b16 v[44:45], v8 offset:5160
    s_waitcnt lgkmcnt(7)
    v_mfma_f32_32x32x16_bf16 v[128:143], v[48:51], v[24:27], v[128:143]
    ds_read_b64_tr_b16 v[46:47], v8 offset:6440
    ds_read_b128 v[32:35], v7 offset:0
    v_mfma_f32_32x32x16_bf16 v[144:159], v[48:51], v[28:31], v[144:159]
    ds_read_b64_tr_b16 v[48:49], v8 offset:5200
    ds_read_b128 v[36:39], v7 offset:4096
    s_waitcnt lgkmcnt(9)
    v_mfma_f32_32x32x16_bf16 v[160:175], v[52:55], v[24:27], v[160:175]
    ds_read_b64_tr_b16 v[50:51], v8 offset:6480
    v_mfma_f32_32x32x16_bf16 v[176:191], v[52:55], v[28:31], v[176:191]
    ds_read_b64_tr_b16 v[52:53], v8 offset:5240
    s_waitcnt lgkmcnt(9)
    v_mfma_f32_32x32x16_bf16 v[192:207], v[56:59], v[24:27], v[192:207]
    ds_read_b64_tr_b16 v[54:55], v8 offset:6520
    v_mfma_f32_32x32x16_bf16 v[208:223], v[56:59], v[28:31], v[208:223]
    ds_read_b64_tr_b16 v[56:57], v9 offset:5152
    s_waitcnt lgkmcnt(4)
    v_mfma_f32_32x32x16_bf16 v[64:79], v[40:43], v[32:35], v[64:79]
    ds_read_b64_tr_b16 v[58:59], v9 offset:6432
    v_mfma_f32_32x32x16_bf16 v[80:95], v[40:43], v[36:39], v[80:95]
    s_barrier
    s_add_u32 s50, s50, 12352
    s_cmp_ge_u32 s50, 61760
    s_cselect_b32 s47, 4294917888, s62
    s_cselect_b32 s50, 0, s50
    v_add_u32 v8, s47, v8
    v_add_u32 v9, s47, v9
    s_add_u32 s51, s51, 32768
    s_cmp_ge_u32 s51, 98304
    s_cselect_b32 s48, 4294901760, s63
    s_cselect_b32 s51, 0, s51
    v_add_u32 v4, s48, v4
    v_add_u32 v5, s48, v5
    v_add_u32 v6, s48, v6
    v_add_u32 v7, s48, v7
    ds_read_b64_tr_b16 v[40:41], v8 offset:0
    s_waitcnt lgkmcnt(6)
    v_mfma_f32_32x32x16_bf16 v[96:111], v[44:47], v[32:35], v[96:111]
    ds_read_b64_tr_b16 v[42:43], v8 offset:1280
    v_mfma_f32_32x32x16_bf16 v[112:127], v[44:47], v[36:39], v[112:127]
    ds_read_b64_tr_b16 v[44:45], v8 offset:40
    s_waitcnt lgkmcnt(7)
    v_mfma_f32_32x32x16_bf16 v[128:143], v[48:51], v[32:35], v[128:143]
    ds_read_b64_tr_b16 v[46:47], v8 offset:1320
    ds_read_b128 v[24:27], v4 offset:0
    v_mfma_f32_32x32x16_bf16 v[144:159], v[48:51], v[36:39], v[144:159]
    ds_read_b64_tr_b16 v[48:49], v8 offset:80
    ds_read_b128 v[28:31], v4 offset:4096
    s_waitcnt lgkmcnt(9)
    v_mfma_f32_32x32x16_bf16 v[160:175], v[52:55], v[32:35], v[160:175]
    ds_read_b64_tr_b16 v[50:51], v8 offset:1360
    v_mfma_f32_32x32x16_bf16 v[176:191], v[52:55], v[36:39], v[176:191]
    ds_read_b64_tr_b16 v[52:53], v8 offset:120
    s_waitcnt lgkmcnt(9)
    v_mfma_f32_32x32x16_bf16 v[192:207], v[56:59], v[32:35], v[192:207]
    ds_read_b64_tr_b16 v[54:55], v8 offset:1400
    v_mfma_f32_32x32x16_bf16 v[208:223], v[56:59], v[36:39], v[208:223]
    ds_read_b64_tr_b16 v[56:57], v9 offset:32
    s_sub_u32 s49, s49, 1
    s_cmp_lg_u32 s49, 0
    s_cbranch_scc1 p1c_21
    s_waitcnt lgkmcnt(4)
    v_mfma_f32_32x32x16_bf16 v[64:79], v[40:43], v[24:27], v[64:79]
    ds_read_b64_tr_b16 v[58:59], v9 offset:1312
    v_mfma_f32_32x32x16_bf16 v[80:95], v[40:43], v[28:31], v[80:95]
    ds_read_b64_tr_b16 v[40:41], v8 offset:5120
    s_waitcnt lgkmcnt(6)
    v_mfma_f32_32x32x16_bf16 v[96:111], v[44:47], v[24:27], v[96:111]
    ds_read_b64_tr_b16 v[42:43], v8 offset:6400
    v_mfma_f32_32x32x16_bf16 v[112:127], v[44:47], v[28:31], v[112:127]
    ds_read_b64_tr_b16 v[44:45], v8 offset:5160
    s_waitcnt lgkmcnt(7)
    v_mfma_f32_32x32x16_bf16 v[128:143], v[48:51], v[24:27], v[128:143]
    ds_read_b64_tr_b16 v[46:47], v8 offset:6440
    ds_read_b128 v[32:35], v5 offset:0
    v_mfma_f32_32x32x16_bf16 v[144:159], v[48:51], v[28:31], v[144:159]
    ds_read_b64_tr_b16 v[48:49], v8 offset:5200
    ds_read_b128 v[36:39], v5 offset:4096
    s_waitcnt lgkmcnt(9)
    v_mfma_f32_32x32x16_bf16 v[160:175], v[52:55], v[24:27], v[160:175]
    ds_read_b64_tr_b16 v[50:51], v8 offset:6480
    v_mfma_f32_32x32x16_bf16 v[176:191], v[52:55], v[28:31], v[176:191]
    ds_read_b64_tr_b16 v[52:53], v8 offset:5240
    s_waitcnt lgkmcnt(9)
    v_mfma_f32_32x32x16_bf16 v[192:207], v[56:59], v[24:27], v[192:207]
    ds_read_b64_tr_b16 v[54:55], v8 offset:6520
    v_mfma_f32_32x32x16_bf16 v[208:223], v[56:59], v[28:31], v[208:223]
    ds_read_b64_tr_b16 v[56:57], v9 offset:5152
    s_waitcnt lgkmcnt(4)
    v_mfma_f32_32x32x16_bf16 v[64:79], v[40:43], v[32:35], v[64:79]
    ds_read_b64_tr_b16 v[58:59], v9 offset:6432
    v_mfma_f32_32x32x16_bf16 v[80:95], v[40:43], v[36:39], v[80:95]
    s_barrier
    s_add_u32 s50, s50, 12352
    s_cmp_ge_u32 s50, 61760
    s_cselect_b32 s47, 4294917888, s62
    s_cselect_b32 s50, 0, s50
    v_add_u32 v8, s47, v8
    v_add_u32 v9, s47, v9
    ds_read_b64_tr_b16 v[40:41], v8 offset:0
    s_waitcnt lgkmcnt(6)
    v_mfma_f32_32x32x16_bf16 v[96:111], v[44:47], v[32:35], v[96:111]
    ds_read_b64_tr_b16 v[42:43], v8 offset:1280
    v_mfma_f32_32x32x16_bf16 v[112:127], v[44:47], v[36:39], v[112:127]
    ds_read_b64_tr_b16 v[44:45], v8 offset:40
    s_waitcnt lgkmcnt(7)
    v_mfma_f32_32x32x16_bf16 v[128:143], v[48:51], v[32:35], v[128:143]
    ds_read_b64_tr_b16 v[46:47], v8 offset:1320
    ds_read_b128 v[24:27], v6 offset:0
    v_mfma_f32_32x32x16_bf16 v[144:159], v[48:51], v[36:39], v[144:159]
    ds_read_b64_tr_b16 v[48:49], v8 offset:80
    ds_read_b128 v[28:31], v6 offset:4096
    s_waitcnt lgkmcnt(9)
    v_mfma_f32_32x32x16_bf16 v[160:175], v[52:55], v[32:35], v[160:175]
    ds_read_b64_tr_b16 v[50:51], v8 offset:1360
    v_mfma_f32_32x32x16_bf16 v[176:191], v[52:55], v[36:39], v[176:191]
    ds_read_b64_tr_b16 v[52:53], v8 offset:120
    s_waitcnt lgkmcnt(9)
    v_mfma_f32_32x32x16_bf16 v[192:207], v[56:59], v[32:35], v[192:207]
    ds_read_b64_tr_b16 v[54:55], v8 offset:1400
    v_mfma_f32_32x32x16_bf16 v[208:223], v[56:59], v[36:39], v[208:223]
    ds_read_b64_tr_b16 v[56:57], v9 offset:32
    s_waitcnt lgkmcnt(4)
    v_mfma_f32_32x32x16_bf16 v[64:79], v[40:43], v[24:27], v[64:79]
    ds_read_b64_tr_b16 v[58:59], v9 offset:1312
    v_mfma_f32_32x32x16_bf16 v[80:95], v[40:43], v[28:31], v[80:95]
    ds_read_b64_tr_b16 v[40:41], v8 offset:5120
    s_waitcnt lgkmcnt(6)
    v_mfma_f32_32x32x16_bf16 v[96:111], v[44:47], v[24:27], v[96:111]
    ds_read_b64_tr_b16 v[42:43], v8 offset:6400
    v_mfma_f32_32x32x16_bf16 v[112:127], v[44:47], v[28:31], v[112:127]
    ds_read_b64_tr_b16 v[44:45], v8 offset:5160
    s_waitcnt lgkmcnt(7)
    v_mfma_f32_32x32x16_bf16 v[128:143], v[48:51], v[24:27], v[128:143]
    ds_read_b64_tr_b16 v[46:47], v8 offset:6440
    ds_read_b128 v[32:35], v7 offset:0
    v_mfma_f32_32x32x16_bf16 v[144:159], v[48:51], v[28:31], v[144:159]
    ds_read_b64_tr_b16 v[48:49], v8 offset:5200
    ds_read_b128 v[36:39], v7 offset:4096
    s_waitcnt lgkmcnt(9)
    v_mfma_f32_32x32x16_bf16 v[160:175], v[52:55], v[24:27], v[160:175]
    ds_read_b64_tr_b16 v[50:51], v8 offset:6480
    v_mfma_f32_32x32x16_bf16 v[176:191], v[52:55], v[28:31], v[176:191]
    ds_read_b64_tr_b16 v[52:53], v8 offset:5240
    s_waitcnt lgkmcnt(9)
    v_mfma_f32_32x32x16_bf16 v[192:207], v[56:59], v[24:27], v[192:207]
    ds_read_b64_tr_b16 v[54:55], v8 offset:6520
    v_mfma_f32_32x32x16_bf16 v[208:223], v[56:59], v[28:31], v[208:223]
    ds_read_b64_tr_b16 v[56:57], v9 offset:5152
    s_waitcnt lgkmcnt(4)
    v_mfma_f32_32x32x16_bf16 v[64:79], v[40:43], v[32:35], v[64:79]
    ds_read_b64_tr_b16 v[58:59], v9 offset:6432
    v_mfma_f32_32x32x16_bf16 v[80:95], v[40:43], v[36:39], v[80:95]
    s_waitcnt lgkmcnt(5)
    v_mfma_f32_32x32x16_bf16 v[96:111], v[44:47], v[32:35], v[96:111]
    v_mfma_f32_32x32x16_bf16 v[112:127], v[44:47], v[36:39], v[112:127]
    s_waitcnt lgkmcnt(4)
    v_mfma_f32_32x32x16_bf16 v[128:143], v[48:51], v[32:35], v[128:143]
    v_mfma_f32_32x32x16_bf16 v[144:159], v[48:51], v[36:39], v[144:159]
    s_waitcnt lgkmcnt(2)
    v_mfma_f32_32x32x16_bf16 v[160:175], v[52:55], v[32:35], v[160:175]
    v_mfma_f32_32x32x16_bf16 v[176:191], v[52:55], v[36:39], v[176:191]
    s_waitcnt lgkmcnt(0)
    v_mfma_f32_32x32x16_bf16 v[192:207], v[56:59], v[32:35], v[192:207]
    v_mfma_f32_32x32x16_bf16 v[208:223], v[56:59], v[36:39], v[208:223]
    v_mov_b32 v23, 0
    global_load_dword v23, v23, s[20:21] sc1
    s_barrier
    s_nop 15
    s_cmp_eq_u32 s46, 0
    s_mov_b32 s60, 2621440
    s_mov_b32 s61, 5242880
    s_mov_b32 s47, 163840
    s_mov_b32 s48, 2560
    s_cselect_b32 s60, 0, s60
    s_cselect_b32 s61, 2621440, s61
    s_cselect_b32 s47, 81920, s47
    s_cselect_b32 s48, 1280, s48
    s_cselect_b32 s49, 0x3ea52b5c, 1.0
    s_add_u32 s40, s22, s60
    s_addc_u32 s41, s23, 0
    s_mov_b32 s42, s61
    s_mov_b32 s43, 0x20000
    s_and_b32 s60, s45, 3
    s_lshl_b32 s60, s60, 3
    s_mul_i32 s60, s60, s47
    s_lshl_b32 s61, s44, 3
    s_lshl_b32 s62, s3, 1
    s_add_u32 s61, s61, s62
    s_mul_i32 s61, s61, s48
    s_add_u32 s50, s60, s61
    v_lshlrev_b32 v10, 4, v1
    v_mul_lo_u32 v11, v3, s47
    v_lshlrev_b32 v12, 3, v2
    v_add_u32 v11, v11, v12
    v_add_u32 v11, 1024, v11
    s_mov_b32 s64, s49
    s_mov_b32 s65, s49
    v_pk_mul_f32 v[64:65], v[64:65], s[64:65]
    v_pk_mul_f32 v[66:67], v[66:67], s[64:65]
    v_pk_mul_f32 v[68:69], v[68:69], s[64:65]
    v_pk_mul_f32 v[70:71], v[70:71], s[64:65]
    v_pk_mul_f32 v[72:73], v[72:73], s[64:65]
    v_pk_mul_f32 v[74:75], v[74:75], s[64:65]
    v_pk_mul_f32 v[76:77], v[76:77], s[64:65]
    v_pk_mul_f32 v[78:79], v[78:79], s[64:65]
    v_cvt_pk_bf16_f32 v24, v64, v65
    v_cvt_pk_bf16_f32 v25, v66, v67
    v_cvt_pk_bf16_f32 v26, v68, v69
    v_cvt_pk_bf16_f32 v27, v70, v71
    s_mul_i32 s60, s47, 0
    s_add_u32 s60, s60, s50
    buffer_store_dwordx4 v[24:27], v10, s[40:43], s60 offen sc1
    v_cvt_pk_bf16_f32 v28, v72, v73
    v_cvt_pk_bf16_f32 v29, v74, v75
    v_cvt_pk_bf16_f32 v30, v76, v77
    v_cvt_pk_bf16_f32 v31, v78, v79
    s_mul_i32 s60, s47, 4
    s_add_u32 s60, s60, s50
    buffer_store_dwordx4 v[28:31], v10, s[40:43], s60 offen sc1
    v_pk_mul_f32 v[80:81], v[80:81], s[64:65]
    v_pk_mul_f32 v[82:83], v[82:83], s[64:65]
    v_pk_mul_f32 v[84:85], v[84:85], s[64:65]
    v_pk_mul_f32 v[86:87], v[86:87], s[64:65]
    v_pk_mul_f32 v[88:89], v[88:89], s[64:65]
    v_pk_mul_f32 v[90:91], v[90:91], s[64:65]
    v_pk_mul_f32 v[92:93], v[92:93], s[64:65]
    v_pk_mul_f32 v[94:95], v[94:95], s[64:65]
    v_cvt_pk_bf16_f32 v32, v80, v81
    v_cvt_pk_bf16_f32 v33, v82, v83
    v_cvt_pk_bf16_f32 v34, v84, v85
    v_cvt_pk_bf16_f32 v35, v86, v87
    s_mul_i32 s60, s47, 0
    s_add_u32 s60, s60, s50
    s_add_u32 s60, s60, s48
    buffer_store_dwordx4 v[32:35], v10, s[40:43], s60 offen sc1
    v_cvt_pk_bf16_f32 v36, v88, v89
    v_cvt_pk_bf16_f32 v37, v90, v91
    v_cvt_pk_bf16_f32 v38, v92, v93
    v_cvt_pk_bf16_f32 v39, v94, v95
    s_mul_i32 s60, s47, 4
    s_add_u32 s60, s60, s50
    s_add_u32 s60, s60, s48
    buffer_store_dwordx4 v[36:39], v10, s[40:43], s60 offen sc1
    v_pk_mul_f32 v[96:97], v[96:97], s[64:65]
    v_pk_mul_f32 v[98:99], v[98:99], s[64:65]
    v_pk_mul_f32 v[100:101], v[100:101], s[64:65]
    v_pk_mul_f32 v[102:103], v[102:103], s[64:65]
    v_pk_mul_f32 v[104:105], v[104:105], s[64:65]
    v_pk_mul_f32 v[106:107], v[106:107], s[64:65]
    v_pk_mul_f32 v[108:109], v[108:109], s[64:65]
    v_pk_mul_f32 v[110:111], v[110:111], s[64:65]
    v_cvt_pk_bf16_f32 v24, v96, v97
    v_cvt_pk_bf16_f32 v25, v98, v99
    v_cvt_pk_bf16_f32 v26, v100, v101
    v_cvt_pk_bf16_f32 v27, v102, v103
    s_mul_i32 s60, s47, 1
    s_add_u32 s60, s60, s50
    buffer_store_dwordx4 v[24:27], v10, s[40:43], s60 offen sc1
    v_cvt_pk_bf16_f32 v28, v104, v105
    v_cvt_pk_bf16_f32 v29, v106, v107
    v_cvt_pk_bf16_f32 v30, v108, v109
    v_cvt_pk_bf16_f32 v31, v110, v111
    s_mul_i32 s60, s47, 5
    s_add_u32 s60, s60, s50
    buffer_store_dwordx4 v[28:31], v10, s[40:43], s60 offen sc1
    v_pk_mul_f32 v[112:113], v[112:113], s[64:65]
    v_pk_mul_f32 v[114:115], v[114:115], s[64:65]
    v_pk_mul_f32 v[116:117], v[116:117], s[64:65]
    v_pk_mul_f32 v[118:119], v[118:119], s[64:65]
    v_pk_mul_f32 v[120:121], v[120:121], s[64:65]
    v_pk_mul_f32 v[122:123], v[122:123], s[64:65]
    v_pk_mul_f32 v[124:125], v[124:125], s[64:65]
    v_pk_mul_f32 v[126:127], v[126:127], s[64:65]
    v_cvt_pk_bf16_f32 v32, v112, v113
    v_cvt_pk_bf16_f32 v33, v114, v115
    v_cvt_pk_bf16_f32 v34, v116, v117
    v_cvt_pk_bf16_f32 v35, v118, v119
    s_mul_i32 s60, s47, 1
    s_add_u32 s60, s60, s50
    s_add_u32 s60, s60, s48
    buffer_store_dwordx4 v[32:35], v10, s[40:43], s60 offen sc1
    v_cvt_pk_bf16_f32 v36, v120, v121
    v_cvt_pk_bf16_f32 v37, v122, v123
    v_cvt_pk_bf16_f32 v38, v124, v125
    v_cvt_pk_bf16_f32 v39, v126, v127
    s_mul_i32 s60, s47, 5
    s_add_u32 s60, s60, s50
    s_add_u32 s60, s60, s48
    buffer_store_dwordx4 v[36:39], v10, s[40:43], s60 offen sc1
    v_pk_mul_f32 v[128:129], v[128:129], s[64:65]
    v_pk_mul_f32 v[130:131], v[130:131], s[64:65]
    v_pk_mul_f32 v[132:133], v[132:133], s[64:65]
    v_pk_mul_f32 v[134:135], v[134:135], s[64:65]
    v_pk_mul_f32 v[136:137], v[136:137], s[64:65]
    v_pk_mul_f32 v[138:139], v[138:139], s[64:65]
    v_pk_mul_f32 v[140:141], v[140:141], s[64:65]
    v_pk_mul_f32 v[142:143], v[142:143], s[64:65]
    v_cvt_pk_bf16_f32 v24, v128, v129
    v_cvt_pk_bf16_f32 v25, v130, v131
    v_cvt_pk_bf16_f32 v26, v132, v133
    v_cvt_pk_bf16_f32 v27, v134, v135
    s_mul_i32 s60, s47, 2
    s_add_u32 s60, s60, s50
    buffer_store_dwordx4 v[24:27], v10, s[40:43], s60 offen sc1
    v_cvt_pk_bf16_f32 v28, v136, v137
    v_cvt_pk_bf16_f32 v29, v138, v139
    v_cvt_pk_bf16_f32 v30, v140, v141
    v_cvt_pk_bf16_f32 v31, v142, v143
    s_mul_i32 s60, s47, 6
    s_add_u32 s60, s60, s50
    buffer_store_dwordx4 v[28:31], v10, s[40:43], s60 offen sc1
    v_pk_mul_f32 v[144:145], v[144:145], s[64:65]
    v_pk_mul_f32 v[146:147], v[146:147], s[64:65]
    v_pk_mul_f32 v[148:149], v[148:149], s[64:65]
    v_pk_mul_f32 v[150:151], v[150:151], s[64:65]
    v_pk_mul_f32 v[152:153], v[152:153], s[64:65]
    v_pk_mul_f32 v[154:155], v[154:155], s[64:65]
    v_pk_mul_f32 v[156:157], v[156:157], s[64:65]
    v_pk_mul_f32 v[158:159], v[158:159], s[64:65]
    v_cvt_pk_bf16_f32 v32, v144, v145
    v_cvt_pk_bf16_f32 v33, v146, v147
    v_cvt_pk_bf16_f32 v34, v148, v149
    v_cvt_pk_bf16_f32 v35, v150, v151
    s_mul_i32 s60, s47, 2
    s_add_u32 s60, s60, s50
    s_add_u32 s60, s60, s48
    buffer_store_dwordx4 v[32:35], v10, s[40:43], s60 offen sc1
    v_cvt_pk_bf16_f32 v36, v152, v153
    v_cvt_pk_bf16_f32 v37, v154, v155
    v_cvt_pk_bf16_f32 v38, v156, v157
    v_cvt_pk_bf16_f32 v39, v158, v159
    s_mul_i32 s60, s47, 6
    s_add_u32 s60, s60, s50
    s_add_u32 s60, s60, s48
    buffer_store_dwordx4 v[36:39], v10, s[40:43], s60 offen sc1
    v_pk_mul_f32 v[160:161], v[160:161], s[64:65]
    v_pk_mul_f32 v[162:163], v[162:163], s[64:65]
    v_pk_mul_f32 v[164:165], v[164:165], s[64:65]
    v_pk_mul_f32 v[166:167], v[166:167], s[64:65]
    v_pk_mul_f32 v[168:169], v[168:169], s[64:65]
    v_pk_mul_f32 v[170:171], v[170:171], s[64:65]
    v_pk_mul_f32 v[172:173], v[172:173], s[64:65]
    v_pk_mul_f32 v[174:175], v[174:175], s[64:65]
    v_cvt_pk_bf16_f32 v24, v160, v161
    v_cvt_pk_bf16_f32 v25, v162, v163
    v_cvt_pk_bf16_f32 v26, v164, v165
    v_cvt_pk_bf16_f32 v27, v166, v167
    s_mul_i32 s60, s47, 3
    s_add_u32 s60, s60, s50
    buffer_store_dwordx4 v[24:27], v10, s[40:43], s60 offen sc1
    v_cvt_pk_bf16_f32 v28, v168, v169
    v_cvt_pk_bf16_f32 v29, v170, v171
    v_cvt_pk_bf16_f32 v30, v172, v173
    v_cvt_pk_bf16_f32 v31, v174, v175
    s_mul_i32 s60, s47, 7
    s_add_u32 s60, s60, s50
    buffer_store_dwordx4 v[28:31], v10, s[40:43], s60 offen sc1
    v_pk_mul_f32 v[176:177], v[176:177], s[64:65]
    v_pk_mul_f32 v[178:179], v[178:179], s[64:65]
    v_pk_mul_f32 v[180:181], v[180:181], s[64:65]
    v_pk_mul_f32 v[182:183], v[182:183], s[64:65]
    v_pk_mul_f32 v[184:185], v[184:185], s[64:65]
    v_pk_mul_f32 v[186:187], v[186:187], s[64:65]
    v_pk_mul_f32 v[188:189], v[188:189], s[64:65]
    v_pk_mul_f32 v[190:191], v[190:191], s[64:65]
    v_cvt_pk_bf16_f32 v32, v176, v177
    v_cvt_pk_bf16_f32 v33, v178, v179
    v_cvt_pk_bf16_f32 v34, v180, v181
    v_cvt_pk_bf16_f32 v35, v182, v183
    s_mul_i32 s60, s47, 3
    s_add_u32 s60, s60, s50
    s_add_u32 s60, s60, s48
    buffer_store_dwordx4 v[32:35], v10, s[40:43], s60 offen sc1
    v_cvt_pk_bf16_f32 v36, v184, v185
    v_cvt_pk_bf16_f32 v37, v186, v187
    v_cvt_pk_bf16_f32 v38, v188, v189
    v_cvt_pk_bf16_f32 v39, v190, v191
    s_mul_i32 s60, s47, 7
    s_add_u32 s60, s60, s50
    s_add_u32 s60, s60, s48
    buffer_store_dwordx4 v[36:39], v10, s[40:43], s60 offen sc1
    v_pk_mul_f32 v[192:193], v[192:193], s[64:65]
    v_pk_mul_f32 v[194:195], v[194:195], s[64:65]
    v_pk_mul_f32 v[196:197], v[196:197], s[64:65]
    v_pk_mul_f32 v[198:199], v[198:199], s[64:65]
    v_pk_mul_f32 v[200:201], v[200:201], s[64:65]
    v_pk_mul_f32 v[202:203], v[202:203], s[64:65]
    v_pk_mul_f32 v[204:205], v[204:205], s[64:65]
    v_pk_mul_f32 v[206:207], v[206:207], s[64:65]
    v_cvt_pk_bf16_f32 v24, v192, v193
    v_cvt_pk_bf16_f32 v25, v194, v195
    s_mul_i32 s60, s47, 0
    s_add_u32 s60, s60, s50
    buffer_store_dwordx2 v[24:25], v11, s[40:43], s60 offen sc1
    v_cvt_pk_bf16_f32 v28, v196, v197
    v_cvt_pk_bf16_f32 v29, v198, v199
    s_mul_i32 s60, s47, 2
    s_add_u32 s60, s60, s50
    buffer_store_dwordx2 v[28:29], v11, s[40:43], s60 offen sc1
    v_cvt_pk_bf16_f32 v32, v200, v201
    v_cvt_pk_bf16_f32 v33, v202, v203
    s_mul_i32 s60, s47, 4
    s_add_u32 s60, s60, s50
    buffer_store_dwordx2 v[32:33], v11, s[40:43], s60 offen sc1
    v_cvt_pk_bf16_f32 v36, v204, v205
    v_cvt_pk_bf16_f32 v37, v206, v207
    s_mul_i32 s60, s47, 6
    s_add_u32 s60, s60, s50
    buffer_store_dwordx2 v[36:37], v11, s[40:43], s60 offen sc1
    v_pk_mul_f32 v[208:209], v[208:209], s[64:65]
    v_pk_mul_f32 v[210:211], v[210:211], s[64:65]
    v_pk_mul_f32 v[212:213], v[212:213], s[64:65]
    v_pk_mul_f32 v[214:215], v[214:215], s[64:65]
    v_pk_mul_f32 v[216:217], v[216:217], s[64:65]
    v_pk_mul_f32 v[218:219], v[218:219], s[64:65]
    v_pk_mul_f32 v[220:221], v[220:221], s[64:65]
    v_pk_mul_f32 v[222:223], v[222:223], s[64:65]
    v_cvt_pk_bf16_f32 v24, v208, v209
    v_cvt_pk_bf16_f32 v25, v210, v211
    s_mul_i32 s60, s47, 0
    s_add_u32 s60, s60, s50
    s_add_u32 s60, s60, s48
    buffer_store_dwordx2 v[24:25], v11, s[40:43], s60 offen sc1
    v_cvt_pk_bf16_f32 v28, v212, v213
    v_cvt_pk_bf16_f32 v29, v214, v215
    s_mul_i32 s60, s47, 2
    s_add_u32 s60, s60, s50
    s_add_u32 s60, s60, s48
    buffer_store_dwordx2 v[28:29], v11, s[40:43], s60 offen sc1
    v_cvt_pk_bf16_f32 v32, v216, v217
    v_cvt_pk_bf16_f32 v33, v218, v219
    s_mul_i32 s60, s47, 4
    s_add_u32 s60, s60, s50
    s_add_u32 s60, s60, s48
    buffer_store_dwordx2 v[32:33], v11, s[40:43], s60 offen sc1
    v_cvt_pk_bf16_f32 v36, v220, v221
    v_cvt_pk_bf16_f32 v37, v222, v223
    s_mul_i32 s60, s47, 6
    s_add_u32 s60, s60, s50
    s_add_u32 s60, s60, s48
    buffer_store_dwordx2 v[36:37], v11, s[40:43], s60 offen sc1
    s_branch p1_sigq
p1_v:
    v_lshlrev_b32 v11, 3, v13
    v_add_u32 v8, v11, v10
    s_mov_b32 s62, 12352
    s_mov_b32 s63, 32768
    s_mov_b32 s50, 0
    s_mov_b32 s51, 0
    v_mov_b32 v64, 0
    v_mov_b32 v65, 0
    v_mov_b32 v66, 0
    v_mov_b32 v67, 0
    v_mov_b32 v68, 0
    v_mov_b32 v69, 0
    v_mov_b32 v70, 0
    v_mov_b32 v71, 0
    v_mov_b32 v72, 0
    v_mov_b32 v73, 0
    v_mov_b32 v74, 0
    v_mov_b32 v75, 0
    v_mov_b32 v76, 0
    v_mov_b32 v77, 0
    v_mov_b32 v78, 0
    v_mov_b32 v79, 0
    v_mov_b32 v80, 0
    v_mov_b32 v81, 0
    v_mov_b32 v82, 0
    v_mov_b32 v83, 0
    v_mov_b32 v84, 0
    v_mov_b32 v85, 0
    v_mov_b32 v86, 0
    v_mov_b32 v87, 0
    v_mov_b32 v88, 0
    v_mov_b32 v89, 0
    v_mov_b32 v90, 0
    v_mov_b32 v91, 0
    v_mov_b32 v92, 0
    v_mov_b32 v93, 0
    v_mov_b32 v94, 0
    v_mov_b32 v95, 0
    v_mov_b32 v96, 0
    v_mov_b32 v97, 0
    v_mov_b32 v98, 0
    v_mov_b32 v99, 0
    v_mov_b32 v100, 0
    v_mov_b32 v101, 0
    v_mov_b32 v102, 0
    v_mov_b32 v103, 0
    v_mov_b32 v104, 0
    v_mov_b32 v105, 0
    v_mov_b32 v106, 0
    v_mov_b32 v107, 0
    v_mov_b32 v108, 0
    v_mov_b32 v109, 0
    v_mov_b32 v110, 0
    v_mov_b32 v111, 0
    v_mov_b32 v112, 0
    v_mov_b32 v113, 0
    v_mov_b32 v114, 0
    v_mov_b32 v115, 0
    v_mov_b32 v116, 0
    v_mov_b32 v117, 0
    v_mov_b32 v118, 0
    v_mov_b32 v119, 0
    v_mov_b32 v120, 0
    v_mov_b32 v121, 0
    v_mov_b32 v122, 0
    v_mov_b32 v123, 0
    v_mov_b32 v124, 0
    v_mov_b32 v125, 0
    v_mov_b32 v126, 0
    v_mov_b32 v127, 0
    v_mov_b32 v128, 0
    v_mov_b32 v129, 0
    v_mov_b32 v130, 0
    v_mov_b32 v131, 0
    v_mov_b32 v132, 0
    v_mov_b32 v133, 0
    v_mov_b32 v134, 0
    v_mov_b32 v135, 0
    v_mov_b32 v136, 0
    v_mov_b32 v137, 0
    v_mov_b32 v138, 0
    v_mov_b32 v139, 0
    v_mov_b32 v140, 0
    v_mov_b32 v141, 0
    v_mov_b32 v142, 0
    v_mov_b32 v143, 0
    v_mov_b32 v144, 0
    v_mov_b32 v145, 0
    v_mov_b32 v146, 0
    v_mov_b32 v147, 0
    v_mov_b32 v148, 0
    v_mov_b32 v149, 0
    v_mov_b32 v150, 0
    v_mov_b32 v151, 0
    v_mov_b32 v152, 0
    v_mov_b32 v153, 0
    v_mov_b32 v154, 0
    v_mov_b32 v155, 0
    v_mov_b32 v156, 0
    v_mov_b32 v157, 0
    v_mov_b32 v158, 0
    v_mov_b32 v159, 0
    v_mov_b32 v160, 0
    v_mov_b32 v161, 0
    v_mov_b32 v162, 0
    v_mov_b32 v163, 0
    v_mov_b32 v164, 0
    v_mov_b32 v165, 0
    v_mov_b32 v166, 0
    v_mov_b32 v167, 0
    v_mov_b32 v168, 0
    v_mov_b32 v169, 0
    v_mov_b32 v170, 0
    v_mov_b32 v171, 0
    v_mov_b32 v172, 0
    v_mov_b32 v173, 0
    v_mov_b32 v174, 0
    v_mov_b32 v175, 0
    v_mov_b32 v176, 0
    v_mov_b32 v177, 0
    v_mov_b32 v178, 0
    v_mov_b32 v179, 0
    v_mov_b32 v180, 0
    v_mov_b32 v181, 0
    v_mov_b32 v182, 0
    v_mov_b32 v183, 0
    v_mov_b32 v184, 0
    v_mov_b32 v185, 0
    v_mov_b32 v186, 0
    v_mov_b32 v187, 0
    v_mov_b32 v188, 0
    v_mov_b32 v189, 0
    v_mov_b32 v190, 0
    v_mov_b32 v191, 0
    v_mov_b32 v192, 0
    v_mov_b32 v193, 0
    v_mov_b32 v194, 0
    v_mov_b32 v195, 0
    v_mov_b32 v196, 0
    v_mov_b32 v197, 0
    v_mov_b32 v198, 0
    v_mov_b32 v199, 0
    v_mov_b32 v200, 0
    v_mov_b32 v201, 0
    v_mov_b32 v202, 0
    v_mov_b32 v203, 0
    v_mov_b32 v204, 0
    v_mov_b32 v205, 0
    v_mov_b32 v206, 0
    v_mov_b32 v207, 0
    v_mov_b32 v208, 0
    v_mov_b32 v209, 0
    v_mov_b32 v210, 0
    v_mov_b32 v211, 0
    v_mov_b32 v212, 0
    v_mov_b32 v213, 0
    v_mov_b32 v214, 0
    v_mov_b32 v215, 0
    v_mov_b32 v216, 0
    v_mov_b32 v217, 0
    v_mov_b32 v218, 0
    v_mov_b32 v219, 0
    v_mov_b32 v220, 0
    v_mov_b32 v221, 0
    v_mov_b32 v222, 0
    v_mov_b32 v223, 0
    s_barrier
    ds_read_b128 v[24:27], v4 offset:0
    ds_read_b128 v[28:31], v4 offset:4096
    ds_read_b64_tr_b16 v[40:41], v8 offset:0
    ds_read_b64_tr_b16 v[42:43], v8 offset:1280
    ds_read_b64_tr_b16 v[44:45], v8 offset:64
    ds_read_b64_tr_b16 v[46:47], v8 offset:1344
    ds_read_b64_tr_b16 v[48:49], v8 offset:128
    ds_read_b64_tr_b16 v[50:51], v8 offset:1408
    ds_read_b64_tr_b16 v[52:53], v8 offset:192
    ds_read_b64_tr_b16 v[54:55], v8 offset:1472
    ds_read_b64_tr_b16 v[56:57], v8 offset:256
    ds_read_b64_tr_b16 v[58:59], v8 offset:1536
    s_waitcnt lgkmcnt(8)
    v_mfma_f32_32x32x16_bf16 v[64:79], v[24:27], v[40:43], v[64:79]
    v_mfma_f32_32x32x16_bf16 v[80:95], v[28:31], v[40:43], v[80:95]
    ds_read_b64_tr_b16 v[40:41], v8 offset:5120
    s_waitcnt lgkmcnt(7)
    v_mfma_f32_32x32x16_bf16 v[96:111], v[24:27], v[44:47], v[96:111]
    ds_read_b64_tr_b16 v[42:43], v8 offset:6400
    v_mfma_f32_32x32x16_bf16 v[112:127], v[28:31], v[44:47], v[112:127]
    ds_read_b64_tr_b16 v[44:45], v8 offset:5184
    s_waitcnt lgkmcnt(7)
    v_mfma_f32_32x32x16_bf16 v[128:143], v[24:27], v[48:51], v[128:143]
    ds_read_b64_tr_b16 v[46:47], v8 offset:6464
    ds_read_b128 v[32:35], v5 offset:0
    v_mfma_f32_32x32x16_bf16 v[144:159], v[28:31], v[48:51], v[144:159]
    ds_read_b64_tr_b16 v[48:49], v8 offset:5248
    ds_read_b128 v[36:39], v5 offset:4096
    s_waitcnt lgkmcnt(9)
    v_mfma_f32_32x32x16_bf16 v[160:175], v[24:27], v[52:55], v[160:175]
    ds_read_b64_tr_b16 v[50:51], v8 offset:6528
    v_mfma_f32_32x32x16_bf16 v[176:191], v[28:31], v[52:55], v[176:191]
    ds_read_b64_tr_b16 v[52:53], v8 offset:5312
    s_waitcnt lgkmcnt(9)
    v_mfma_f32_32x32x16_bf16 v[192:207], v[24:27], v[56:59], v[192:207]
    ds_read_b64_tr_b16 v[54:55], v8 offset:6592
    v_mfma_f32_32x32x16_bf16 v[208:223], v[28:31], v[56:59], v[208:223]
    ds_read_b64_tr_b16 v[56:57], v8 offset:5376
    s_waitcnt lgkmcnt(4)
    v_mfma_f32_32x32x16_bf16 v[64:79], v[32:35], v[40:43], v[64:79]
    ds_read_b64_tr_b16 v[58:59], v8 offset:6656
    v_mfma_f32_32x32x16_bf16 v[80:95], v[36:39], v[40:43], v[80:95]
    s_barrier
    s_add_u32 s50, s50, 12352
    s_cmp_ge_u32 s50, 61760
    s_cselect_b32 s47, 4294917888, s62
    s_cselect_b32 s50, 0, s50
    v_add_u32 v8, s47, v8
    ds_read_b64_tr_b16 v[40:41], v8 offset:0
    s_waitcnt lgkmcnt(6)
    v_mfma_f32_32x32x16_bf16 v[96:111], v[32:35], v[44:47], v[96:111]
    ds_read_b64_tr_b16 v[42:43], v8 offset:1280
    v_mfma_f32_32x32x16_bf16 v[112:127], v[36:39], v[44:47], v[112:127]
    ds_read_b64_tr_b16 v[44:45], v8 offset:64
    s_waitcnt lgkmcnt(7)
    v_mfma_f32_32x32x16_bf16 v[128:143], v[32:35], v[48:51], v[128:143]
    ds_read_b64_tr_b16 v[46:47], v8 offset:1344
    ds_read_b128 v[24:27], v6 offset:0
    v_mfma_f32_32x32x16_bf16 v[144:159], v[36:39], v[48:51], v[144:159]
    ds_read_b64_tr_b16 v[48:49], v8 offset:128
    ds_read_b128 v[28:31], v6 offset:4096
    s_waitcnt lgkmcnt(9)
    v_mfma_f32_32x32x16_bf16 v[160:175], v[32:35], v[52:55], v[160:175]
    ds_read_b64_tr_b16 v[50:51], v8 offset:1408
    v_mfma_f32_32x32x16_bf16 v[176:191], v[36:39], v[52:55], v[176:191]
    ds_read_b64_tr_b16 v[52:53], v8 offset:192
    s_waitcnt lgkmcnt(9)
    v_mfma_f32_32x32x16_bf16 v[192:207], v[32:35], v[56:59], v[192:207]
    ds_read_b64_tr_b16 v[54:55], v8 offset:1472
    v_mfma_f32_32x32x16_bf16 v[208:223], v[36:39], v[56:59], v[208:223]
    ds_read_b64_tr_b16 v[56:57], v8 offset:256
    s_waitcnt lgkmcnt(4)
    v_mfma_f32_32x32x16_bf16 v[64:79], v[24:27], v[40:43], v[64:79]
    ds_read_b64_tr_b16 v[58:59], v8 offset:1536
    v_mfma_f32_32x32x16_bf16 v[80:95], v[28:31], v[40:43], v[80:95]
    ds_read_b64_tr_b16 v[40:41], v8 offset:5120
    s_waitcnt lgkmcnt(6)
    v_mfma_f32_32x32x16_bf16 v[96:111], v[24:27], v[44:47], v[96:111]
    ds_read_b64_tr_b16 v[42:43], v8 offset:6400
    v_mfma_f32_32x32x16_bf16 v[112:127], v[28:31], v[44:47], v[112:127]
    ds_read_b64_tr_b16 v[44:45], v8 offset:5184
    s_waitcnt lgkmcnt(7)
    v_mfma_f32_32x32x16_bf16 v[128:143], v[24:27], v[48:51], v[128:143]
    ds_read_b64_tr_b16 v[46:47], v8 offset:6464
    ds_read_b128 v[32:35], v7 offset:0
    v_mfma_f32_32x32x16_bf16 v[144:159], v[28:31], v[48:51], v[144:159]
    ds_read_b64_tr_b16 v[48:49], v8 offset:5248
    ds_read_b128 v[36:39], v7 offset:4096
    s_waitcnt lgkmcnt(9)
    v_mfma_f32_32x32x16_bf16 v[160:175], v[24:27], v[52:55], v[160:175]
    ds_read_b64_tr_b16 v[50:51], v8 offset:6528
    v_mfma_f32_32x32x16_bf16 v[176:191], v[28:31], v[52:55], v[176:191]
    ds_read_b64_tr_b16 v[52:53], v8 offset:5312
    s_waitcnt lgkmcnt(9)
    v_mfma_f32_32x32x16_bf16 v[192:207], v[24:27], v[56:59], v[192:207]
    ds_read_b64_tr_b16 v[54:55], v8 offset:6592
    v_mfma_f32_32x32x16_bf16 v[208:223], v[28:31], v[56:59], v[208:223]
    ds_read_b64_tr_b16 v[56:57], v8 offset:5376
    s_waitcnt lgkmcnt(4)
    v_mfma_f32_32x32x16_bf16 v[64:79], v[32:35], v[40:43], v[64:79]
    ds_read_b64_tr_b16 v[58:59], v8 offset:6656
    v_mfma_f32_32x32x16_bf16 v[80:95], v[36:39], v[40:43], v[80:95]
    s_barrier
    s_add_u32 s50, s50, 12352
    s_cmp_ge_u32 s50, 61760
    s_cselect_b32 s47, 4294917888, s62
    s_cselect_b32 s50, 0, s50
    v_add_u32 v8, s47, v8
    s_add_u32 s51, s51, 32768
    s_cmp_ge_u32 s51, 98304
    s_cselect_b32 s48, 4294901760, s63
    s_cselect_b32 s51, 0, s51
    v_add_u32 v4, s48, v4
    v_add_u32 v5, s48, v5
    v_add_u32 v6, s48, v6
    v_add_u32 v7, s48, v7
    ds_read_b64_tr_b16 v[40:41], v8 offset:0
    s_waitcnt lgkmcnt(6)
    v_mfma_f32_32x32x16_bf16 v[96:111], v[32:35], v[44:47], v[96:111]
    ds_read_b64_tr_b16 v[42:43], v8 offset:1280
    v_mfma_f32_32x32x16_bf16 v[112:127], v[36:39], v[44:47], v[112:127]
    ds_read_b64_tr_b16 v[44:45], v8 offset:64
    s_waitcnt lgkmcnt(7)
    v_mfma_f32_32x32x16_bf16 v[128:143], v[32:35], v[48:51], v[128:143]
    ds_read_b64_tr_b16 v[46:47], v8 offset:1344
    ds_read_b128 v[24:27], v4 offset:0
    v_mfma_f32_32x32x16_bf16 v[144:159], v[36:39], v[48:51], v[144:159]
    ds_read_b64_tr_b16 v[48:49], v8 offset:128
    ds_read_b128 v[28:31], v4 offset:4096
    s_waitcnt lgkmcnt(9)
    v_mfma_f32_32x32x16_bf16 v[160:175], v[32:35], v[52:55], v[160:175]
    ds_read_b64_tr_b16 v[50:51], v8 offset:1408
    v_mfma_f32_32x32x16_bf16 v[176:191], v[36:39], v[52:55], v[176:191]
    ds_read_b64_tr_b16 v[52:53], v8 offset:192
    s_waitcnt lgkmcnt(9)
    v_mfma_f32_32x32x16_bf16 v[192:207], v[32:35], v[56:59], v[192:207]
    ds_read_b64_tr_b16 v[54:55], v8 offset:1472
    v_mfma_f32_32x32x16_bf16 v[208:223], v[36:39], v[56:59], v[208:223]
    ds_read_b64_tr_b16 v[56:57], v8 offset:256
    s_mov_b32 s49, 8
p1c_22:
    s_waitcnt lgkmcnt(4)
    v_mfma_f32_32x32x16_bf16 v[64:79], v[24:27], v[40:43], v[64:79]
    ds_read_b64_tr_b16 v[58:59], v8 offset:1536
    v_mfma_f32_32x32x16_bf16 v[80:95], v[28:31], v[40:43], v[80:95]
    ds_read_b64_tr_b16 v[40:41], v8 offset:5120
    s_waitcnt lgkmcnt(6)
    v_mfma_f32_32x32x16_bf16 v[96:111], v[24:27], v[44:47], v[96:111]
    ds_read_b64_tr_b16 v[42:43], v8 offset:6400
    v_mfma_f32_32x32x16_bf16 v[112:127], v[28:31], v[44:47], v[112:127]
    ds_read_b64_tr_b16 v[44:45], v8 offset:5184
    s_waitcnt lgkmcnt(7)
    v_mfma_f32_32x32x16_bf16 v[128:143], v[24:27], v[48:51], v[128:143]
    ds_read_b64_tr_b16 v[46:47], v8 offset:6464
    ds_read_b128 v[32:35], v5 offset:0
    v_mfma_f32_32x32x16_bf16 v[144:159], v[28:31], v[48:51], v[144:159]
    ds_read_b64_tr_b16 v[48:49], v8 offset:5248
    ds_read_b128 v[36:39], v5 offset:4096
    s_waitcnt lgkmcnt(9)
    v_mfma_f32_32x32x16_bf16 v[160:175], v[24:27], v[52:55], v[160:175]
    ds_read_b64_tr_b16 v[50:51], v8 offset:6528
    v_mfma_f32_32x32x16_bf16 v[176:191], v[28:31], v[52:55], v[176:191]
    ds_read_b64_tr_b16 v[52:53], v8 offset:5312
    s_waitcnt lgkmcnt(9)
    v_mfma_f32_32x32x16_bf16 v[192:207], v[24:27], v[56:59], v[192:207]
    ds_read_b64_tr_b16 v[54:55], v8 offset:6592
    v_mfma_f32_32x32x16_bf16 v[208:223], v[28:31], v[56:59], v[208:223]
    ds_read_b64_tr_b16 v[56:57], v8 offset:5376
    s_waitcnt lgkmcnt(4)
    v_mfma_f32_32x32x16_bf16 v[64:79], v[32:35], v[40:43], v[64:79]
    ds_read_b64_tr_b16 v[58:59], v8 offset:6656
    v_mfma_f32_32x32x16_bf16 v[80:95], v[36:39], v[40:43], v[80:95]
    s_barrier
    s_add_u32 s50, s50, 12352
    s_cmp_ge_u32 s50, 61760
    s_cselect_b32 s47, 4294917888, s62
    s_cselect_b32 s50, 0, s50
    v_add_u32 v8, s47, v8
    ds_read_b64_tr_b16 v[40:41], v8 offset:0
    s_waitcnt lgkmcnt(6)
    v_mfma_f32_32x32x16_bf16 v[96:111], v[32:35], v[44:47], v[96:111]
    ds_read_b64_tr_b16 v[42:43], v8 offset:1280
    v_mfma_f32_32x32x16_bf16 v[112:127], v[36:39], v[44:47], v[112:127]
    ds_read_b64_tr_b16 v[44:45], v8 offset:64
    s_waitcnt lgkmcnt(7)
    v_mfma_f32_32x32x16_bf16 v[128:143], v[32:35], v[48:51], v[128:143]
    ds_read_b64_tr_b16 v[46:47], v8 offset:1344
    ds_read_b128 v[24:27], v6 offset:0
    v_mfma_f32_32x32x16_bf16 v[144:159], v[36:39], v[48:51], v[144:159]
    ds_read_b64_tr_b16 v[48:49], v8 offset:128
    ds_read_b128 v[28:31], v6 offset:4096
    s_waitcnt lgkmcnt(9)
    v_mfma_f32_32x32x16_bf16 v[160:175], v[32:35], v[52:55], v[160:175]
    ds_read_b64_tr_b16 v[50:51], v8 offset:1408
    v_mfma_f32_32x32x16_bf16 v[176:191], v[36:39], v[52:55], v[176:191]
    ds_read_b64_tr_b16 v[52:53], v8 offset:192
    s_waitcnt lgkmcnt(9)
    v_mfma_f32_32x32x16_bf16 v[192:207], v[32:35], v[56:59], v[192:207]
    ds_read_b64_tr_b16 v[54:55], v8 offset:1472
    v_mfma_f32_32x32x16_bf16 v[208:223], v[36:39], v[56:59], v[208:223]
    ds_read_b64_tr_b16 v[56:57], v8 offset:256
    s_waitcnt lgkmcnt(4)
    v_mfma_f32_32x32x16_bf16 v[64:79], v[24:27], v[40:43], v[64:79]
    ds_read_b64_tr_b16 v[58:59], v8 offset:1536
    v_mfma_f32_32x32x16_bf16 v[80:95], v[28:31], v[40:43], v[80:95]
    ds_read_b64_tr_b16 v[40:41], v8 offset:5120
    s_waitcnt lgkmcnt(6)
    v_mfma_f32_32x32x16_bf16 v[96:111], v[24:27], v[44:47], v[96:111]
    ds_read_b64_tr_b16 v[42:43], v8 offset:6400
    v_mfma_f32_32x32x16_bf16 v[112:127], v[28:31], v[44:47], v[112:127]
    ds_read_b64_tr_b16 v[44:45], v8 offset:5184
    s_waitcnt lgkmcnt(7)
    v_mfma_f32_32x32x16_bf16 v[128:143], v[24:27], v[48:51], v[128:143]
    ds_read_b64_tr_b16 v[46:47], v8 offset:6464
    ds_read_b128 v[32:35], v7 offset:0
    v_mfma_f32_32x32x16_bf16 v[144:159], v[28:31], v[48:51], v[144:159]
    ds_read_b64_tr_b16 v[48:49], v8 offset:5248
    ds_read_b128 v[36:39], v7 offset:4096
    s_waitcnt lgkmcnt(9)
    v_mfma_f32_32x32x16_bf16 v[160:175], v[24:27], v[52:55], v[160:175]
    ds_read_b64_tr_b16 v[50:51], v8 offset:6528
    v_mfma_f32_32x32x16_bf16 v[176:191], v[28:31], v[52:55], v[176:191]
    ds_read_b64_tr_b16 v[52:53], v8 offset:5312
    s_waitcnt lgkmcnt(9)
    v_mfma_f32_32x32x16_bf16 v[192:207], v[24:27], v[56:59], v[192:207]
    ds_read_b64_tr_b16 v[54:55], v8 offset:6592
    v_mfma_f32_32x32x16_bf16 v[208:223], v[28:31], v[56:59], v[208:223]
    ds_read_b64_tr_b16 v[56:57], v8 offset:5376
    s_waitcnt lgkmcnt(4)
    v_mfma_f32_32x32x16_bf16 v[64:79], v[32:35], v[40:43], v[64:79]
    ds_read_b64_tr_b16 v[58:59], v8 offset:6656
    v_mfma_f32_32x32x16_bf16 v[80:95], v[36:39], v[40:43], v[80:95]
    s_barrier
    s_add_u32 s50, s50, 12352
    s_cmp_ge_u32 s50, 61760
    s_cselect_b32 s47, 4294917888, s62
    s_cselect_b32 s50, 0, s50
    v_add_u32 v8, s47, v8
    s_add_u32 s51, s51, 32768
    s_cmp_ge_u32 s51, 98304
    s_cselect_b32 s48, 4294901760, s63
    s_cselect_b32 s51, 0, s51
    v_add_u32 v4, s48, v4
    v_add_u32 v5, s48, v5
    v_add_u32 v6, s48, v6
    v_add_u32 v7, s48, v7
    ds_read_b64_tr_b16 v[40:41], v8 offset:0
    s_waitcnt lgkmcnt(6)
    v_mfma_f32_32x32x16_bf16 v[96:111], v[32:35], v[44:47], v[96:111]
    ds_read_b64_tr_b16 v[42:43], v8 offset:1280
    v_mfma_f32_32x32x16_bf16 v[112:127], v[36:39], v[44:47], v[112:127]
    ds_read_b64_tr_b16 v[44:45], v8 offset:64
    s_waitcnt lgkmcnt(7)
    v_mfma_f32_32x32x16_bf16 v[128:143], v[32:35], v[48:51], v[128:143]
    ds_read_b64_tr_b16 v[46:47], v8 offset:1344
    ds_read_b128 v[24:27], v4 offset:0
    v_mfma_f32_32x32x16_bf16 v[144:159], v[36:39], v[48:51], v[144:159]
    ds_read_b64_tr_b16 v[48:49], v8 offset:128
    ds_read_b128 v[28:31], v4 offset:4096
    s_waitcnt lgkmcnt(9)
    v_mfma_f32_32x32x16_bf16 v[160:175], v[32:35], v[52:55], v[160:175]
    ds_read_b64_tr_b16 v[50:51], v8 offset:1408
    v_mfma_f32_32x32x16_bf16 v[176:191], v[36:39], v[52:55], v[176:191]
    ds_read_b64_tr_b16 v[52:53], v8 offset:192
    s_waitcnt lgkmcnt(9)
    v_mfma_f32_32x32x16_bf16 v[192:207], v[32:35], v[56:59], v[192:207]
    ds_read_b64_tr_b16 v[54:55], v8 offset:1472
    v_mfma_f32_32x32x16_bf16 v[208:223], v[36:39], v[56:59], v[208:223]
    ds_read_b64_tr_b16 v[56:57], v8 offset:256
    s_sub_u32 s49, s49, 1
    s_cmp_lg_u32 s49, 0
    s_cbranch_scc1 p1c_22
    s_waitcnt lgkmcnt(4)
    v_mfma_f32_32x32x16_bf16 v[64:79], v[24:27], v[40:43], v[64:79]
    ds_read_b64_tr_b16 v[58:59], v8 offset:1536
    v_mfma_f32_32x32x16_bf16 v[80:95], v[28:31], v[40:43], v[80:95]
    ds_read_b64_tr_b16 v[40:41], v8 offset:5120
    s_waitcnt lgkmcnt(6)
    v_mfma_f32_32x32x16_bf16 v[96:111], v[24:27], v[44:47], v[96:111]
    ds_read_b64_tr_b16 v[42:43], v8 offset:6400
    v_mfma_f32_32x32x16_bf16 v[112:127], v[28:31], v[44:47], v[112:127]
    ds_read_b64_tr_b16 v[44:45], v8 offset:5184
    s_waitcnt lgkmcnt(7)
    v_mfma_f32_32x32x16_bf16 v[128:143], v[24:27], v[48:51], v[128:143]
    ds_read_b64_tr_b16 v[46:47], v8 offset:6464
    ds_read_b128 v[32:35], v5 offset:0
    v_mfma_f32_32x32x16_bf16 v[144:159], v[28:31], v[48:51], v[144:159]
    ds_read_b64_tr_b16 v[48:49], v8 offset:5248
    ds_read_b128 v[36:39], v5 offset:4096
    s_waitcnt lgkmcnt(9)
    v_mfma_f32_32x32x16_bf16 v[160:175], v[24:27], v[52:55], v[160:175]
    ds_read_b64_tr_b16 v[50:51], v8 offset:6528
    v_mfma_f32_32x32x16_bf16 v[176:191], v[28:31], v[52:55], v[176:191]
    ds_read_b64_tr_b16 v[52:53], v8 offset:5312
    s_waitcnt lgkmcnt(9)
    v_mfma_f32_32x32x16_bf16 v[192:207], v[24:27], v[56:59], v[192:207]
    ds_read_b64_tr_b16 v[54:55], v8 offset:6592
    v_mfma_f32_32x32x16_bf16 v[208:223], v[28:31], v[56:59], v[208:223]
    ds_read_b64_tr_b16 v[56:57], v8 offset:5376
    s_waitcnt lgkmcnt(4)
    v_mfma_f32_32x32x16_bf16 v[64:79], v[32:35], v[40:43], v[64:79]
    ds_read_b64_tr_b16 v[58:59], v8 offset:6656
    v_mfma_f32_32x32x16_bf16 v[80:95], v[36:39], v[40:43], v[80:95]
    s_barrier
    s_add_u32 s50, s50, 12352
    s_cmp_ge_u32 s50, 61760
    s_cselect_b32 s47, 4294917888, s62
    s_cselect_b32 s50, 0, s50
    v_add_u32 v8, s47, v8
    ds_read_b64_tr_b16 v[40:41], v8 offset:0
    s_waitcnt lgkmcnt(6)
    v_mfma_f32_32x32x16_bf16 v[96:111], v[32:35], v[44:47], v[96:111]
    ds_read_b64_tr_b16 v[42:43], v8 offset:1280
    v_mfma_f32_32x32x16_bf16 v[112:127], v[36:39], v[44:47], v[112:127]
    ds_read_b64_tr_b16 v[44:45], v8 offset:64
    s_waitcnt lgkmcnt(7)
    v_mfma_f32_32x32x16_bf16 v[128:143], v[32:35], v[48:51], v[128:143]
    ds_read_b64_tr_b16 v[46:47], v8 offset:1344
    ds_read_b128 v[24:27], v6 offset:0
    v_mfma_f32_32x32x16_bf16 v[144:159], v[36:39], v[48:51], v[144:159]
    ds_read_b64_tr_b16 v[48:49], v8 offset:128
    ds_read_b128 v[28:31], v6 offset:4096
    s_waitcnt lgkmcnt(9)
    v_mfma_f32_32x32x16_bf16 v[160:175], v[32:35], v[52:55], v[160:175]
    ds_read_b64_tr_b16 v[50:51], v8 offset:1408
    v_mfma_f32_32x32x16_bf16 v[176:191], v[36:39], v[52:55], v[176:191]
    ds_read_b64_tr_b16 v[52:53], v8 offset:192
    s_waitcnt lgkmcnt(9)
    v_mfma_f32_32x32x16_bf16 v[192:207], v[32:35], v[56:59], v[192:207]
    ds_read_b64_tr_b16 v[54:55], v8 offset:1472
    v_mfma_f32_32x32x16_bf16 v[208:223], v[36:39], v[56:59], v[208:223]
    ds_read_b64_tr_b16 v[56:57], v8 offset:256
    s_waitcnt lgkmcnt(4)
    v_mfma_f32_32x32x16_bf16 v[64:79], v[24:27], v[40:43], v[64:79]
    ds_read_b64_tr_b16 v[58:59], v8 offset:1536
    v_mfma_f32_32x32x16_bf16 v[80:95], v[28:31], v[40:43], v[80:95]
    ds_read_b64_tr_b16 v[40:41], v8 offset:5120
    s_waitcnt lgkmcnt(6)
    v_mfma_f32_32x32x16_bf16 v[96:111], v[24:27], v[44:47], v[96:111]
    ds_read_b64_tr_b16 v[42:43], v8 offset:6400
    v_mfma_f32_32x32x16_bf16 v[112:127], v[28:31], v[44:47], v[112:127]
    ds_read_b64_tr_b16 v[44:45], v8 offset:5184
    s_waitcnt lgkmcnt(7)
    v_mfma_f32_32x32x16_bf16 v[128:143], v[24:27], v[48:51], v[128:143]
    ds_read_b64_tr_b16 v[46:47], v8 offset:6464
    ds_read_b128 v[32:35], v7 offset:0
    v_mfma_f32_32x32x16_bf16 v[144:159], v[28:31], v[48:51], v[144:159]
    ds_read_b64_tr_b16 v[48:49], v8 offset:5248
    ds_read_b128 v[36:39], v7 offset:4096
    s_waitcnt lgkmcnt(9)
    v_mfma_f32_32x32x16_bf16 v[160:175], v[24:27], v[52:55], v[160:175]
    ds_read_b64_tr_b16 v[50:51], v8 offset:6528
    v_mfma_f32_32x32x16_bf16 v[176:191], v[28:31], v[52:55], v[176:191]
    ds_read_b64_tr_b16 v[52:53], v8 offset:5312
    s_waitcnt lgkmcnt(9)
    v_mfma_f32_32x32x16_bf16 v[192:207], v[24:27], v[56:59], v[192:207]
    ds_read_b64_tr_b16 v[54:55], v8 offset:6592
    v_mfma_f32_32x32x16_bf16 v[208:223], v[28:31], v[56:59], v[208:223]
    ds_read_b64_tr_b16 v[56:57], v8 offset:5376
    s_waitcnt lgkmcnt(4)
    v_mfma_f32_32x32x16_bf16 v[64:79], v[32:35], v[40:43], v[64:79]
    ds_read_b64_tr_b16 v[58:59], v8 offset:6656
    v_mfma_f32_32x32x16_bf16 v[80:95], v[36:39], v[40:43], v[80:95]
    s_waitcnt lgkmcnt(5)
    v_mfma_f32_32x32x16_bf16 v[96:111], v[32:35], v[44:47], v[96:111]
    v_mfma_f32_32x32x16_bf16 v[112:127], v[36:39], v[44:47], v[112:127]
    s_waitcnt lgkmcnt(4)
    v_mfma_f32_32x32x16_bf16 v[128:143], v[32:35], v[48:51], v[128:143]
    v_mfma_f32_32x32x16_bf16 v[144:159], v[36:39], v[48:51], v[144:159]
    s_waitcnt lgkmcnt(2)
    v_mfma_f32_32x32x16_bf16 v[160:175], v[32:35], v[52:55], v[160:175]
    v_mfma_f32_32x32x16_bf16 v[176:191], v[36:39], v[52:55], v[176:191]
    s_waitcnt lgkmcnt(0)
    v_mfma_f32_32x32x16_bf16 v[192:207], v[32:35], v[56:59], v[192:207]
    v_mfma_f32_32x32x16_bf16 v[208:223], v[36:39], v[56:59], v[208:223]
    v_mov_b32 v23, 0
    global_load_dword v23, v23, s[20:21] sc1
    s_barrier
    s_nop 15
    s_add_u32 s40, s22, 2621440
    s_addc_u32 s41, s23, 0
    s_mov_b32 s42, 5242880
    s_mov_b32 s43, 0x20000
    s_lshl_b32 s61, s44, 3
    s_lshl_b32 s62, s3, 1
    s_add_u32 s61, s61, s62
    s_mul_i32 s61, s61, 2560
    s_add_u32 s50, s61, 1280
    s_and_b32 s60, s45, 3
    s_mul_i32 s60, s60, 160
    s_mov_b32 s47, 163840
    v_add_u32 v10, s60, v2
    v_add_u32 v10, 0, v10
    v_mul_u32_u24 v11, 52429, v10
    v_lshrrev_b32 v11, 20, v11
    v_mul_u32_u24 v12, 20, v11
    v_sub_u32 v12, v10, v12
    v_mul_lo_u32 v11, v11, s47
    v_lshrrev_b32 v13, 4, v12
    v_xor_b32 v13, v13, v3
    v_lshl_add_u32 v13, v12, 1, v13
    v_lshl_add_u32 v14, v13, 4, v11
    v_cvt_pk_bf16_f32 v24, v64, v65
    v_cvt_pk_bf16_f32 v25, v66, v67
    v_cvt_pk_bf16_f32 v26, v68, v69
    v_cvt_pk_bf16_f32 v27, v70, v71
    buffer_store_dwordx4 v[24:27], v14, s[40:43], s50 offen offset:0 sc1
    v_cvt_pk_bf16_f32 v28, v72, v73
    v_cvt_pk_bf16_f32 v29, v74, v75
    v_cvt_pk_bf16_f32 v30, v76, v77
    v_cvt_pk_bf16_f32 v31, v78, v79
    buffer_store_dwordx4 v[28:31], v14, s[40:43], s50 offen offset:640 sc1
    v_cvt_pk_bf16_f32 v32, v80, v81
    v_cvt_pk_bf16_f32 v33, v82, v83
    v_cvt_pk_bf16_f32 v34, v84, v85
    v_cvt_pk_bf16_f32 v35, v86, v87
    buffer_store_dwordx4 v[32:35], v14, s[40:43], s50 offen offset:2560 sc1
    v_cvt_pk_bf16_f32 v36, v88, v89
    v_cvt_pk_bf16_f32 v37, v90, v91
    v_cvt_pk_bf16_f32 v38, v92, v93
    v_cvt_pk_bf16_f32 v39, v94, v95
    buffer_store_dwordx4 v[36:39], v14, s[40:43], s50 offen offset:3200 sc1
    v_add_u32 v10, s60, v2
    v_add_u32 v10, 32, v10
    v_mul_u32_u24 v11, 52429, v10
    v_lshrrev_b32 v11, 20, v11
    v_mul_u32_u24 v12, 20, v11
    v_sub_u32 v12, v10, v12
    v_mul_lo_u32 v11, v11, s47
    v_lshrrev_b32 v13, 4, v12
    v_xor_b32 v13, v13, v3
    v_lshl_add_u32 v13, v12, 1, v13
    v_lshl_add_u32 v15, v13, 4, v11
    v_cvt_pk_bf16_f32 v24, v96, v97
    v_cvt_pk_bf16_f32 v25, v98, v99
    v_cvt_pk_bf16_f32 v26, v100, v101
    v_cvt_pk_bf16_f32 v27, v102, v103
    buffer_store_dwordx4 v[24:27], v15, s[40:43], s50 offen offset:0 sc1
    v_cvt_pk_bf16_f32 v28, v104, v105
    v_cvt_pk_bf16_f32 v29, v106, v107
    v_cvt_pk_bf16_f32 v30, v108, v109
    v_cvt_pk_bf16_f32 v31, v110, v111
    buffer_store_dwordx4 v[28:31], v15, s[40:43], s50 offen offset:640 sc1
    v_cvt_pk_bf16_f32 v32, v112, v113
    v_cvt_pk_bf16_f32 v33, v114, v115
    v_cvt_pk_bf16_f32 v34, v116, v117
    v_cvt_pk_bf16_f32 v35, v118, v119
    buffer_store_dwordx4 v[32:35], v15, s[40:43], s50 offen offset:2560 sc1
    v_cvt_pk_bf16_f32 v36, v120, v121
    v_cvt_pk_bf16_f32 v37, v122, v123
    v_cvt_pk_bf16_f32 v38, v124, v125
    v_cvt_pk_bf16_f32 v39, v126, v127
    buffer_store_dwordx4 v[36:39], v15, s[40:43], s50 offen offset:3200 sc1
    v_add_u32 v10, s60, v2
    v_add_u32 v10, 64, v10
    v_mul_u32_u24 v11, 52429, v10
    v_lshrrev_b32 v11, 20, v11
    v_mul_u32_u24 v12, 20, v11
    v_sub_u32 v12, v10, v12
    v_mul_lo_u32 v11, v11, s47
    v_lshrrev_b32 v13, 4, v12
    v_xor_b32 v13, v13, v3
    v_lshl_add_u32 v13, v12, 1, v13
    v_lshl_add_u32 v14, v13, 4, v11
    v_cvt_pk_bf16_f32 v24, v128, v129
    v_cvt_pk_bf16_f32 v25, v130, v131
    v_cvt_pk_bf16_f32 v26, v132, v133
    v_cvt_pk_bf16_f32 v27, v134, v135
    buffer_store_dwordx4 v[24:27], v14, s[40:43], s50 offen offset:0 sc1
    v_cvt_pk_bf16_f32 v28, v136, v137
    v_cvt_pk_bf16_f32 v29, v138, v139
    v_cvt_pk_bf16_f32 v30, v140, v141
    v_cvt_pk_bf16_f32 v31, v142, v143
    buffer_store_dwordx4 v[28:31], v14, s[40:43], s50 offen offset:640 sc1
    v_cvt_pk_bf16_f32 v32, v144, v145
    v_cvt_pk_bf16_f32 v33, v146, v147
    v_cvt_pk_bf16_f32 v34, v148, v149
    v_cvt_pk_bf16_f32 v35, v150, v151
    buffer_store_dwordx4 v[32:35], v14, s[40:43], s50 offen offset:2560 sc1
    v_cvt_pk_bf16_f32 v36, v152, v153
    v_cvt_pk_bf16_f32 v37, v154, v155
    v_cvt_pk_bf16_f32 v38, v156, v157
    v_cvt_pk_bf16_f32 v39, v158, v159
    buffer_store_dwordx4 v[36:39], v14, s[40:43], s50 offen offset:3200 sc1
    v_add_u32 v10, s60, v2
    v_add_u32 v10, 96, v10
    v_mul_u32_u24 v11, 52429, v10
    v_lshrrev_b32 v11, 20, v11
    v_mul_u32_u24 v12, 20, v11
    v_sub_u32 v12, v10, v12
    v_mul_lo_u32 v11, v11, s47
    v_lshrrev_b32 v13, 4, v12
    v_xor_b32 v13, v13, v3
    v_lshl_add_u32 v13, v12, 1, v13
    v_lshl_add_u32 v15, v13, 4, v11
    v_cvt_pk_bf16_f32 v24, v160, v161
    v_cvt_pk_bf16_f32 v25, v162, v163
    v_cvt_pk_bf16_f32 v26, v164, v165
    v_cvt_pk_bf16_f32 v27, v166, v167
    buffer_store_dwordx4 v[24:27], v15, s[40:43], s50 offen offset:0 sc1
    v_cvt_pk_bf16_f32 v28, v168, v169
    v_cvt_pk_bf16_f32 v29, v170, v171
    v_cvt_pk_bf16_f32 v30, v172, v173
    v_cvt_pk_bf16_f32 v31, v174, v175
    buffer_store_dwordx4 v[28:31], v15, s[40:43], s50 offen offset:640 sc1
    v_cvt_pk_bf16_f32 v32, v176, v177
    v_cvt_pk_bf16_f32 v33, v178, v179
    v_cvt_pk_bf16_f32 v34, v180, v181
    v_cvt_pk_bf16_f32 v35, v182, v183
    buffer_store_dwordx4 v[32:35], v15, s[40:43], s50 offen offset:2560 sc1
    v_cvt_pk_bf16_f32 v36, v184, v185
    v_cvt_pk_bf16_f32 v37, v186, v187
    v_cvt_pk_bf16_f32 v38, v188, v189
    v_cvt_pk_bf16_f32 v39, v190, v191
    buffer_store_dwordx4 v[36:39], v15, s[40:43], s50 offen offset:3200 sc1
    v_add_u32 v10, s60, v2
    v_add_u32 v10, 128, v10
    v_mul_u32_u24 v11, 52429, v10
    v_lshrrev_b32 v11, 20, v11
    v_mul_u32_u24 v12, 20, v11
    v_sub_u32 v12, v10, v12
    v_mul_lo_u32 v11, v11, s47
    v_lshrrev_b32 v13, 4, v12
    v_xor_b32 v13, v13, v3
    v_lshl_add_u32 v13, v12, 1, v13
    v_lshl_add_u32 v14, v13, 4, v11
    v_cvt_pk_bf16_f32 v24, v192, v193
    v_cvt_pk_bf16_f32 v25, v194, v195
    v_cvt_pk_bf16_f32 v26, v196, v197
    v_cvt_pk_bf16_f32 v27, v198, v199
    buffer_store_dwordx4 v[24:27], v14, s[40:43], s50 offen offset:0 sc1
    v_cvt_pk_bf16_f32 v28, v200, v201
    v_cvt_pk_bf16_f32 v29, v202, v203
    v_cvt_pk_bf16_f32 v30, v204, v205
    v_cvt_pk_bf16_f32 v31, v206, v207
    buffer_store_dwordx4 v[28:31], v14, s[40:43], s50 offen offset:640 sc1
    v_cvt_pk_bf16_f32 v32, v208, v209
    v_cvt_pk_bf16_f32 v33, v210, v211
    v_cvt_pk_bf16_f32 v34, v212, v213
    v_cvt_pk_bf16_f32 v35, v214, v215
    buffer_store_dwordx4 v[32:35], v14, s[40:43], s50 offen offset:2560 sc1
    v_cvt_pk_bf16_f32 v36, v216, v217
    v_cvt_pk_bf16_f32 v37, v218, v219
    v_cvt_pk_bf16_f32 v38, v220, v221
    v_cvt_pk_bf16_f32 v39, v222, v223
    buffer_store_dwordx4 v[36:39], v14, s[40:43], s50 offen offset:3200 sc1
p1_sigq:
    s_waitcnt vmcnt(0)
    s_barrier
    s_and_b32 s60, s45, 3
    s_lshl_b32 s60, s60, 1
    s_cmp_lg_u32 s3, 0
    s_cbranch_scc1 sig_23
    s_mov_b32 s26, 0x40000
sig_23_p:
    v_readfirstlane_b32 s27, v23
    s_sub_u32 s26, s26, 1
    s_cmp_eq_u32 s26, 0
    s_cbranch_scc1 sig_23_go
    s_cmp_lg_u32 s27, 0
    s_cbranch_scc1 sig_23_go
    v_mov_b32 v23, 0
    global_load_dword v23, v23, s[20:21] sc1
    s_waitcnt vmcnt(0)
    s_branch sig_23_p
sig_23_go:
    s_mov_b64 s[24:25], exec
    s_mov_b64 exec, 3
    v_add_u32 v10, s60, v1
    v_lshlrev_b32 v10, 8, v10
    v_add_u32 v10, 8126464, v10
    v_mov_b32 v11, 1
    global_atomic_add v10, v11, s[22:23]
    s_mov_b64 exec, s[24:25]
sig_23:
    s_mov_b32 s54, -1
    s_mov_b32 s47, 0
    s_branch after_p1
p1_notqkv:
    s_sub_u32 s61, s61, 3
    s_cmp_lt_u32 s60, 2
    s_cselect_b32 s62, 5, 4
    s_cmp_ge_u32 s61, s62
    s_cbranch_scc1 p1_gate
    s_mul_i32 s45, s60, 5
    s_cmp_eq_u32 s60, 3
    s_cselect_b32 s62, 1, 0
    s_sub_u32 s45, s45, s62
    s_add_u32 s45, s45, s61
    s_mov_b32 s56, 104480
    s_cmp_lt_u32 s3, 4
    s_cbranch_scc1 p1_fc
    s_sub_u32 s51, s3, 4
    v_lshrrev_b32 v16, 3, v1
    v_and_b32 v17, 7, v1
    s_lshl_b32 s60, s44, 8
    s_lshl_b32 s61, s51, 6
    s_add_u32 s60, s60, s61
    v_add_u32 v18, s60, v16
    v_mul_u32_u24 v18, 1280, v18
    v_lshrrev_b32 v19, 4, v1
    v_xor_b32 v20, v19, v17
    v_lshl_add_u32 v4, v20, 4, v18
    v_xor_b32 v20, 4, v20
    v_lshl_add_u32 v5, v20, 4, v18
    v_add_u32 v5, 9216, v5
    v_add_u32 v6, 18432, v4
    v_add_u32 v7, 18432, v5
    v_add_u32 v8, 40960, v4
    v_add_u32 v9, 40960, v5
    v_add_u32 v10, 40960, v6
    v_add_u32 v11, 40960, v7
    s_lshl_b32 s52, s51, 13
    s_mov_b32 s47, 0
    s_and_b32 s60, s44, 3
    s_mul_i32 s60, s60, 1
    s_lshr_b32 s61, s2, 5
    s_add_u32 s60, s60, s61
    s_and_b32 s60, s60, 3
    s_mul_i32 s57, s60, 5
    s_lshr_b32 s57, s57, 1
    s_lshl_b32 s49, s57, 7
    s_mul_i32 s62, s45, 192
    s_mul_i32 s60, s51, 3
    s_add_u32 s60, s60, 0
    s_cmp_lt_u32 s60, 6
    s_cselect_b32 s63, 0, 6
    s_cselect_b32 s53, 98304, s56
    s_sub_u32 s60, s60, s63
    s_lshl_b32 s61, s60, 6
    v_add_u32 v16, s61, v1
    v_mul_u32_u24 v17, 5462, v16
    v_lshrrev_b32 v17, 16, v17
    v_mul_u32_u24 v18, 12, v17
    v_sub_u32 v18, v16, v18
    v_mul_u32_u24 v17, 3456, v17
    v_lshlrev_b32 v18, 4, v18
    v_add3_u32 v12, v17, v18, s62
    s_lshl_b32 s60, s60, 10
    s_add_u32 s53, s53, s60
    s_mul_i32 s60, s51, 3
    s_add_u32 s60, s60, 1
    s_cmp_lt_u32 s60, 6
    s_cselect_b32 s63, 0, 6
    s_cselect_b32 s54, 98304, s56
    s_sub_u32 s60, s60, s63
    s_lshl_b32 s61, s60, 6
    v_add_u32 v16, s61, v1
    v_mul_u32_u24 v17, 5462, v16
    v_lshrrev_b32 v17, 16, v17
    v_mul_u32_u24 v18, 12, v17
    v_sub_u32 v18, v16, v18
    v_mul_u32_u24 v17, 3456, v17
    v_lshlrev_b32 v18, 4, v18
    v_add3_u32 v13, v17, v18, s62
    s_lshl_b32 s60, s60, 10
    s_add_u32 s54, s54, s60
    s_mul_i32 s60, s51, 3
    s_add_u32 s60, s60, 2
    s_cmp_lt_u32 s60, 6
    s_cselect_b32 s63, 0, 6
    s_cselect_b32 s55, 98304, s56
    s_sub_u32 s60, s60, s63
    s_lshl_b32 s61, s60, 6
    v_add_u32 v16, s61, v1
    v_mul_u32_u24 v17, 5462, v16
    v_lshrrev_b32 v17, 16, v17
    v_mul_u32_u24 v18, 12, v17
    v_sub_u32 v18, v16, v18
    v_mul_u32_u24 v17, 3456, v17
    v_lshlrev_b32 v18, 4, v18
    v_add3_u32 v14, v17, v18, s62
    s_lshl_b32 s60, s60, 10
    s_add_u32 s55, s55, s60
    s_mov_b32 s48, 0
    s_mul_i32 s50, s57, 221184
    s_waitcnt lgkmcnt(0)
    s_mov_b32 s28, s4
    s_mov_b32 s29, s5
    s_mov_b32 s30, 2621440
    s_mov_b32 s31, 0x20000
    s_cmp_lt_u32 s3, 6
    s_cselect_b32 s32, s10, s12
    s_cselect_b32 s33, s11, s13
    s_mov_b32 s34, 2211840
    s_mov_b32 s35, 0x20000
    s_add_u32 m0, s47, s52
    s_nop 0
    buffer_load_dwordx4 v4, s[28:31], s49 offen offset:0  lds
    buffer_load_dwordx4 v5, s[28:31], s49 offen offset:1024  lds
    buffer_load_dwordx4 v6, s[28:31], s49 offen offset:2048  lds
    buffer_load_dwordx4 v7, s[28:31], s49 offen offset:3072  lds
    s_add_u32 m0, m0, 4096
    s_add_u32 s47, s47, 32768
    buffer_load_dwordx4 v8, s[28:31], s49 offen offset:0  lds
    buffer_load_dwordx4 v9, s[28:31], s49 offen offset:1024  lds
    buffer_load_dwordx4 v10, s[28:31], s49 offen offset:2048  lds
    buffer_load_dwordx4 v11, s[28:31], s49 offen offset:3072  lds
    s_add_u32 s49, s49, 128
    s_cmp_ge_u32 s47, 98304
    s_cselect_b32 s47, 0, s47
    s_cmp_ge_u32 s49, 1280
    s_cselect_b32 s49, 0, s49
    s_add_u32 m0, s48, s53
    s_nop 0
    buffer_load_dwordx4 v12, s[32:35], s50 offen  lds
    s_add_u32 m0, s48, s54
    s_nop 0
    buffer_load_dwordx4 v13, s[32:35], s50 offen  lds
    s_add_u32 m0, s48, s55
    s_nop 0
    buffer_load_dwordx4 v14, s[32:35], s50 offen  lds
    s_add_u32 s50, s50, 110592
    s_add_u32 s48, s48, 12352
    s_cmp_ge_u32 s48, 61760
    s_cselect_b32 s48, 0, s48
    s_cmp_ge_u32 s50, 2211840
    s_cselect_b32 s50, 0, s50
    s_add_u32 m0, s48, s53
    s_nop 0
    buffer_load_dwordx4 v12, s[32:35], s50 offen  lds
    s_add_u32 m0, s48, s54
    s_nop 0
    buffer_load_dwordx4 v13, s[32:35], s50 offen  lds
    s_add_u32 m0, s48, s55
    s_nop 0
    buffer_load_dwordx4 v14, s[32:35], s50 offen  lds
    s_add_u32 s50, s50, 110592
    s_add_u32 s48, s48, 12352
    s_cmp_ge_u32 s48, 61760
    s_cselect_b32 s48, 0, s48
    s_cmp_ge_u32 s50, 2211840
    s_cselect_b32 s50, 0, s50
    s_add_u32 m0, s47, s52
    s_nop 0
    buffer_load_dwordx4 v4, s[28:31], s49 offen offset:0  lds
    buffer_load_dwordx4 v5, s[28:31], s49 offen offset:1024  lds
    buffer_load_dwordx4 v6, s[28:31], s49 offen offset:2048  lds
    buffer_load_dwordx4 v7, s[28:31], s49 offen offset:3072  lds
    s_add_u32 m0, m0, 4096
    s_add_u32 s47, s47, 32768
    buffer_load_dwordx4 v8, s[28:31], s49 offen offset:0  lds
    buffer_load_dwordx4 v9, s[28:31], s49 offen offset:1024  lds
    buffer_load_dwordx4 v10, s[28:31], s49 offen offset:2048  lds
    buffer_load_dwordx4 v11, s[28:31], s49 offen offset:3072  lds
    s_add_u32 s49, s49, 128
    s_cmp_ge_u32 s47, 98304
    s_cselect_b32 s47, 0, s47
    s_cmp_ge_u32 s49, 1280
    s_cselect_b32 s49, 0, s49
    s_waitcnt vmcnt(11)
    s_barrier
    s_add_u32 m0, s48, s53
    s_nop 0
    buffer_load_dwordx4 v12, s[32:35], s50 offen  lds
    s_add_u32 m0, s48, s54
    s_nop 0
    buffer_load_dwordx4 v13, s[32:35], s50 offen  lds
    s_add_u32 m0, s48, s55
    s_nop 0
    buffer_load_dwordx4 v14, s[32:35], s50 offen  lds
    s_add_u32 s50, s50, 110592
    s_add_u32 s48, s48, 12352
    s_cmp_ge_u32 s48, 61760
    s_cselect_b32 s48, 0, s48
    s_cmp_ge_u32 s50, 2211840
    s_cselect_b32 s50, 0, s50
    s_add_u32 m0, s48, s53
    s_nop 0
    buffer_load_dwordx4 v12, s[32:35], s50 offen  lds
    s_add_u32 m0, s48, s54
    s_nop 0
    buffer_load_dwordx4 v13, s[32:35], s50 offen  lds
    s_add_u32 m0, s48, s55
    s_nop 0
    buffer_load_dwordx4 v14, s[32:35], s50 offen  lds
    s_add_u32 s50, s50, 110592
    s_add_u32 s48, s48, 12352
    s_cmp_ge_u32 s48, 61760
    s_cselect_b32 s48, 0, s48
    s_cmp_ge_u32 s50, 2211840
    s_cselect_b32 s50, 0, s50
    s_waitcnt vmcnt(14)
    s_barrier
    s_add_u32 m0, s47, s52
    s_nop 0
    buffer_load_dwordx4 v4, s[28:31], s49 offen offset:0  lds
    buffer_load_dwordx4 v5, s[28:31], s49 offen offset:1024  lds
    buffer_load_dwordx4 v6, s[28:31], s49 offen offset:2048  lds
    buffer_load_dwordx4 v7, s[28:31], s49 offen offset:3072  lds
    s_add_u32 m0, m0, 4096
    s_add_u32 s47, s47, 32768
    buffer_load_dwordx4 v8, s[28:31], s49 offen offset:0  lds
    buffer_load_dwordx4 v9, s[28:31], s49 offen offset:1024  lds
    buffer_load_dwordx4 v10, s[28:31], s49 offen offset:2048  lds
    buffer_load_dwordx4 v11, s[28:31], s49 offen offset:3072  lds
    s_add_u32 s49, s49, 128
    s_cmp_ge_u32 s47, 98304
    s_cselect_b32 s47, 0, s47
    s_cmp_ge_u32 s49, 1280
    s_cselect_b32 s49, 0, s49
    s_add_u32 m0, s48, s53
    s_nop 0
    buffer_load_dwordx4 v12, s[32:35], s50 offen  lds
    s_add_u32 m0, s48, s54
    s_nop 0
    buffer_load_dwordx4 v13, s[32:35], s50 offen  lds
    s_add_u32 m0, s48, s55
    s_nop 0
    buffer_load_dwordx4 v14, s[32:35], s50 offen  lds
    s_add_u32 s50, s50, 110592
    s_add_u32 s48, s48, 12352
    s_cmp_ge_u32 s48, 61760
    s_cselect_b32 s48, 0, s48
    s_cmp_ge_u32 s50, 2211840
    s_cselect_b32 s50, 0, s50
    s_waitcnt vmcnt(14)
    s_barrier
    s_add_u32 m0, s48, s53
    s_nop 0
    buffer_load_dwordx4 v12, s[32:35], s50 offen  lds
    s_add_u32 m0, s48, s54
    s_nop 0
    buffer_load_dwordx4 v13, s[32:35], s50 offen  lds
    s_add_u32 m0, s48, s55
    s_nop 0
    buffer_load_dwordx4 v14, s[32:35], s50 offen  lds
    s_add_u32 s50, s50, 110592
    s_add_u32 s48, s48, 12352
    s_cmp_ge_u32 s48, 61760
    s_cselect_b32 s48, 0, s48
    s_cmp_ge_u32 s50, 2211840
    s_cselect_b32 s50, 0, s50
    s_waitcnt vmcnt(14)
    s_barrier
    s_add_u32 m0, s47, s52
    s_nop 0
    buffer_load_dwordx4 v4, s[28:31], s49 offen offset:0  lds
    buffer_load_dwordx4 v5, s[28:31], s49 offen offset:1024  lds
    buffer_load_dwordx4 v6, s[28:31], s49 offen offset:2048  lds
    buffer_load_dwordx4 v7, s[28:31], s49 offen offset:3072  lds
    s_add_u32 m0, m0, 4096
    s_add_u32 s47, s47, 32768
    buffer_load_dwordx4 v8, s[28:31], s49 offen offset:0  lds
    buffer_load_dwordx4 v9, s[28:31], s49 offen offset:1024  lds
    buffer_load_dwordx4 v10, s[28:31], s49 offen offset:2048  lds
    buffer_load_dwordx4 v11, s[28:31], s49 offen offset:3072  lds
    s_add_u32 s49, s49, 128
    s_cmp_ge_u32 s47, 98304
    s_cselect_b32 s47, 0, s47
    s_cmp_ge_u32 s49, 1280
    s_cselect_b32 s49, 0, s49
    s_add_u32 m0, s48, s53
    s_nop 0
    buffer_load_dwordx4 v12, s[32:35], s50 offen  lds
    s_add_u32 m0, s48, s54
    s_nop 0
    buffer_load_dwordx4 v13, s[32:35], s50 offen  lds
    s_add_u32 m0, s48, s55
    s_nop 0
    buffer_load_dwordx4 v14, s[32:35], s50 offen  lds
    s_add_u32 s50, s50, 110592
    s_add_u32 s48, s48, 12352
    s_cmp_ge_u32 s48, 61760
    s_cselect_b32 s48, 0, s48
    s_cmp_ge_u32 s50, 2211840
    s_cselect_b32 s50, 0, s50
    s_waitcnt vmcnt(14)
    s_barrier
    s_add_u32 m0, s48, s53
    s_nop 0
    buffer_load_dwordx4 v12, s[32:35], s50 offen  lds
    s_add_u32 m0, s48, s54
    s_nop 0
    buffer_load_dwordx4 v13, s[32:35], s50 offen  lds
    s_add_u32 m0, s48, s55
    s_nop 0
    buffer_load_dwordx4 v14, s[32:35], s50 offen  lds
    s_add_u32 s50, s50, 110592
    s_add_u32 s48, s48, 12352
    s_cmp_ge_u32 s48, 61760
    s_cselect_b32 s48, 0, s48
    s_cmp_ge_u32 s50, 2211840
    s_cselect_b32 s50, 0, s50
    s_waitcnt vmcnt(14)
    s_barrier
    s_add_u32 m0, s47, s52
    s_nop 0
    buffer_load_dwordx4 v4, s[28:31], s49 offen offset:0  lds
    buffer_load_dwordx4 v5, s[28:31], s49 offen offset:1024  lds
    buffer_load_dwordx4 v6, s[28:31], s49 offen offset:2048  lds
    buffer_load_dwordx4 v7, s[28:31], s49 offen offset:3072  lds
    s_add_u32 m0, m0, 4096
    s_add_u32 s47, s47, 32768
    buffer_load_dwordx4 v8, s[28:31], s49 offen offset:0  lds
    buffer_load_dwordx4 v9, s[28:31], s49 offen offset:1024  lds
    buffer_load_dwordx4 v10, s[28:31], s49 offen offset:2048  lds
    buffer_load_dwordx4 v11, s[28:31], s49 offen offset:3072  lds
    s_add_u32 s49, s49, 128
    s_cmp_ge_u32 s47, 98304
    s_cselect_b32 s47, 0, s47
    s_cmp_ge_u32 s49, 1280
    s_cselect_b32 s49, 0, s49
    s_add_u32 m0, s48, s53
    s_nop 0
    buffer_load_dwordx4 v12, s[32:35], s50 offen  lds
    s_add_u32 m0, s48, s54
    s_nop 0
    buffer_load_dwordx4 v13, s[32:35], s50 offen  lds
    s_add_u32 m0, s48, s55
    s_nop 0
    buffer_load_dwordx4 v14, s[32:35], s50 offen  lds
    s_add_u32 s50, s50, 110592
    s_add_u32 s48, s48, 12352
    s_cmp_ge_u32 s48, 61760
    s_cselect_b32 s48, 0, s48
    s_cmp_ge_u32 s50, 2211840
    s_cselect_b32 s50, 0, s50
    s_waitcnt vmcnt(14)
    s_barrier
    s_add_u32 m0, s48, s53
    s_nop 0
    buffer_load_dwordx4 v12, s[32:35], s50 offen  lds
    s_add_u32 m0, s48, s54
    s_nop 0
    buffer_load_dwordx4 v13, s[32:35], s50 offen  lds
    s_add_u32 m0, s48, s55
    s_nop 0
    buffer_load_dwordx4 v14, s[32:35], s50 offen  lds
    s_add_u32 s50, s50, 110592
    s_add_u32 s48, s48, 12352
    s_cmp_ge_u32 s48, 61760
    s_cselect_b32 s48, 0, s48
    s_cmp_ge_u32 s50, 2211840
    s_cselect_b32 s50, 0, s50
    s_waitcnt vmcnt(14)
    s_barrier
    s_add_u32 m0, s47, s52
    s_nop 0
    buffer_load_dwordx4 v4, s[28:31], s49 offen offset:0  lds
    buffer_load_dwordx4 v5, s[28:31], s49 offen offset:1024  lds
    buffer_load_dwordx4 v6, s[28:31], s49 offen offset:2048  lds
    buffer_load_dwordx4 v7, s[28:31], s49 offen offset:3072  lds
    s_add_u32 m0, m0, 4096
    s_add_u32 s47, s47, 32768
    buffer_load_dwordx4 v8, s[28:31], s49 offen offset:0  lds
    buffer_load_dwordx4 v9, s[28:31], s49 offen offset:1024  lds
    buffer_load_dwordx4 v10, s[28:31], s49 offen offset:2048  lds
    buffer_load_dwordx4 v11, s[28:31], s49 offen offset:3072  lds
    s_add_u32 s49, s49, 128
    s_cmp_ge_u32 s47, 98304
    s_cselect_b32 s47, 0, s47
    s_cmp_ge_u32 s49, 1280
    s_cselect_b32 s49, 0, s49
    s_add_u32 m0, s48, s53
    s_nop 0
    buffer_load_dwordx4 v12, s[32:35], s50 offen  lds
    s_add_u32 m0, s48, s54
    s_nop 0
    buffer_load_dwordx4 v13, s[32:35], s50 offen  lds
    s_add_u32 m0, s48, s55
    s_nop 0
    buffer_load_dwordx4 v14, s[32:35], s50 offen  lds
    s_add_u32 s50, s50, 110592
    s_add_u32 s48, s48, 12352
    s_cmp_ge_u32 s48, 61760
    s_cselect_b32 s48, 0, s48
    s_cmp_ge_u32 s50, 2211840
    s_cselect_b32 s50, 0, s50
    s_waitcnt vmcnt(14)
    s_barrier
    s_add_u32 m0, s48, s53
    s_nop 0
    buffer_load_dwordx4 v12, s[32:35], s50 offen  lds
    s_add_u32 m0, s48, s54
    s_nop 0
    buffer_load_dwordx4 v13, s[32:35], s50 offen  lds
    s_add_u32 m0, s48, s55
    s_nop 0
    buffer_load_dwordx4 v14, s[32:35], s50 offen  lds
    s_add_u32 s50, s50, 110592
    s_add_u32 s48, s48, 12352
    s_cmp_ge_u32 s48, 61760
    s_cselect_b32 s48, 0, s48
    s_cmp_ge_u32 s50, 2211840
    s_cselect_b32 s50, 0, s50
    s_waitcnt vmcnt(14)
    s_barrier
    s_add_u32 m0, s47, s52
    s_nop 0
    buffer_load_dwordx4 v4, s[28:31], s49 offen offset:0  lds
    buffer_load_dwordx4 v5, s[28:31], s49 offen offset:1024  lds
    buffer_load_dwordx4 v6, s[28:31], s49 offen offset:2048  lds
    buffer_load_dwordx4 v7, s[28:31], s49 offen offset:3072  lds
    s_add_u32 m0, m0, 4096
    s_add_u32 s47, s47, 32768
    buffer_load_dwordx4 v8, s[28:31], s49 offen offset:0  lds
    buffer_load_dwordx4 v9, s[28:31], s49 offen offset:1024  lds
    buffer_load_dwordx4 v10, s[28:31], s49 offen offset:2048  lds
    buffer_load_dwordx4 v11, s[28:31], s49 offen offset:3072  lds
    s_add_u32 s49, s49, 128
    s_cmp_ge_u32 s47, 98304
    s_cselect_b32 s47, 0, s47
    s_cmp_ge_u32 s49, 1280
    s_cselect_b32 s49, 0, s49
    s_add_u32 m0, s48, s53
    s_nop 0
    buffer_load_dwordx4 v12, s[32:35], s50 offen  lds
    s_add_u32 m0, s48, s54
    s_nop 0
    buffer_load_dwordx4 v13, s[32:35], s50 offen  lds
    s_add_u32 m0, s48, s55
    s_nop 0
    buffer_load_dwordx4 v14, s[32:35], s50 offen  lds
    s_add_u32 s50, s50, 110592
    s_add_u32 s48, s48, 12352
    s_cmp_ge_u32 s48, 61760
    s_cselect_b32 s48, 0, s48
    s_cmp_ge_u32 s50, 2211840
    s_cselect_b32 s50, 0, s50
    s_waitcnt vmcnt(14)
    s_barrier
    s_add_u32 m0, s48, s53
    s_nop 0
    buffer_load_dwordx4 v12, s[32:35], s50 offen  lds
    s_add_u32 m0, s48, s54
    s_nop 0
    buffer_load_dwordx4 v13, s[32:35], s50 offen  lds
    s_add_u32 m0, s48, s55
    s_nop 0
    buffer_load_dwordx4 v14, s[32:35], s50 offen  lds
    s_add_u32 s50, s50, 110592
    s_add_u32 s48, s48, 12352
    s_cmp_ge_u32 s48, 61760
    s_cselect_b32 s48, 0, s48
    s_cmp_ge_u32 s50, 2211840
    s_cselect_b32 s50, 0, s50
    s_waitcnt vmcnt(14)
    s_barrier
    s_add_u32 m0, s47, s52
    s_nop 0
    buffer_load_dwordx4 v4, s[28:31], s49 offen offset:0  lds
    buffer_load_dwordx4 v5, s[28:31], s49 offen offset:1024  lds
    buffer_load_dwordx4 v6, s[28:31], s49 offen offset:2048  lds
    buffer_load_dwordx4 v7, s[28:31], s49 offen offset:3072  lds
    s_add_u32 m0, m0, 4096
    s_add_u32 s47, s47, 32768
    buffer_load_dwordx4 v8, s[28:31], s49 offen offset:0  lds
    buffer_load_dwordx4 v9, s[28:31], s49 offen offset:1024  lds
    buffer_load_dwordx4 v10, s[28:31], s49 offen offset:2048  lds
    buffer_load_dwordx4 v11, s[28:31], s49 offen offset:3072  lds
    s_add_u32 s49, s49, 128
    s_cmp_ge_u32 s47, 98304
    s_cselect_b32 s47, 0, s47
    s_cmp_ge_u32 s49, 1280
    s_cselect_b32 s49, 0, s49
    s_add_u32 m0, s48, s53
    s_nop 0
    buffer_load_dwordx4 v12, s[32:35], s50 offen  lds
    s_add_u32 m0, s48, s54
    s_nop 0
    buffer_load_dwordx4 v13, s[32:35], s50 offen  lds
    s_add_u32 m0, s48, s55
    s_nop 0
    buffer_load_dwordx4 v14, s[32:35], s50 offen  lds
    s_add_u32 s50, s50, 110592
    s_add_u32 s48, s48, 12352
    s_cmp_ge_u32 s48, 61760
    s_cselect_b32 s48, 0, s48
    s_cmp_ge_u32 s50, 2211840
    s_cselect_b32 s50, 0, s50
    s_waitcnt vmcnt(14)
    s_barrier
    s_add_u32 m0, s48, s53
    s_nop 0
    buffer_load_dwordx4 v12, s[32:35], s50 offen  lds
    s_add_u32 m0, s48, s54
    s_nop 0
    buffer_load_dwordx4 v13, s[32:35], s50 offen  lds
    s_add_u32 m0, s48, s55
    s_nop 0
    buffer_load_dwordx4 v14, s[32:35], s50 offen  lds
    s_add_u32 s50, s50, 110592
    s_add_u32 s48, s48, 12352
    s_cmp_ge_u32 s48, 61760
    s_cselect_b32 s48, 0, s48
    s_cmp_ge_u32 s50, 2211840
    s_cselect_b32 s50, 0, s50
    s_waitcnt vmcnt(14)
    s_barrier
    s_add_u32 m0, s47, s52
    s_nop 0
    buffer_load_dwordx4 v4, s[28:31], s49 offen offset:0  lds
    buffer_load_dwordx4 v5, s[28:31], s49 offen offset:1024  lds
    buffer_load_dwordx4 v6, s[28:31], s49 offen offset:2048  lds
    buffer_load_dwordx4 v7, s[28:31], s49 offen offset:3072  lds
    s_add_u32 m0, m0, 4096
    s_add_u32 s47, s47, 32768
    buffer_load_dwordx4 v8, s[28:31], s49 offen offset:0  lds
    buffer_load_dwordx4 v9, s[28:31], s49 offen offset:1024  lds
    buffer_load_dwordx4 v10, s[28:31], s49 offen offset:2048  lds
    buffer_load_dwordx4 v11, s[28:31], s49 offen offset:3072  lds
    s_add_u32 s49, s49, 128
    s_cmp_ge_u32 s47, 98304
    s_cselect_b32 s47, 0, s47
    s_cmp_ge_u32 s49, 1280
    s_cselect_b32 s49, 0, s49
    s_add_u32 m0, s48, s53
    s_nop 0
    buffer_load_dwordx4 v12, s[32:35], s50 offen  lds
    s_add_u32 m0, s48, s54
    s_nop 0
    buffer_load_dwordx4 v13, s[32:35], s50 offen  lds
    s_add_u32 m0, s48, s55
    s_nop 0
    buffer_load_dwordx4 v14, s[32:35], s50 offen  lds
    s_add_u32 s50, s50, 110592
    s_add_u32 s48, s48, 12352
    s_cmp_ge_u32 s48, 61760
    s_cselect_b32 s48, 0, s48
    s_cmp_ge_u32 s50, 2211840
    s_cselect_b32 s50, 0, s50
    s_waitcnt vmcnt(14)
    s_barrier
    s_add_u32 m0, s48, s53
    s_nop 0
    buffer_load_dwordx4 v12, s[32:35], s50 offen  lds
    s_add_u32 m0, s48, s54
    s_nop 0
    buffer_load_dwordx4 v13, s[32:35], s50 offen  lds
    s_add_u32 m0, s48, s55
    s_nop 0
    buffer_load_dwordx4 v14, s[32:35], s50 offen  lds
    s_add_u32 s50, s50, 110592
    s_add_u32 s48, s48, 12352
    s_cmp_ge_u32 s48, 61760
    s_cselect_b32 s48, 0, s48
    s_cmp_ge_u32 s50, 2211840
    s_cselect_b32 s50, 0, s50
    s_waitcnt vmcnt(14)
    s_barrier
    s_add_u32 m0, s47, s52
    s_nop 0
    buffer_load_dwordx4 v4, s[28:31], s49 offen offset:0  lds
    buffer_load_dwordx4 v5, s[28:31], s49 offen offset:1024  lds
    buffer_load_dwordx4 v6, s[28:31], s49 offen offset:2048  lds
    buffer_load_dwordx4 v7, s[28:31], s49 offen offset:3072  lds
    s_add_u32 m0, m0, 4096
    s_add_u32 s47, s47, 32768
    buffer_load_dwordx4 v8, s[28:31], s49 offen offset:0  lds
    buffer_load_dwordx4 v9, s[28:31], s49 offen offset:1024  lds
    buffer_load_dwordx4 v10, s[28:31], s49 offen offset:2048  lds
    buffer_load_dwordx4 v11, s[28:31], s49 offen offset:3072  lds
    s_add_u32 s49, s49, 128
    s_cmp_ge_u32 s47, 98304
    s_cselect_b32 s47, 0, s47
    s_cmp_ge_u32 s49, 1280
    s_cselect_b32 s49, 0, s49
    s_add_u32 m0, s48, s53
    s_nop 0
    buffer_load_dwordx4 v12, s[32:35], s50 offen  lds
    s_add_u32 m0, s48, s54
    s_nop 0
    buffer_load_dwordx4 v13, s[32:35], s50 offen  lds
    s_add_u32 m0, s48, s55
    s_nop 0
    buffer_load_dwordx4 v14, s[32:35], s50 offen  lds
    s_add_u32 s50, s50, 110592
    s_add_u32 s48, s48, 12352
    s_cmp_ge_u32 s48, 61760
    s_cselect_b32 s48, 0, s48
    s_cmp_ge_u32 s50, 2211840
    s_cselect_b32 s50, 0, s50
    s_waitcnt vmcnt(14)
    s_barrier
    s_add_u32 m0, s48, s53
    s_nop 0
    buffer_load_dwordx4 v12, s[32:35], s50 offen  lds
    s_add_u32 m0, s48, s54
    s_nop 0
    buffer_load_dwordx4 v13, s[32:35], s50 offen  lds
    s_add_u32 m0, s48, s55
    s_nop 0
    buffer_load_dwordx4 v14, s[32:35], s50 offen  lds
    s_add_u32 s50, s50, 110592
    s_add_u32 s48, s48, 12352
    s_cmp_ge_u32 s48, 61760
    s_cselect_b32 s48, 0, s48
    s_cmp_ge_u32 s50, 2211840
    s_cselect_b32 s50, 0, s50
    s_waitcnt vmcnt(14)
    s_barrier
    s_waitcnt vmcnt(3)
    s_barrier
    s_waitcnt vmcnt(0)
    s_barrier
    s_barrier
    s_setprio 3
    s_add_u32 s54, s44, 8
    s_mov_b32 s47, 0
    s_branch after_p1
p1_fc:
    v_and_b32 v2, 31, v1
    v_lshrrev_b32 v3, 5, v1
    s_lshl_b32 s60, s3, 6
    v_add_u32 v10, s60, v2
    v_lshrrev_b32 v11, 1, v10
    v_and_b32 v11, 7, v11
    v_xor_b32 v11, v11, v3
    v_lshlrev_b32 v11, 4, v11
    v_lshlrev_b32 v10, 7, v10
    v_add_u32 v4, v10, v11
    v_xor_b32 v5, 32, v4
    v_xor_b32 v6, 64, v4
    v_xor_b32 v7, 96, v4
    v_lshrrev_b32 v10, 4, v1
    v_and_b32 v11, 15, v1
    v_lshrrev_b32 v12, 2, v11
    v_and_b32 v13, 3, v11
    v_and_b32 v14, 1, v10
    v_lshrrev_b32 v10, 1, v10
    v_lshlrev_b32 v10, 3, v10
    v_add_u32 v10, v10, v12
    s_waitcnt lgkmcnt(0)
    v_mul_u32_u24 v10, 192, v10
    v_mul_u32_u24 v14, 6176, v14
    v_and_b32 v11, 1, v13
    v_lshlrev_b32 v11, 1, v11
    v_lshrrev_b32 v13, 1, v13
    v_or_b32 v11, v11, v13
    v_lshlrev_b32 v11, 3, v11
    v_add3_u32 v10, v10, v14, v11
    v_add_u32 v8, 98304, v10
    s_mov_b32 s62, 12352
    s_mov_b32 s63, 32768
    s_mov_b32 s50, 0
    s_mov_b32 s51, 0
    v_mov_b32 v64, 0
    v_mov_b32 v65, 0
    v_mov_b32 v66, 0
    v_mov_b32 v67, 0
    v_mov_b32 v68, 0
    v_mov_b32 v69, 0
    v_mov_b32 v70, 0
    v_mov_b32 v71, 0
    v_mov_b32 v72, 0
    v_mov_b32 v73, 0
    v_mov_b32 v74, 0
    v_mov_b32 v75, 0
    v_mov_b32 v76, 0
    v_mov_b32 v77, 0
    v_mov_b32 v78, 0
    v_mov_b32 v79, 0
    v_mov_b32 v80, 0
    v_mov_b32 v81, 0
    v_mov_b32 v82, 0
    v_mov_b32 v83, 0
    v_mov_b32 v84, 0
    v_mov_b32 v85, 0
    v_mov_b32 v86, 0
    v_mov_b32 v87, 0
    v_mov_b32 v88, 0
    v_mov_b32 v89, 0
    v_mov_b32 v90, 0
    v_mov_b32 v91, 0
    v_mov_b32 v92, 0
    v_mov_b32 v93, 0
    v_mov_b32 v94, 0
    v_mov_b32 v95, 0
    v_mov_b32 v96, 0
    v_mov_b32 v97, 0
    v_mov_b32 v98, 0
    v_mov_b32 v99, 0
    v_mov_b32 v100, 0
    v_mov_b32 v101, 0
    v_mov_b32 v102, 0
    v_mov_b32 v103, 0
    v_mov_b32 v104, 0
    v_mov_b32 v105, 0
    v_mov_b32 v106, 0
    v_mov_b32 v107, 0
    v_mov_b32 v108, 0
    v_mov_b32 v109, 0
    v_mov_b32 v110, 0
    v_mov_b32 v111, 0
    v_mov_b32 v112, 0
    v_mov_b32 v113, 0
    v_mov_b32 v114, 0
    v_mov_b32 v115, 0
    v_mov_b32 v116, 0
    v_mov_b32 v117, 0
    v_mov_b32 v118, 0
    v_mov_b32 v119, 0
    v_mov_b32 v120, 0
    v_mov_b32 v121, 0
    v_mov_b32 v122, 0
    v_mov_b32 v123, 0
    v_mov_b32 v124, 0
    v_mov_b32 v125, 0
    v_mov_b32 v126, 0
    v_mov_b32 v127, 0
    v_mov_b32 v128, 0
    v_mov_b32 v129, 0
    v_mov_b32 v130, 0
    v_mov_b32 v131, 0
    v_mov_b32 v132, 0
    v_mov_b32 v133, 0
    v_mov_b32 v134, 0
    v_mov_b32 v135, 0
    v_mov_b32 v136, 0
    v_mov_b32 v137, 0
    v_mov_b32 v138, 0
    v_mov_b32 v139, 0
    v_mov_b32 v140, 0
    v_mov_b32 v141, 0
    v_mov_b32 v142, 0
    v_mov_b32 v143, 0
    v_mov_b32 v144, 0
    v_mov_b32 v145, 0
    v_mov_b32 v146, 0
    v_mov_b32 v147, 0
    v_mov_b32 v148, 0
    v_mov_b32 v149, 0
    v_mov_b32 v150, 0
    v_mov_b32 v151, 0
    v_mov_b32 v152, 0
    v_mov_b32 v153, 0
    v_mov_b32 v154, 0
    v_mov_b32 v155, 0
    v_mov_b32 v156, 0
    v_mov_b32 v157, 0
    v_mov_b32 v158, 0
    v_mov_b32 v159, 0
    v_mov_b32 v160, 0
    v_mov_b32 v161, 0
    v_mov_b32 v162, 0
    v_mov_b32 v163, 0
    v_mov_b32 v164, 0
    v_mov_b32 v165, 0
    v_mov_b32 v166, 0
    v_mov_b32 v167, 0
    v_mov_b32 v168, 0
    v_mov_b32 v169, 0
    v_mov_b32 v170, 0
    v_mov_b32 v171, 0
    v_mov_b32 v172, 0
    v_mov_b32 v173, 0
    v_mov_b32 v174, 0
    v_mov_b32 v175, 0
    v_mov_b32 v176, 0
    v_mov_b32 v177, 0
    v_mov_b32 v178, 0
    v_mov_b32 v179, 0
    v_mov_b32 v180, 0
    v_mov_b32 v181, 0
    v_mov_b32 v182, 0
    v_mov_b32 v183, 0
    v_mov_b32 v184, 0
    v_mov_b32 v185, 0
    v_mov_b32 v186, 0
    v_mov_b32 v187, 0
    v_mov_b32 v188, 0
    v_mov_b32 v189, 0
    v_mov_b32 v190, 0
    v_mov_b32 v191, 0
    v_mov_b32 v192, 0
    v_mov_b32 v193, 0
    v_mov_b32 v194, 0
    v_mov_b32 v195, 0
    v_mov_b32 v196, 0
    v_mov_b32 v197, 0
    v_mov_b32 v198, 0
    v_mov_b32 v199, 0
    v_mov_b32 v200, 0
    v_mov_b32 v201, 0
    v_mov_b32 v202, 0
    v_mov_b32 v203, 0
    v_mov_b32 v204, 0
    v_mov_b32 v205, 0
    v_mov_b32 v206, 0
    v_mov_b32 v207, 0
    v_mov_b32 v208, 0
    v_mov_b32 v209, 0
    v_mov_b32 v210, 0
    v_mov_b32 v211, 0
    v_mov_b32 v212, 0
    v_mov_b32 v213, 0
    v_mov_b32 v214, 0
    v_mov_b32 v215, 0
    v_mov_b32 v216, 0
    v_mov_b32 v217, 0
    v_mov_b32 v218, 0
    v_mov_b32 v219, 0
    v_mov_b32 v220, 0
    v_mov_b32 v221, 0
    v_mov_b32 v222, 0
    v_mov_b32 v223, 0
    v_mov_b32 v224, 0
    v_mov_b32 v225, 0
    v_mov_b32 v226, 0
    v_mov_b32 v227, 0
    v_mov_b32 v228, 0
    v_mov_b32 v229, 0
    v_mov_b32 v230, 0
    v_mov_b32 v231, 0
    v_mov_b32 v232, 0
    v_mov_b32 v233, 0
    v_mov_b32 v234, 0
    v_mov_b32 v235, 0
    v_mov_b32 v236, 0
    v_mov_b32 v237, 0
    v_mov_b32 v238, 0
    v_mov_b32 v239, 0
    v_mov_b32 v240, 0
    v_mov_b32 v241, 0
    v_mov_b32 v242, 0
    v_mov_b32 v243, 0
    v_mov_b32 v244, 0
    v_mov_b32 v245, 0
    v_mov_b32 v246, 0
    v_mov_b32 v247, 0
    v_mov_b32 v248, 0
    v_mov_b32 v249, 0
    v_mov_b32 v250, 0
    v_mov_b32 v251, 0
    v_mov_b32 v252, 0
    v_mov_b32 v253, 0
    v_mov_b32 v254, 0
    v_mov_b32 v255, 0
    s_barrier
    ds_read_b128 v[24:27], v4 offset:0
    ds_read_b128 v[28:31], v4 offset:4096
    ds_read_b64_tr_b16 v[40:41], v8 offset:0
    ds_read_b64_tr_b16 v[42:43], v8 offset:768
    ds_read_b64_tr_b16 v[44:45], v8 offset:32
    ds_read_b64_tr_b16 v[46:47], v8 offset:800
    ds_read_b64_tr_b16 v[48:49], v8 offset:64
    ds_read_b64_tr_b16 v[50:51], v8 offset:832
    ds_read_b64_tr_b16 v[52:53], v8 offset:96
    ds_read_b64_tr_b16 v[54:55], v8 offset:864
    ds_read_b64_tr_b16 v[56:57], v8 offset:128
    ds_read_b64_tr_b16 v[58:59], v8 offset:896
    ds_read_b64_tr_b16 v[60:61], v8 offset:160
    ds_read_b64_tr_b16 v[62:63], v8 offset:928
    s_waitcnt lgkmcnt(10)
    v_mfma_f32_32x32x16_bf16 v[64:79], v[40:43], v[24:27], v[64:79]
    v_mfma_f32_32x32x16_bf16 v[80:95], v[40:43], v[28:31], v[80:95]
    ds_read_b64_tr_b16 v[40:41], v8 offset:3072
    s_waitcnt lgkmcnt(9)
    v_mfma_f32_32x32x16_bf16 v[96:111], v[44:47], v[24:27], v[96:111]
    ds_read_b64_tr_b16 v[42:43], v8 offset:3840
    v_mfma_f32_32x32x16_bf16 v[112:127], v[44:47], v[28:31], v[112:127]
    ds_read_b64_tr_b16 v[44:45], v8 offset:3104
    s_waitcnt lgkmcnt(9)
    v_mfma_f32_32x32x16_bf16 v[128:143], v[48:51], v[24:27], v[128:143]
    ds_read_b64_tr_b16 v[46:47], v8 offset:3872
    ds_read_b128 v[32:35], v5 offset:0
    v_mfma_f32_32x32x16_bf16 v[144:159], v[48:51], v[28:31], v[144:159]
    ds_read_b64_tr_b16 v[48:49], v8 offset:3136
    ds_read_b128 v[36:39], v5 offset:4096
    s_waitcnt lgkmcnt(11)
    v_mfma_f32_32x32x16_bf16 v[160:175], v[52:55], v[24:27], v[160:175]
    ds_read_b64_tr_b16 v[50:51], v8 offset:3904
    v_mfma_f32_32x32x16_bf16 v[176:191], v[52:55], v[28:31], v[176:191]
    ds_read_b64_tr_b16 v[52:53], v8 offset:3168
    s_waitcnt lgkmcnt(11)
    v_mfma_f32_32x32x16_bf16 v[192:207], v[56:59], v[24:27], v[192:207]
    ds_read_b64_tr_b16 v[54:55], v8 offset:3936
    v_mfma_f32_32x32x16_bf16 v[208:223], v[56:59], v[28:31], v[208:223]
    ds_read_b64_tr_b16 v[56:57], v8 offset:3200
    s_waitcnt lgkmcnt(11)
    v_mfma_f32_32x32x16_bf16 v[224:239], v[60:63], v[24:27], v[224:239]
    ds_read_b64_tr_b16 v[58:59], v8 offset:3968
    v_mfma_f32_32x32x16_bf16 v[240:255], v[60:63], v[28:31], v[240:255]
    ds_read_b64_tr_b16 v[60:61], v8 offset:3232
    s_waitcnt lgkmcnt(6)
    v_mfma_f32_32x32x16_bf16 v[64:79], v[40:43], v[32:35], v[64:79]
    ds_read_b64_tr_b16 v[62:63], v8 offset:4000
    v_mfma_f32_32x32x16_bf16 v[80:95], v[40:43], v[36:39], v[80:95]
    s_barrier
    s_add_u32 s50, s50, 12352
    s_cmp_ge_u32 s50, 61760
    s_cselect_b32 s47, 4294917888, s62
    s_cselect_b32 s50, 0, s50
    v_add_u32 v8, s47, v8
    ds_read_b64_tr_b16 v[40:41], v8 offset:0
    s_waitcnt lgkmcnt(8)
    v_mfma_f32_32x32x16_bf16 v[96:111], v[44:47], v[32:35], v[96:111]
    ds_read_b64_tr_b16 v[42:43], v8 offset:768
    v_mfma_f32_32x32x16_bf16 v[112:127], v[44:47], v[36:39], v[112:127]
    ds_read_b64_tr_b16 v[44:45], v8 offset:32
    s_waitcnt lgkmcnt(9)
    v_mfma_f32_32x32x16_bf16 v[128:143], v[48:51], v[32:35], v[128:143]
    ds_read_b64_tr_b16 v[46:47], v8 offset:800
    ds_read_b128 v[24:27], v6 offset:0
    v_mfma_f32_32x32x16_bf16 v[144:159], v[48:51], v[36:39], v[144:159]
    ds_read_b64_tr_b16 v[48:49], v8 offset:64
    ds_read_b128 v[28:31], v6 offset:4096
    s_waitcnt lgkmcnt(11)
    v_mfma_f32_32x32x16_bf16 v[160:175], v[52:55], v[32:35], v[160:175]
    ds_read_b64_tr_b16 v[50:51], v8 offset:832
    v_mfma_f32_32x32x16_bf16 v[176:191], v[52:55], v[36:39], v[176:191]
    ds_read_b64_tr_b16 v[52:53], v8 offset:96
    s_waitcnt lgkmcnt(11)
    v_mfma_f32_32x32x16_bf16 v[192:207], v[56:59], v[32:35], v[192:207]
    ds_read_b64_tr_b16 v[54:55], v8 offset:864
    v_mfma_f32_32x32x16_bf16 v[208:223], v[56:59], v[36:39], v[208:223]
    ds_read_b64_tr_b16 v[56:57], v8 offset:128
    s_waitcnt lgkmcnt(11)
    v_mfma_f32_32x32x16_bf16 v[224:239], v[60:63], v[32:35], v[224:239]
    ds_read_b64_tr_b16 v[58:59], v8 offset:896
    v_mfma_f32_32x32x16_bf16 v[240:255], v[60:63], v[36:39], v[240:255]
    ds_read_b64_tr_b16 v[60:61], v8 offset:160
    s_waitcnt lgkmcnt(6)
    v_mfma_f32_32x32x16_bf16 v[64:79], v[40:43], v[24:27], v[64:79]
    ds_read_b64_tr_b16 v[62:63], v8 offset:928
    v_mfma_f32_32x32x16_bf16 v[80:95], v[40:43], v[28:31], v[80:95]
    ds_read_b64_tr_b16 v[40:41], v8 offset:3072
    s_waitcnt lgkmcnt(8)
    v_mfma_f32_32x32x16_bf16 v[96:111], v[44:47], v[24:27], v[96:111]
    ds_read_b64_tr_b16 v[42:43], v8 offset:3840
    v_mfma_f32_32x32x16_bf16 v[112:127], v[44:47], v[28:31], v[112:127]
    ds_read_b64_tr_b16 v[44:45], v8 offset:3104
    s_waitcnt lgkmcnt(9)
    v_mfma_f32_32x32x16_bf16 v[128:143], v[48:51], v[24:27], v[128:143]
    ds_read_b64_tr_b16 v[46:47], v8 offset:3872
    ds_read_b128 v[32:35], v7 offset:0
    v_mfma_f32_32x32x16_bf16 v[144:159], v[48:51], v[28:31], v[144:159]
    ds_read_b64_tr_b16 v[48:49], v8 offset:3136
    ds_read_b128 v[36:39], v7 offset:4096
    s_waitcnt lgkmcnt(11)
    v_mfma_f32_32x32x16_bf16 v[160:175], v[52:55], v[24:27], v[160:175]
    ds_read_b64_tr_b16 v[50:51], v8 offset:3904
    v_mfma_f32_32x32x16_bf16 v[176:191], v[52:55], v[28:31], v[176:191]
    ds_read_b64_tr_b16 v[52:53], v8 offset:3168
    s_waitcnt lgkmcnt(11)
    v_mfma_f32_32x32x16_bf16 v[192:207], v[56:59], v[24:27], v[192:207]
    ds_read_b64_tr_b16 v[54:55], v8 offset:3936
    v_mfma_f32_32x32x16_bf16 v[208:223], v[56:59], v[28:31], v[208:223]
    ds_read_b64_tr_b16 v[56:57], v8 offset:3200
    s_waitcnt lgkmcnt(11)
    v_mfma_f32_32x32x16_bf16 v[224:239], v[60:63], v[24:27], v[224:239]
    ds_read_b64_tr_b16 v[58:59], v8 offset:3968
    v_mfma_f32_32x32x16_bf16 v[240:255], v[60:63], v[28:31], v[240:255]
    ds_read_b64_tr_b16 v[60:61], v8 offset:3232
    s_waitcnt lgkmcnt(6)
    v_mfma_f32_32x32x16_bf16 v[64:79], v[40:43], v[32:35], v[64:79]
    ds_read_b64_tr_b16 v[62:63], v8 offset:4000
    v_mfma_f32_32x32x16_bf16 v[80:95], v[40:43], v[36:39], v[80:95]
    s_barrier
    s_add_u32 s50, s50, 12352
    s_cmp_ge_u32 s50, 61760
    s_cselect_b32 s47, 4294917888, s62
    s_cselect_b32 s50, 0, s50
    v_add_u32 v8, s47, v8
    s_add_u32 s51, s51, 32768
    s_cmp_ge_u32 s51, 98304
    s_cselect_b32 s48, 4294901760, s63
    s_cselect_b32 s51, 0, s51
    v_add_u32 v4, s48, v4
    v_add_u32 v5, s48, v5
    v_add_u32 v6, s48, v6
    v_add_u32 v7, s48, v7
    ds_read_b64_tr_b16 v[40:41], v8 offset:0
    s_waitcnt lgkmcnt(8)
    v_mfma_f32_32x32x16_bf16 v[96:111], v[44:47], v[32:35], v[96:111]
    ds_read_b64_tr_b16 v[42:43], v8 offset:768
    v_mfma_f32_32x32x16_bf16 v[112:127], v[44:47], v[36:39], v[112:127]
    ds_read_b64_tr_b16 v[44:45], v8 offset:32
    s_waitcnt lgkmcnt(9)
    v_mfma_f32_32x32x16_bf16 v[128:143], v[48:51], v[32:35], v[128:143]
    ds_read_b64_tr_b16 v[46:47], v8 offset:800
    ds_read_b128 v[24:27], v4 offset:0
    v_mfma_f32_32x32x16_bf16 v[144:159], v[48:51], v[36:39], v[144:159]
    ds_read_b64_tr_b16 v[48:49], v8 offset:64
    ds_read_b128 v[28:31], v4 offset:4096
    s_waitcnt lgkmcnt(11)
    v_mfma_f32_32x32x16_bf16 v[160:175], v[52:55], v[32:35], v[160:175]
    ds_read_b64_tr_b16 v[50:51], v8 offset:832
    v_mfma_f32_32x32x16_bf16 v[176:191], v[52:55], v[36:39], v[176:191]
    ds_read_b64_tr_b16 v[52:53], v8 offset:96
    s_waitcnt lgkmcnt(11)
    v_mfma_f32_32x32x16_bf16 v[192:207], v[56:59], v[32:35], v[192:207]
    ds_read_b64_tr_b16 v[54:55], v8 offset:864
    v_mfma_f32_32x32x16_bf16 v[208:223], v[56:59], v[36:39], v[208:223]
    ds_read_b64_tr_b16 v[56:57], v8 offset:128
    s_waitcnt lgkmcnt(11)
    v_mfma_f32_32x32x16_bf16 v[224:239], v[60:63], v[32:35], v[224:239]
    ds_read_b64_tr_b16 v[58:59], v8 offset:896
    v_mfma_f32_32x32x16_bf16 v[240:255], v[60:63], v[36:39], v[240:255]
    ds_read_b64_tr_b16 v[60:61], v8 offset:160
    s_mov_b32 s49, 8
p1c_24:
    s_waitcnt lgkmcnt(6)
    v_mfma_f32_32x32x16_bf16 v[64:79], v[40:43], v[24:27], v[64:79]
    ds_read_b64_tr_b16 v[62:63], v8 offset:928
    v_mfma_f32_32x32x16_bf16 v[80:95], v[40:43], v[28:31], v[80:95]
    ds_read_b64_tr_b16 v[40:41], v8 offset:3072
    s_waitcnt lgkmcnt(8)
    v_mfma_f32_32x32x16_bf16 v[96:111], v[44:47], v[24:27], v[96:111]
    ds_read_b64_tr_b16 v[42:43], v8 offset:3840
    v_mfma_f32_32x32x16_bf16 v[112:127], v[44:47], v[28:31], v[112:127]
    ds_read_b64_tr_b16 v[44:45], v8 offset:3104
    s_waitcnt lgkmcnt(9)
    v_mfma_f32_32x32x16_bf16 v[128:143], v[48:51], v[24:27], v[128:143]
    ds_read_b64_tr_b16 v[46:47], v8 offset:3872
    ds_read_b128 v[32:35], v5 offset:0
    v_mfma_f32_32x32x16_bf16 v[144:159], v[48:51], v[28:31], v[144:159]
    ds_read_b64_tr_b16 v[48:49], v8 offset:3136
    ds_read_b128 v[36:39], v5 offset:4096
    s_waitcnt lgkmcnt(11)
    v_mfma_f32_32x32x16_bf16 v[160:175], v[52:55], v[24:27], v[160:175]
    ds_read_b64_tr_b16 v[50:51], v8 offset:3904
    v_mfma_f32_32x32x16_bf16 v[176:191], v[52:55], v[28:31], v[176:191]
    ds_read_b64_tr_b16 v[52:53], v8 offset:3168
    s_waitcnt lgkmcnt(11)
    v_mfma_f32_32x32x16_bf16 v[192:207], v[56:59], v[24:27], v[192:207]
    ds_read_b64_tr_b16 v[54:55], v8 offset:3936
    v_mfma_f32_32x32x16_bf16 v[208:223], v[56:59], v[28:31], v[208:223]
    ds_read_b64_tr_b16 v[56:57], v8 offset:3200
    s_waitcnt lgkmcnt(11)
    v_mfma_f32_32x32x16_bf16 v[224:239], v[60:63], v[24:27], v[224:239]
    ds_read_b64_tr_b16 v[58:59], v8 offset:3968
    v_mfma_f32_32x32x16_bf16 v[240:255], v[60:63], v[28:31], v[240:255]
    ds_read_b64_tr_b16 v[60:61], v8 offset:3232
    s_waitcnt lgkmcnt(6)
    v_mfma_f32_32x32x16_bf16 v[64:79], v[40:43], v[32:35], v[64:79]
    ds_read_b64_tr_b16 v[62:63], v8 offset:4000
    v_mfma_f32_32x32x16_bf16 v[80:95], v[40:43], v[36:39], v[80:95]
    s_barrier
    s_add_u32 s50, s50, 12352
    s_cmp_ge_u32 s50, 61760
    s_cselect_b32 s47, 4294917888, s62
    s_cselect_b32 s50, 0, s50
    v_add_u32 v8, s47, v8
    ds_read_b64_tr_b16 v[40:41], v8 offset:0
    s_waitcnt lgkmcnt(8)
    v_mfma_f32_32x32x16_bf16 v[96:111], v[44:47], v[32:35], v[96:111]
    ds_read_b64_tr_b16 v[42:43], v8 offset:768
    v_mfma_f32_32x32x16_bf16 v[112:127], v[44:47], v[36:39], v[112:127]
    ds_read_b64_tr_b16 v[44:45], v8 offset:32
    s_waitcnt lgkmcnt(9)
    v_mfma_f32_32x32x16_bf16 v[128:143], v[48:51], v[32:35], v[128:143]
    ds_read_b64_tr_b16 v[46:47], v8 offset:800
    ds_read_b128 v[24:27], v6 offset:0
    v_mfma_f32_32x32x16_bf16 v[144:159], v[48:51], v[36:39], v[144:159]
    ds_read_b64_tr_b16 v[48:49], v8 offset:64
    ds_read_b128 v[28:31], v6 offset:4096
    s_waitcnt lgkmcnt(11)
    v_mfma_f32_32x32x16_bf16 v[160:175], v[52:55], v[32:35], v[160:175]
    ds_read_b64_tr_b16 v[50:51], v8 offset:832
    v_mfma_f32_32x32x16_bf16 v[176:191], v[52:55], v[36:39], v[176:191]
    ds_read_b64_tr_b16 v[52:53], v8 offset:96
    s_waitcnt lgkmcnt(11)
    v_mfma_f32_32x32x16_bf16 v[192:207], v[56:59], v[32:35], v[192:207]
    ds_read_b64_tr_b16 v[54:55], v8 offset:864
    v_mfma_f32_32x32x16_bf16 v[208:223], v[56:59], v[36:39], v[208:223]
    ds_read_b64_tr_b16 v[56:57], v8 offset:128
    s_waitcnt lgkmcnt(11)
    v_mfma_f32_32x32x16_bf16 v[224:239], v[60:63], v[32:35], v[224:239]
    ds_read_b64_tr_b16 v[58:59], v8 offset:896
    v_mfma_f32_32x32x16_bf16 v[240:255], v[60:63], v[36:39], v[240:255]
    ds_read_b64_tr_b16 v[60:61], v8 offset:160
    s_waitcnt lgkmcnt(6)
    v_mfma_f32_32x32x16_bf16 v[64:79], v[40:43], v[24:27], v[64:79]
    ds_read_b64_tr_b16 v[62:63], v8 offset:928
    v_mfma_f32_32x32x16_bf16 v[80:95], v[40:43], v[28:31], v[80:95]
    ds_read_b64_tr_b16 v[40:41], v8 offset:3072
    s_waitcnt lgkmcnt(8)
    v_mfma_f32_32x32x16_bf16 v[96:111], v[44:47], v[24:27], v[96:111]
    ds_read_b64_tr_b16 v[42:43], v8 offset:3840
    v_mfma_f32_32x32x16_bf16 v[112:127], v[44:47], v[28:31], v[112:127]
    ds_read_b64_tr_b16 v[44:45], v8 offset:3104
    s_waitcnt lgkmcnt(9)
    v_mfma_f32_32x32x16_bf16 v[128:143], v[48:51], v[24:27], v[128:143]
    ds_read_b64_tr_b16 v[46:47], v8 offset:3872
    ds_read_b128 v[32:35], v7 offset:0
    v_mfma_f32_32x32x16_bf16 v[144:159], v[48:51], v[28:31], v[144:159]
    ds_read_b64_tr_b16 v[48:49], v8 offset:3136
    ds_read_b128 v[36:39], v7 offset:4096
    s_waitcnt lgkmcnt(11)
    v_mfma_f32_32x32x16_bf16 v[160:175], v[52:55], v[24:27], v[160:175]
    ds_read_b64_tr_b16 v[50:51], v8 offset:3904
    v_mfma_f32_32x32x16_bf16 v[176:191], v[52:55], v[28:31], v[176:191]
    ds_read_b64_tr_b16 v[52:53], v8 offset:3168
    s_waitcnt lgkmcnt(11)
    v_mfma_f32_32x32x16_bf16 v[192:207], v[56:59], v[24:27], v[192:207]
    ds_read_b64_tr_b16 v[54:55], v8 offset:3936
    v_mfma_f32_32x32x16_bf16 v[208:223], v[56:59], v[28:31], v[208:223]
    ds_read_b64_tr_b16 v[56:57], v8 offset:3200
    s_waitcnt lgkmcnt(11)
    v_mfma_f32_32x32x16_bf16 v[224:239], v[60:63], v[24:27], v[224:239]
    ds_read_b64_tr_b16 v[58:59], v8 offset:3968
    v_mfma_f32_32x32x16_bf16 v[240:255], v[60:63], v[28:31], v[240:255]
    ds_read_b64_tr_b16 v[60:61], v8 offset:3232
    s_waitcnt lgkmcnt(6)
    v_mfma_f32_32x32x16_bf16 v[64:79], v[40:43], v[32:35], v[64:79]
    ds_read_b64_tr_b16 v[62:63], v8 offset:4000
    v_mfma_f32_32x32x16_bf16 v[80:95], v[40:43], v[36:39], v[80:95]
    s_barrier
    s_add_u32 s50, s50, 12352
    s_cmp_ge_u32 s50, 61760
    s_cselect_b32 s47, 4294917888, s62
    s_cselect_b32 s50, 0, s50
    v_add_u32 v8, s47, v8
    s_add_u32 s51, s51, 32768
    s_cmp_ge_u32 s51, 98304
    s_cselect_b32 s48, 4294901760, s63
    s_cselect_b32 s51, 0, s51
    v_add_u32 v4, s48, v4
    v_add_u32 v5, s48, v5
    v_add_u32 v6, s48, v6
    v_add_u32 v7, s48, v7
    ds_read_b64_tr_b16 v[40:41], v8 offset:0
    s_waitcnt lgkmcnt(8)
    v_mfma_f32_32x32x16_bf16 v[96:111], v[44:47], v[32:35], v[96:111]
    ds_read_b64_tr_b16 v[42:43], v8 offset:768
    v_mfma_f32_32x32x16_bf16 v[112:127], v[44:47], v[36:39], v[112:127]
    ds_read_b64_tr_b16 v[44:45], v8 offset:32
    s_waitcnt lgkmcnt(9)
    v_mfma_f32_32x32x16_bf16 v[128:143], v[48:51], v[32:35], v[128:143]
    ds_read_b64_tr_b16 v[46:47], v8 offset:800
    ds_read_b128 v[24:27], v4 offset:0
    v_mfma_f32_32x32x16_bf16 v[144:159], v[48:51], v[36:39], v[144:159]
    ds_read_b64_tr_b16 v[48:49], v8 offset:64
    ds_read_b128 v[28:31], v4 offset:4096
    s_waitcnt lgkmcnt(11)
    v_mfma_f32_32x32x16_bf16 v[160:175], v[52:55], v[32:35], v[160:175]
    ds_read_b64_tr_b16 v[50:51], v8 offset:832
    v_mfma_f32_32x32x16_bf16 v[176:191], v[52:55], v[36:39], v[176:191]
    ds_read_b64_tr_b16 v[52:53], v8 offset:96
    s_waitcnt lgkmcnt(11)
    v_mfma_f32_32x32x16_bf16 v[192:207], v[56:59], v[32:35], v[192:207]
    ds_read_b64_tr_b16 v[54:55], v8 offset:864
    v_mfma_f32_32x32x16_bf16 v[208:223], v[56:59], v[36:39], v[208:223]
    ds_read_b64_tr_b16 v[56:57], v8 offset:128
    s_waitcnt lgkmcnt(11)
    v_mfma_f32_32x32x16_bf16 v[224:239], v[60:63], v[32:35], v[224:239]
    ds_read_b64_tr_b16 v[58:59], v8 offset:896
    v_mfma_f32_32x32x16_bf16 v[240:255], v[60:63], v[36:39], v[240:255]
    ds_read_b64_tr_b16 v[60:61], v8 offset:160
    s_sub_u32 s49, s49, 1
    s_cmp_lg_u32 s49, 0
    s_cbranch_scc1 p1c_24
    s_waitcnt lgkmcnt(6)
    v_mfma_f32_32x32x16_bf16 v[64:79], v[40:43], v[24:27], v[64:79]
    ds_read_b64_tr_b16 v[62:63], v8 offset:928
    v_mfma_f32_32x32x16_bf16 v[80:95], v[40:43], v[28:31], v[80:95]
    ds_read_b64_tr_b16 v[40:41], v8 offset:3072
    s_waitcnt lgkmcnt(8)
    v_mfma_f32_32x32x16_bf16 v[96:111], v[44:47], v[24:27], v[96:111]
    ds_read_b64_tr_b16 v[42:43], v8 offset:3840
    v_mfma_f32_32x32x16_bf16 v[112:127], v[44:47], v[28:31], v[112:127]
    ds_read_b64_tr_b16 v[44:45], v8 offset:3104
    s_waitcnt lgkmcnt(9)
    v_mfma_f32_32x32x16_bf16 v[128:143], v[48:51], v[24:27], v[128:143]
    ds_read_b64_tr_b16 v[46:47], v8 offset:3872
    ds_read_b128 v[32:35], v5 offset:0
    v_mfma_f32_32x32x16_bf16 v[144:159], v[48:51], v[28:31], v[144:159]
    ds_read_b64_tr_b16 v[48:49], v8 offset:3136
    ds_read_b128 v[36:39], v5 offset:4096
    s_waitcnt lgkmcnt(11)
    v_mfma_f32_32x32x16_bf16 v[160:175], v[52:55], v[24:27], v[160:175]
    ds_read_b64_tr_b16 v[50:51], v8 offset:3904
    v_mfma_f32_32x32x16_bf16 v[176:191], v[52:55], v[28:31], v[176:191]
    ds_read_b64_tr_b16 v[52:53], v8 offset:3168
    s_waitcnt lgkmcnt(11)
    v_mfma_f32_32x32x16_bf16 v[192:207], v[56:59], v[24:27], v[192:207]
    ds_read_b64_tr_b16 v[54:55], v8 offset:3936
    v_mfma_f32_32x32x16_bf16 v[208:223], v[56:59], v[28:31], v[208:223]
    ds_read_b64_tr_b16 v[56:57], v8 offset:3200
    s_waitcnt lgkmcnt(11)
    v_mfma_f32_32x32x16_bf16 v[224:239], v[60:63], v[24:27], v[224:239]
    ds_read_b64_tr_b16 v[58:59], v8 offset:3968
    v_mfma_f32_32x32x16_bf16 v[240:255], v[60:63], v[28:31], v[240:255]
    ds_read_b64_tr_b16 v[60:61], v8 offset:3232
    s_waitcnt lgkmcnt(6)
    v_mfma_f32_32x32x16_bf16 v[64:79], v[40:43], v[32:35], v[64:79]
    ds_read_b64_tr_b16 v[62:63], v8 offset:4000
    v_mfma_f32_32x32x16_bf16 v[80:95], v[40:43], v[36:39], v[80:95]
    s_barrier
    s_add_u32 s50, s50, 12352
    s_cmp_ge_u32 s50, 61760
    s_cselect_b32 s47, 4294917888, s62
    s_cselect_b32 s50, 0, s50
    v_add_u32 v8, s47, v8
    ds_read_b64_tr_b16 v[40:41], v8 offset:0
    s_waitcnt lgkmcnt(8)
    v_mfma_f32_32x32x16_bf16 v[96:111], v[44:47], v[32:35], v[96:111]
    ds_read_b64_tr_b16 v[42:43], v8 offset:768
    v_mfma_f32_32x32x16_bf16 v[112:127], v[44:47], v[36:39], v[112:127]
    ds_read_b64_tr_b16 v[44:45], v8 offset:32
    s_waitcnt lgkmcnt(9)
    v_mfma_f32_32x32x16_bf16 v[128:143], v[48:51], v[32:35], v[128:143]
    ds_read_b64_tr_b16 v[46:47], v8 offset:800
    ds_read_b128 v[24:27], v6 offset:0
    v_mfma_f32_32x32x16_bf16 v[144:159], v[48:51], v[36:39], v[144:159]
    ds_read_b64_tr_b16 v[48:49], v8 offset:64
    ds_read_b128 v[28:31], v6 offset:4096
    s_waitcnt lgkmcnt(11)
    v_mfma_f32_32x32x16_bf16 v[160:175], v[52:55], v[32:35], v[160:175]
    ds_read_b64_tr_b16 v[50:51], v8 offset:832
    v_mfma_f32_32x32x16_bf16 v[176:191], v[52:55], v[36:39], v[176:191]
    ds_read_b64_tr_b16 v[52:53], v8 offset:96
    s_waitcnt lgkmcnt(11)
    v_mfma_f32_32x32x16_bf16 v[192:207], v[56:59], v[32:35], v[192:207]
    ds_read_b64_tr_b16 v[54:55], v8 offset:864
    v_mfma_f32_32x32x16_bf16 v[208:223], v[56:59], v[36:39], v[208:223]
    ds_read_b64_tr_b16 v[56:57], v8 offset:128
    s_waitcnt lgkmcnt(11)
    v_mfma_f32_32x32x16_bf16 v[224:239], v[60:63], v[32:35], v[224:239]
    ds_read_b64_tr_b16 v[58:59], v8 offset:896
    v_mfma_f32_32x32x16_bf16 v[240:255], v[60:63], v[36:39], v[240:255]
    ds_read_b64_tr_b16 v[60:61], v8 offset:160
    s_waitcnt lgkmcnt(6)
    v_mfma_f32_32x32x16_bf16 v[64:79], v[40:43], v[24:27], v[64:79]
    ds_read_b64_tr_b16 v[62:63], v8 offset:928
    v_mfma_f32_32x32x16_bf16 v[80:95], v[40:43], v[28:31], v[80:95]
    ds_read_b64_tr_b16 v[40:41], v8 offset:3072
    s_waitcnt lgkmcnt(8)
    v_mfma_f32_32x32x16_bf16 v[96:111], v[44:47], v[24:27], v[96:111]
    ds_read_b64_tr_b16 v[42:43], v8 offset:3840
    v_mfma_f32_32x32x16_bf16 v[112:127], v[44:47], v[28:31], v[112:127]
    ds_read_b64_tr_b16 v[44:45], v8 offset:3104
    s_waitcnt lgkmcnt(9)
    v_mfma_f32_32x32x16_bf16 v[128:143], v[48:51], v[24:27], v[128:143]
    ds_read_b64_tr_b16 v[46:47], v8 offset:3872
    ds_read_b128 v[32:35], v7 offset:0
    v_mfma_f32_32x32x16_bf16 v[144:159], v[48:51], v[28:31], v[144:159]
    ds_read_b64_tr_b16 v[48:49], v8 offset:3136
    ds_read_b128 v[36:39], v7 offset:4096
    s_waitcnt lgkmcnt(11)
    v_mfma_f32_32x32x16_bf16 v[160:175], v[52:55], v[24:27], v[160:175]
    ds_read_b64_tr_b16 v[50:51], v8 offset:3904
    v_mfma_f32_32x32x16_bf16 v[176:191], v[52:55], v[28:31], v[176:191]
    ds_read_b64_tr_b16 v[52:53], v8 offset:3168
    s_waitcnt lgkmcnt(11)
    v_mfma_f32_32x32x16_bf16 v[192:207], v[56:59], v[24:27], v[192:207]
    ds_read_b64_tr_b16 v[54:55], v8 offset:3936
    v_mfma_f32_32x32x16_bf16 v[208:223], v[56:59], v[28:31], v[208:223]
    ds_read_b64_tr_b16 v[56:57], v8 offset:3200
    s_waitcnt lgkmcnt(11)
    v_mfma_f32_32x32x16_bf16 v[224:239], v[60:63], v[24:27], v[224:239]
    ds_read_b64_tr_b16 v[58:59], v8 offset:3968
    v_mfma_f32_32x32x16_bf16 v[240:255], v[60:63], v[28:31], v[240:255]
    ds_read_b64_tr_b16 v[60:61], v8 offset:3232
    s_waitcnt lgkmcnt(6)
    v_mfma_f32_32x32x16_bf16 v[64:79], v[40:43], v[32:35], v[64:79]
    ds_read_b64_tr_b16 v[62:63], v8 offset:4000
    v_mfma_f32_32x32x16_bf16 v[80:95], v[40:43], v[36:39], v[80:95]
    s_waitcnt lgkmcnt(7)
    v_mfma_f32_32x32x16_bf16 v[96:111], v[44:47], v[32:35], v[96:111]
    v_mfma_f32_32x32x16_bf16 v[112:127], v[44:47], v[36:39], v[112:127]
    s_waitcnt lgkmcnt(6)
    v_mfma_f32_32x32x16_bf16 v[128:143], v[48:51], v[32:35], v[128:143]
    v_mfma_f32_32x32x16_bf16 v[144:159], v[48:51], v[36:39], v[144:159]
    s_waitcnt lgkmcnt(4)
    v_mfma_f32_32x32x16_bf16 v[160:175], v[52:55], v[32:35], v[160:175]
    v_mfma_f32_32x32x16_bf16 v[176:191], v[52:55], v[36:39], v[176:191]
    s_waitcnt lgkmcnt(2)
    v_mfma_f32_32x32x16_bf16 v[192:207], v[56:59], v[32:35], v[192:207]
    v_mfma_f32_32x32x16_bf16 v[208:223], v[56:59], v[36:39], v[208:223]
    s_waitcnt lgkmcnt(0)
    v_mfma_f32_32x32x16_bf16 v[224:239], v[60:63], v[32:35], v[224:239]
    v_mfma_f32_32x32x16_bf16 v[240:255], v[60:63], v[36:39], v[240:255]
    s_barrier
    s_nop 15
    s_add_u32 s40, s22, 11534336
    s_addc_u32 s41, s23, 0
    s_mov_b32 s42, 7077888
    s_mov_b32 s43, 0x20000
    s_mul_i32 s60, s45, 393216
    s_lshl_b32 s61, s44, 8
    s_lshl_b32 s62, s3, 6
    s_add_u32 s61, s61, s62
    s_lshl_b32 s61, s61, 5
    s_add_u32 s50, s60, s61
    v_lshlrev_b32 v10, 5, v2
    v_lshlrev_b32 v11, 4, v3
    v_add_u32 v10, v10, v11
    s_mov_b32 s64, 0xbfb8aa3b
    s_mov_b32 s65, 0xbfb8aa3b
    s_mov_b32 s66, 1.0
    s_mov_b32 s67, 1.0
    v_pk_mul_f32 v[24:25], v[128:129], s[64:65]
    v_pk_mul_f32 v[26:27], v[130:131], s[64:65]
    v_pk_mul_f32 v[28:29], v[132:133], s[64:65]
    v_pk_mul_f32 v[30:31], v[134:135], s[64:65]
    v_exp_f32 v24, v24
    v_exp_f32 v25, v25
    v_exp_f32 v26, v26
    v_exp_f32 v27, v27
    v_exp_f32 v28, v28
    v_exp_f32 v29, v29
    v_exp_f32 v30, v30
    v_exp_f32 v31, v31
    v_pk_mul_f32 v[136:137], v[136:137], v[128:129]
    v_pk_mul_f32 v[138:139], v[138:139], v[130:131]
    v_pk_mul_f32 v[140:141], v[140:141], v[132:133]
    v_pk_mul_f32 v[142:143], v[142:143], v[134:135]
    v_pk_add_f32 v[24:25], v[24:25], s[66:67]
    v_pk_add_f32 v[26:27], v[26:27], s[66:67]
    v_pk_add_f32 v[28:29], v[28:29], s[66:67]
    v_pk_add_f32 v[30:31], v[30:31], s[66:67]
    v_rcp_f32 v24, v24
    v_rcp_f32 v25, v25
    v_rcp_f32 v26, v26
    v_rcp_f32 v27, v27
    v_rcp_f32 v28, v28
    v_rcp_f32 v29, v29
    v_rcp_f32 v30, v30
    v_rcp_f32 v31, v31
    s_nop 0
    v_pk_mul_f32 v[136:137], v[136:137], v[24:25]
    v_pk_mul_f32 v[138:139], v[138:139], v[26:27]
    v_pk_mul_f32 v[140:141], v[140:141], v[28:29]
    v_pk_mul_f32 v[142:143], v[142:143], v[30:31]
    v_cvt_pk_bf16_f32 v40, v136, v137
    v_cvt_pk_bf16_f32 v41, v138, v139
    v_cvt_pk_bf16_f32 v42, v140, v141
    v_cvt_pk_bf16_f32 v43, v142, v143
    v_pk_mul_f32 v[32:33], v[144:145], s[64:65]
    v_pk_mul_f32 v[34:35], v[146:147], s[64:65]
    v_pk_mul_f32 v[36:37], v[148:149], s[64:65]
    v_pk_mul_f32 v[38:39], v[150:151], s[64:65]
    v_exp_f32 v32, v32
    v_exp_f32 v33, v33
    v_exp_f32 v34, v34
    v_exp_f32 v35, v35
    v_exp_f32 v36, v36
    v_exp_f32 v37, v37
    v_exp_f32 v38, v38
    v_exp_f32 v39, v39
    v_pk_mul_f32 v[152:153], v[152:153], v[144:145]
    v_pk_mul_f32 v[154:155], v[154:155], v[146:147]
    v_pk_mul_f32 v[156:157], v[156:157], v[148:149]
    v_pk_mul_f32 v[158:159], v[158:159], v[150:151]
    v_pk_add_f32 v[32:33], v[32:33], s[66:67]
    v_pk_add_f32 v[34:35], v[34:35], s[66:67]
    v_pk_add_f32 v[36:37], v[36:37], s[66:67]
    v_pk_add_f32 v[38:39], v[38:39], s[66:67]
    v_rcp_f32 v32, v32
    v_rcp_f32 v33, v33
    v_rcp_f32 v34, v34
    v_rcp_f32 v35, v35
    v_rcp_f32 v36, v36
    v_rcp_f32 v37, v37
    v_rcp_f32 v38, v38
    v_rcp_f32 v39, v39
    s_nop 0
    v_pk_mul_f32 v[152:153], v[152:153], v[32:33]
    v_pk_mul_f32 v[154:155], v[154:155], v[34:35]
    v_pk_mul_f32 v[156:157], v[156:157], v[36:37]
    v_pk_mul_f32 v[158:159], v[158:159], v[38:39]
    v_cvt_pk_bf16_f32 v44, v152, v153
    v_cvt_pk_bf16_f32 v45, v154, v155
    v_cvt_pk_bf16_f32 v46, v156, v157
    v_cvt_pk_bf16_f32 v47, v158, v159
    v_pk_mul_f32 v[24:25], v[160:161], s[64:65]
    v_pk_mul_f32 v[26:27], v[162:163], s[64:65]
    v_pk_mul_f32 v[28:29], v[164:165], s[64:65]
    v_pk_mul_f32 v[30:31], v[166:167], s[64:65]
    v_exp_f32 v24, v24
    v_exp_f32 v25, v25
    v_exp_f32 v26, v26
    v_exp_f32 v27, v27
    v_exp_f32 v28, v28
    v_exp_f32 v29, v29
    v_exp_f32 v30, v30
    v_exp_f32 v31, v31
    v_pk_mul_f32 v[168:169], v[168:169], v[160:161]
    v_pk_mul_f32 v[170:171], v[170:171], v[162:163]
    v_pk_mul_f32 v[172:173], v[172:173], v[164:165]
    v_pk_mul_f32 v[174:175], v[174:175], v[166:167]
    v_pk_add_f32 v[24:25], v[24:25], s[66:67]
    v_pk_add_f32 v[26:27], v[26:27], s[66:67]
    v_pk_add_f32 v[28:29], v[28:29], s[66:67]
    v_pk_add_f32 v[30:31], v[30:31], s[66:67]
    v_rcp_f32 v24, v24
    v_rcp_f32 v25, v25
    v_rcp_f32 v26, v26
    v_rcp_f32 v27, v27
    v_rcp_f32 v28, v28
    v_rcp_f32 v29, v29
    v_rcp_f32 v30, v30
    v_rcp_f32 v31, v31
    s_nop 0
    v_pk_mul_f32 v[168:169], v[168:169], v[24:25]
    v_pk_mul_f32 v[170:171], v[170:171], v[26:27]
    v_pk_mul_f32 v[172:173], v[172:173], v[28:29]
    v_pk_mul_f32 v[174:175], v[174:175], v[30:31]
    v_cvt_pk_bf16_f32 v128, v168, v169
    v_cvt_pk_bf16_f32 v129, v170, v171
    v_cvt_pk_bf16_f32 v130, v172, v173
    v_cvt_pk_bf16_f32 v131, v174, v175
    v_pk_mul_f32 v[32:33], v[176:177], s[64:65]
    v_pk_mul_f32 v[34:35], v[178:179], s[64:65]
    v_pk_mul_f32 v[36:37], v[180:181], s[64:65]
    v_pk_mul_f32 v[38:39], v[182:183], s[64:65]
    v_exp_f32 v32, v32
    v_exp_f32 v33, v33
    v_exp_f32 v34, v34
    v_exp_f32 v35, v35
    v_exp_f32 v36, v36
    v_exp_f32 v37, v37
    v_exp_f32 v38, v38
    v_exp_f32 v39, v39
    v_pk_mul_f32 v[184:185], v[184:185], v[176:177]
    v_pk_mul_f32 v[186:187], v[186:187], v[178:179]
    v_pk_mul_f32 v[188:189], v[188:189], v[180:181]
    v_pk_mul_f32 v[190:191], v[190:191], v[182:183]
    v_pk_add_f32 v[32:33], v[32:33], s[66:67]
    v_pk_add_f32 v[34:35], v[34:35], s[66:67]
    v_pk_add_f32 v[36:37], v[36:37], s[66:67]
    v_pk_add_f32 v[38:39], v[38:39], s[66:67]
    v_rcp_f32 v32, v32
    v_rcp_f32 v33, v33
    v_rcp_f32 v34, v34
    v_rcp_f32 v35, v35
    v_rcp_f32 v36, v36
    v_rcp_f32 v37, v37
    v_rcp_f32 v38, v38
    v_rcp_f32 v39, v39
    s_nop 0
    v_pk_mul_f32 v[184:185], v[184:185], v[32:33]
    v_pk_mul_f32 v[186:187], v[186:187], v[34:35]
    v_pk_mul_f32 v[188:189], v[188:189], v[36:37]
    v_pk_mul_f32 v[190:191], v[190:191], v[38:39]
    v_cvt_pk_bf16_f32 v132, v184, v185
    v_cvt_pk_bf16_f32 v133, v186, v187
    v_cvt_pk_bf16_f32 v134, v188, v189
    v_cvt_pk_bf16_f32 v135, v190, v191
    v_pk_mul_f32 v[24:25], v[64:65], s[64:65]
    v_pk_mul_f32 v[26:27], v[66:67], s[64:65]
    v_pk_mul_f32 v[28:29], v[68:69], s[64:65]
    v_pk_mul_f32 v[30:31], v[70:71], s[64:65]
    v_exp_f32 v24, v24
    v_exp_f32 v25, v25
    v_exp_f32 v26, v26
    v_exp_f32 v27, v27
    v_exp_f32 v28, v28
    v_exp_f32 v29, v29
    v_exp_f32 v30, v30
    v_exp_f32 v31, v31
    v_pk_mul_f32 v[72:73], v[72:73], v[64:65]
    v_pk_mul_f32 v[74:75], v[74:75], v[66:67]
    v_pk_mul_f32 v[76:77], v[76:77], v[68:69]
    v_pk_mul_f32 v[78:79], v[78:79], v[70:71]
    v_pk_add_f32 v[24:25], v[24:25], s[66:67]
    v_pk_add_f32 v[26:27], v[26:27], s[66:67]
    v_pk_add_f32 v[28:29], v[28:29], s[66:67]
    v_pk_add_f32 v[30:31], v[30:31], s[66:67]
    v_rcp_f32 v24, v24
    v_rcp_f32 v25, v25
    v_rcp_f32 v26, v26
    v_rcp_f32 v27, v27
    v_rcp_f32 v28, v28
    v_rcp_f32 v29, v29
    v_rcp_f32 v30, v30
    v_rcp_f32 v31, v31
    s_nop 0
    v_pk_mul_f32 v[72:73], v[72:73], v[24:25]
    v_pk_mul_f32 v[74:75], v[74:75], v[26:27]
    v_pk_mul_f32 v[76:77], v[76:77], v[28:29]
    v_pk_mul_f32 v[78:79], v[78:79], v[30:31]
    v_cvt_pk_bf16_f32 v136, v72, v73
    v_cvt_pk_bf16_f32 v137, v74, v75
    v_cvt_pk_bf16_f32 v138, v76, v77
    v_cvt_pk_bf16_f32 v139, v78, v79
    v_pk_mul_f32 v[32:33], v[80:81], s[64:65]
    v_pk_mul_f32 v[34:35], v[82:83], s[64:65]
    v_pk_mul_f32 v[36:37], v[84:85], s[64:65]
    v_pk_mul_f32 v[38:39], v[86:87], s[64:65]
    v_exp_f32 v32, v32
    v_exp_f32 v33, v33
    v_exp_f32 v34, v34
    v_exp_f32 v35, v35
    v_exp_f32 v36, v36
    v_exp_f32 v37, v37
    v_exp_f32 v38, v38
    v_exp_f32 v39, v39
    v_pk_mul_f32 v[88:89], v[88:89], v[80:81]
    v_pk_mul_f32 v[90:91], v[90:91], v[82:83]
    v_pk_mul_f32 v[92:93], v[92:93], v[84:85]
    v_pk_mul_f32 v[94:95], v[94:95], v[86:87]
    v_pk_add_f32 v[32:33], v[32:33], s[66:67]
    v_pk_add_f32 v[34:35], v[34:35], s[66:67]
    v_pk_add_f32 v[36:37], v[36:37], s[66:67]
    v_pk_add_f32 v[38:39], v[38:39], s[66:67]
    v_rcp_f32 v32, v32
    v_rcp_f32 v33, v33
    v_rcp_f32 v34, v34
    v_rcp_f32 v35, v35
    v_rcp_f32 v36, v36
    v_rcp_f32 v37, v37
    v_rcp_f32 v38, v38
    v_rcp_f32 v39, v39
    s_nop 0
    v_pk_mul_f32 v[88:89], v[88:89], v[32:33]
    v_pk_mul_f32 v[90:91], v[90:91], v[34:35]
    v_pk_mul_f32 v[92:93], v[92:93], v[36:37]
    v_pk_mul_f32 v[94:95], v[94:95], v[38:39]
    v_cvt_pk_bf16_f32 v140, v88, v89
    v_cvt_pk_bf16_f32 v141, v90, v91
    v_cvt_pk_bf16_f32 v142, v92, v93
    v_cvt_pk_bf16_f32 v143, v94, v95
    v_pk_mul_f32 v[24:25], v[96:97], s[64:65]
    v_pk_mul_f32 v[26:27], v[98:99], s[64:65]
    v_pk_mul_f32 v[28:29], v[100:101], s[64:65]
    v_pk_mul_f32 v[30:31], v[102:103], s[64:65]
    v_exp_f32 v24, v24
    v_exp_f32 v25, v25
    v_exp_f32 v26, v26
    v_exp_f32 v27, v27
    v_exp_f32 v28, v28
    v_exp_f32 v29, v29
    v_exp_f32 v30, v30
    v_exp_f32 v31, v31
    v_pk_mul_f32 v[104:105], v[104:105], v[96:97]
    v_pk_mul_f32 v[106:107], v[106:107], v[98:99]
    v_pk_mul_f32 v[108:109], v[108:109], v[100:101]
    v_pk_mul_f32 v[110:111], v[110:111], v[102:103]
    v_pk_add_f32 v[24:25], v[24:25], s[66:67]
    v_pk_add_f32 v[26:27], v[26:27], s[66:67]
    v_pk_add_f32 v[28:29], v[28:29], s[66:67]
    v_pk_add_f32 v[30:31], v[30:31], s[66:67]
    v_rcp_f32 v24, v24
    v_rcp_f32 v25, v25
    v_rcp_f32 v26, v26
    v_rcp_f32 v27, v27
    v_rcp_f32 v28, v28
    v_rcp_f32 v29, v29
    v_rcp_f32 v30, v30
    v_rcp_f32 v31, v31
    s_nop 0
    v_pk_mul_f32 v[104:105], v[104:105], v[24:25]
    v_pk_mul_f32 v[106:107], v[106:107], v[26:27]
    v_pk_mul_f32 v[108:109], v[108:109], v[28:29]
    v_pk_mul_f32 v[110:111], v[110:111], v[30:31]
    v_cvt_pk_bf16_f32 v144, v104, v105
    v_cvt_pk_bf16_f32 v145, v106, v107
    v_cvt_pk_bf16_f32 v146, v108, v109
    v_cvt_pk_bf16_f32 v147, v110, v111
    v_pk_mul_f32 v[32:33], v[112:113], s[64:65]
    v_pk_mul_f32 v[34:35], v[114:115], s[64:65]
    v_pk_mul_f32 v[36:37], v[116:117], s[64:65]
    v_pk_mul_f32 v[38:39], v[118:119], s[64:65]
    v_exp_f32 v32, v32
    v_exp_f32 v33, v33
    v_exp_f32 v34, v34
    v_exp_f32 v35, v35
    v_exp_f32 v36, v36
    v_exp_f32 v37, v37
    v_exp_f32 v38, v38
    v_exp_f32 v39, v39
    v_pk_mul_f32 v[120:121], v[120:121], v[112:113]
    v_pk_mul_f32 v[122:123], v[122:123], v[114:115]
    v_pk_mul_f32 v[124:125], v[124:125], v[116:117]
    v_pk_mul_f32 v[126:127], v[126:127], v[118:119]
    v_pk_add_f32 v[32:33], v[32:33], s[66:67]
    v_pk_add_f32 v[34:35], v[34:35], s[66:67]
    v_pk_add_f32 v[36:37], v[36:37], s[66:67]
    v_pk_add_f32 v[38:39], v[38:39], s[66:67]
    v_rcp_f32 v32, v32
    v_rcp_f32 v33, v33
    v_rcp_f32 v34, v34
    v_rcp_f32 v35, v35
    v_rcp_f32 v36, v36
    v_rcp_f32 v37, v37
    v_rcp_f32 v38, v38
    v_rcp_f32 v39, v39
    s_nop 0
    v_pk_mul_f32 v[120:121], v[120:121], v[32:33]
    v_pk_mul_f32 v[122:123], v[122:123], v[34:35]
    v_pk_mul_f32 v[124:125], v[124:125], v[36:37]
    v_pk_mul_f32 v[126:127], v[126:127], v[38:39]
    v_cvt_pk_bf16_f32 v148, v120, v121
    v_cvt_pk_bf16_f32 v149, v122, v123
    v_cvt_pk_bf16_f32 v150, v124, v125
    v_cvt_pk_bf16_f32 v151, v126, v127
    v_pk_mul_f32 v[24:25], v[192:193], s[64:65]
    v_pk_mul_f32 v[26:27], v[194:195], s[64:65]
    v_pk_mul_f32 v[28:29], v[196:197], s[64:65]
    v_pk_mul_f32 v[30:31], v[198:199], s[64:65]
    v_exp_f32 v24, v24
    v_exp_f32 v25, v25
    v_exp_f32 v26, v26
    v_exp_f32 v27, v27
    v_exp_f32 v28, v28
    v_exp_f32 v29, v29
    v_exp_f32 v30, v30
    v_exp_f32 v31, v31
    v_pk_mul_f32 v[200:201], v[200:201], v[192:193]
    v_pk_mul_f32 v[202:203], v[202:203], v[194:195]
    v_pk_mul_f32 v[204:205], v[204:205], v[196:197]
    v_pk_mul_f32 v[206:207], v[206:207], v[198:199]
    v_pk_add_f32 v[24:25], v[24:25], s[66:67]
    v_pk_add_f32 v[26:27], v[26:27], s[66:67]
    v_pk_add_f32 v[28:29], v[28:29], s[66:67]
    v_pk_add_f32 v[30:31], v[30:31], s[66:67]
    v_rcp_f32 v24, v24
    v_rcp_f32 v25, v25
    v_rcp_f32 v26, v26
    v_rcp_f32 v27, v27
    v_rcp_f32 v28, v28
    v_rcp_f32 v29, v29
    v_rcp_f32 v30, v30
    v_rcp_f32 v31, v31
    s_nop 0
    v_pk_mul_f32 v[200:201], v[200:201], v[24:25]
    v_pk_mul_f32 v[202:203], v[202:203], v[26:27]
    v_pk_mul_f32 v[204:205], v[204:205], v[28:29]
    v_pk_mul_f32 v[206:207], v[206:207], v[30:31]
    v_cvt_pk_bf16_f32 v152, v200, v201
    v_cvt_pk_bf16_f32 v153, v202, v203
    v_cvt_pk_bf16_f32 v154, v204, v205
    v_cvt_pk_bf16_f32 v155, v206, v207
    v_pk_mul_f32 v[32:33], v[208:209], s[64:65]
    v_pk_mul_f32 v[34:35], v[210:211], s[64:65]
    v_pk_mul_f32 v[36:37], v[212:213], s[64:65]
    v_pk_mul_f32 v[38:39], v[214:215], s[64:65]
    v_exp_f32 v32, v32
    v_exp_f32 v33, v33
    v_exp_f32 v34, v34
    v_exp_f32 v35, v35
    v_exp_f32 v36, v36
    v_exp_f32 v37, v37
    v_exp_f32 v38, v38
    v_exp_f32 v39, v39
    v_pk_mul_f32 v[216:217], v[216:217], v[208:209]
    v_pk_mul_f32 v[218:219], v[218:219], v[210:211]
    v_pk_mul_f32 v[220:221], v[220:221], v[212:213]
    v_pk_mul_f32 v[222:223], v[222:223], v[214:215]
    v_pk_add_f32 v[32:33], v[32:33], s[66:67]
    v_pk_add_f32 v[34:35], v[34:35], s[66:67]
    v_pk_add_f32 v[36:37], v[36:37], s[66:67]
    v_pk_add_f32 v[38:39], v[38:39], s[66:67]
    v_rcp_f32 v32, v32
    v_rcp_f32 v33, v33
    v_rcp_f32 v34, v34
    v_rcp_f32 v35, v35
    v_rcp_f32 v36, v36
    v_rcp_f32 v37, v37
    v_rcp_f32 v38, v38
    v_rcp_f32 v39, v39
    s_nop 0
    v_pk_mul_f32 v[216:217], v[216:217], v[32:33]
    v_pk_mul_f32 v[218:219], v[218:219], v[34:35]
    v_pk_mul_f32 v[220:221], v[220:221], v[36:37]
    v_pk_mul_f32 v[222:223], v[222:223], v[38:39]
    v_cvt_pk_bf16_f32 v156, v216, v217
    v_cvt_pk_bf16_f32 v157, v218, v219
    v_cvt_pk_bf16_f32 v158, v220, v221
    v_cvt_pk_bf16_f32 v159, v222, v223
    v_pk_mul_f32 v[24:25], v[224:225], s[64:65]
    v_pk_mul_f32 v[26:27], v[226:227], s[64:65]
    v_pk_mul_f32 v[28:29], v[228:229], s[64:65]
    v_pk_mul_f32 v[30:31], v[230:231], s[64:65]
    v_exp_f32 v24, v24
    v_exp_f32 v25, v25
    v_exp_f32 v26, v26
    v_exp_f32 v27, v27
    v_exp_f32 v28, v28
    v_exp_f32 v29, v29
    v_exp_f32 v30, v30
    v_exp_f32 v31, v31
    v_pk_mul_f32 v[232:233], v[232:233], v[224:225]
    v_pk_mul_f32 v[234:235], v[234:235], v[226:227]
    v_pk_mul_f32 v[236:237], v[236:237], v[228:229]
    v_pk_mul_f32 v[238:239], v[238:239], v[230:231]
    v_pk_add_f32 v[24:25], v[24:25], s[66:67]
    v_pk_add_f32 v[26:27], v[26:27], s[66:67]
    v_pk_add_f32 v[28:29], v[28:29], s[66:67]
    v_pk_add_f32 v[30:31], v[30:31], s[66:67]
    v_rcp_f32 v24, v24
    v_rcp_f32 v25, v25
    v_rcp_f32 v26, v26
    v_rcp_f32 v27, v27
    v_rcp_f32 v28, v28
    v_rcp_f32 v29, v29
    v_rcp_f32 v30, v30
    v_rcp_f32 v31, v31
    s_nop 0
    v_pk_mul_f32 v[232:233], v[232:233], v[24:25]
    v_pk_mul_f32 v[234:235], v[234:235], v[26:27]
    v_pk_mul_f32 v[236:237], v[236:237], v[28:29]
    v_pk_mul_f32 v[238:239], v[238:239], v[30:31]
    v_cvt_pk_bf16_f32 v160, v232, v233
    v_cvt_pk_bf16_f32 v161, v234, v235
    v_cvt_pk_bf16_f32 v162, v236, v237
    v_cvt_pk_bf16_f32 v163, v238, v239
    v_pk_mul_f32 v[32:33], v[240:241], s[64:65]
    v_pk_mul_f32 v[34:35], v[242:243], s[64:65]
    v_pk_mul_f32 v[36:37], v[244:245], s[64:65]
    v_pk_mul_f32 v[38:39], v[246:247], s[64:65]
    v_exp_f32 v32, v32
    v_exp_f32 v33, v33
    v_exp_f32 v34, v34
    v_exp_f32 v35, v35
    v_exp_f32 v36, v36
    v_exp_f32 v37, v37
    v_exp_f32 v38, v38
    v_exp_f32 v39, v39
    v_pk_mul_f32 v[248:249], v[248:249], v[240:241]
    v_pk_mul_f32 v[250:251], v[250:251], v[242:243]
    v_pk_mul_f32 v[252:253], v[252:253], v[244:245]
    v_pk_mul_f32 v[254:255], v[254:255], v[246:247]
    v_pk_add_f32 v[32:33], v[32:33], s[66:67]
    v_pk_add_f32 v[34:35], v[34:35], s[66:67]
    v_pk_add_f32 v[36:37], v[36:37], s[66:67]
    v_pk_add_f32 v[38:39], v[38:39], s[66:67]
    v_rcp_f32 v32, v32
    v_rcp_f32 v33, v33
    v_rcp_f32 v34, v34
    v_rcp_f32 v35, v35
    v_rcp_f32 v36, v36
    v_rcp_f32 v37, v37
    v_rcp_f32 v38, v38
    v_rcp_f32 v39, v39
    s_nop 0
    v_pk_mul_f32 v[248:249], v[248:249], v[32:33]
    v_pk_mul_f32 v[250:251], v[250:251], v[34:35]
    v_pk_mul_f32 v[252:253], v[252:253], v[36:37]
    v_pk_mul_f32 v[254:255], v[254:255], v[38:39]
    v_cvt_pk_bf16_f32 v164, v248, v249
    v_cvt_pk_bf16_f32 v165, v250, v251
    v_cvt_pk_bf16_f32 v166, v252, v253
    v_cvt_pk_bf16_f32 v167, v254, v255
    v_mov_b32 v168, v40
    v_mov_b32 v169, v41
    v_mov_b32 v170, v42
    v_mov_b32 v171, v43
    v_mov_b32 v172, v44
    v_mov_b32 v173, v45
    v_mov_b32 v174, v46
    v_mov_b32 v175, v47
    s_mov_b32 s55, s50
    s_mov_b32 s47, 1
    s_add_u32 s54, s44, 8
    v_mov_b32 v99, 0
    global_load_dword v99, v99, s[20:21] sc1
    s_branch after_p1
p1_gate:
    s_waitcnt lgkmcnt(0)
    s_sub_u32 s60, s60, 2
    s_lshl_b32 s60, s60, 3
    s_add_u32 s44, s44, s60
    s_mov_b32 s54, -1
    s_or_b32 s61, s44, s3
    s_cmp_lg_u32 s61, 0
    s_cbranch_scc1 cinit_25
    v_lshlrev_b32 v4, 8, v1
    v_add_u32 v4, 8126464, v4
    v_mov_b32 v5, 0
    s_mov_b64 exec, 0xffffffff
    global_store_dword v4, v5, s[22:23] sc1
    s_waitcnt vmcnt(0)
    s_mov_b64 exec, 1
    v_mov_b32 v4, 0
    v_mov_b32 v5, 1
    global_atomic_add v4, v5, s[20:21]
    s_mov_b64 exec, -1
cinit_25:
    v_mov_b32 v7, 0
    global_load_dword v7, v7, s[20:21] sc1
    s_mov_b32 s28, s4
    s_mov_b32 s29, s5
    s_mov_b32 s30, 2621440
    s_mov_b32 s31, 0x20000
    s_mov_b32 s32, s16
    s_mov_b32 s33, s17
    s_mov_b32 s34, 1280
    s_mov_b32 s35, 0x20000
    s_add_u32 s40, s22, 7864320
    s_addc_u32 s41, s23, 0
    s_mov_b32 s42, 16384
    s_mov_b32 s43, 0x20000
    v_and_b32 v2, 15, v1
    v_lshrrev_b32 v3, 4, v1
    v_mul_u32_u24 v4, 80, v2
    s_lshl_b32 s60, s44, 7
    s_lshl_b32 s61, s3, 4
    s_add_u32 s51, s60, s61
    v_add_u32 v5, s51, v3
    v_mul_u32_u24 v6, 1280, v5
    v_add_u32 v6, v6, v4
    buffer_load_dwordx4 v[8:11], v4, s[32:35], 0 offen offset:0
    buffer_load_dwordx4 v[12:15], v4, s[32:35], 0 offen offset:16
    buffer_load_dwordx4 v[16:19], v4, s[32:35], 0 offen offset:32
    buffer_load_dwordx4 v[20:23], v4, s[32:35], 0 offen offset:48
    buffer_load_dwordx4 v[24:27], v4, s[32:35], 0 offen offset:64
    s_mov_b32 s61, 0
    buffer_load_dwordx4 v[100:103], v6, s[28:31], s61 offen offset:0
    buffer_load_dwordx4 v[104:107], v6, s[28:31], s61 offen offset:16
    buffer_load_dwordx4 v[108:111], v6, s[28:31], s61 offen offset:32
    buffer_load_dwordx4 v[112:115], v6, s[28:31], s61 offen offset:48
    buffer_load_dwordx4 v[116:119], v6, s[28:31], s61 offen offset:64
    s_mov_b32 s61, 5120
    buffer_load_dwordx4 v[120:123], v6, s[28:31], s61 offen offset:0
    buffer_load_dwordx4 v[124:127], v6, s[28:31], s61 offen offset:16
    buffer_load_dwordx4 v[128:131], v6, s[28:31], s61 offen offset:32
    buffer_load_dwordx4 v[132:135], v6, s[28:31], s61 offen offset:48
    buffer_load_dwordx4 v[136:139], v6, s[28:31], s61 offen offset:64
    s_mov_b32 s61, 10240
    buffer_load_dwordx4 v[140:143], v6, s[28:31], s61 offen offset:0
    buffer_load_dwordx4 v[144:147], v6, s[28:31], s61 offen offset:16
    buffer_load_dwordx4 v[148:151], v6, s[28:31], s61 offen offset:32
    buffer_load_dwordx4 v[152:155], v6, s[28:31], s61 offen offset:48
    buffer_load_dwordx4 v[156:159], v6, s[28:31], s61 offen offset:64
    s_mov_b32 s61, 15360
    buffer_load_dwordx4 v[160:163], v6, s[28:31], s61 offen offset:0
    buffer_load_dwordx4 v[164:167], v6, s[28:31], s61 offen offset:16
    buffer_load_dwordx4 v[168:171], v6, s[28:31], s61 offen offset:32
    buffer_load_dwordx4 v[172:175], v6, s[28:31], s61 offen offset:48
    buffer_load_dwordx4 v[176:179], v6, s[28:31], s61 offen offset:64
    s_mov_b32 s92, s14
    s_mov_b32 s93, s15
    s_mov_b32 s94, 2211840
    s_mov_b32 s95, 0x20000
    s_mov_b32 s96, s8
    s_mov_b32 s97, s9
    s_mov_b32 s98, 819200
    s_mov_b32 s99, 0x20000
    s_add_u32 s64, s22, 18874368
    s_addc_u32 s65, s23, 0
    s_mov_b32 s66, 3194880
    s_mov_b32 s67, 0x20000
    s_mul_i32 s60, s3, 320
    s_add_u32 s60, s60, 0
    v_add_u32 v206, s60, v1
    v_mul_u32_u24 v207, 3277, v206
    v_lshrrev_b32 v207, 18, v207
    v_mul_u32_u24 v208, 80, v207
    v_sub_u32 v208, v206, v208
    v_and_b32 v209, 7, v207
    v_lshlrev_b32 v209, 1, v209
    v_xor_b32 v208, v208, v209
    v_lshlrev_b32 v208, 4, v208
    v_lshrrev_b32 v209, 4, v207
    v_bfe_u32 v210, v207, 2, 1
    v_bfe_u32 v211, v207, 3, 1
    v_and_b32 v212, 3, v207
    v_lshlrev_b32 v213, 4, v209
    v_lshl_add_u32 v213, v210, 3, v213
    v_lshl_add_u32 v213, v211, 2, v213
    v_add_u32 v213, v213, v212
    v_mul_u32_u24 v213, 1280, v213
    v_add_u32 v180, v213, v208
    v_mul_u32_u24 v213, 20, v209
    v_lshl_add_u32 v213, v210, 2, v213
    v_lshl_add_u32 v213, v211, 3, v213
    v_add_u32 v213, v213, v212
    v_mul_u32_u24 v213, 1280, v213
    v_add_u32 v185, v213, v208
    v_lshl_add_u32 v213, v209, 1, v210
    v_mul_u32_u24 v213, 20, v213
    v_add3_u32 v213, v213, v212, 16
    v_mul_u32_u24 v213, 1280, v213
    v_add_u32 v213, v213, v208
    v_cmp_eq_u32 vcc, 0, v211
    v_mov_b32 v212, 0x40000000
    s_nop 0
    v_cndmask_b32 v190, v212, v213, vcc
    s_mul_i32 s60, s3, 320
    s_add_u32 s60, s60, 64
    v_add_u32 v206, s60, v1
    v_mul_u32_u24 v207, 3277, v206
    v_lshrrev_b32 v207, 18, v207
    v_mul_u32_u24 v208, 80, v207
    v_sub_u32 v208, v206, v208
    v_and_b32 v209, 7, v207
    v_lshlrev_b32 v209, 1, v209
    v_xor_b32 v208, v208, v209
    v_lshlrev_b32 v208, 4, v208
    v_lshrrev_b32 v209, 4, v207
    v_bfe_u32 v210, v207, 2, 1
    v_bfe_u32 v211, v207, 3, 1
    v_and_b32 v212, 3, v207
    v_lshlrev_b32 v213, 4, v209
    v_lshl_add_u32 v213, v210, 3, v213
    v_lshl_add_u32 v213, v211, 2, v213
    v_add_u32 v213, v213, v212
    v_mul_u32_u24 v213, 1280, v213
    v_add_u32 v181, v213, v208
    v_mul_u32_u24 v213, 20, v209
    v_lshl_add_u32 v213, v210, 2, v213
    v_lshl_add_u32 v213, v211, 3, v213
    v_add_u32 v213, v213, v212
    v_mul_u32_u24 v213, 1280, v213
    v_add_u32 v186, v213, v208
    v_lshl_add_u32 v213, v209, 1, v210
    v_mul_u32_u24 v213, 20, v213
    v_add3_u32 v213, v213, v212, 16
    v_mul_u32_u24 v213, 1280, v213
    v_add_u32 v213, v213, v208
    v_cmp_eq_u32 vcc, 0, v211
    v_mov_b32 v212, 0x40000000
    s_nop 0
    v_cndmask_b32 v191, v212, v213, vcc
    s_mul_i32 s60, s3, 320
    s_add_u32 s60, s60, 128
    v_add_u32 v206, s60, v1
    v_mul_u32_u24 v207, 3277, v206
    v_lshrrev_b32 v207, 18, v207
    v_mul_u32_u24 v208, 80, v207
    v_sub_u32 v208, v206, v208
    v_and_b32 v209, 7, v207
    v_lshlrev_b32 v209, 1, v209
    v_xor_b32 v208, v208, v209
    v_lshlrev_b32 v208, 4, v208
    v_lshrrev_b32 v209, 4, v207
    v_bfe_u32 v210, v207, 2, 1
    v_bfe_u32 v211, v207, 3, 1
    v_and_b32 v212, 3, v207
    v_lshlrev_b32 v213, 4, v209
    v_lshl_add_u32 v213, v210, 3, v213
    v_lshl_add_u32 v213, v211, 2, v213
    v_add_u32 v213, v213, v212
    v_mul_u32_u24 v213, 1280, v213
    v_add_u32 v182, v213, v208
    v_mul_u32_u24 v213, 20, v209
    v_lshl_add_u32 v213, v210, 2, v213
    v_lshl_add_u32 v213, v211, 3, v213
    v_add_u32 v213, v213, v212
    v_mul_u32_u24 v213, 1280, v213
    v_add_u32 v187, v213, v208
    v_lshl_add_u32 v213, v209, 1, v210
    v_mul_u32_u24 v213, 20, v213
    v_add3_u32 v213, v213, v212, 16
    v_mul_u32_u24 v213, 1280, v213
    v_add_u32 v213, v213, v208
    v_cmp_eq_u32 vcc, 0, v211
    v_mov_b32 v212, 0x40000000
    s_nop 0
    v_cndmask_b32 v192, v212, v213, vcc
    s_mul_i32 s60, s3, 320
    s_add_u32 s60, s60, 192
    v_add_u32 v206, s60, v1
    v_mul_u32_u24 v207, 3277, v206
    v_lshrrev_b32 v207, 18, v207
    v_mul_u32_u24 v208, 80, v207
    v_sub_u32 v208, v206, v208
    v_and_b32 v209, 7, v207
    v_lshlrev_b32 v209, 1, v209
    v_xor_b32 v208, v208, v209
    v_lshlrev_b32 v208, 4, v208
    v_lshrrev_b32 v209, 4, v207
    v_bfe_u32 v210, v207, 2, 1
    v_bfe_u32 v211, v207, 3, 1
    v_and_b32 v212, 3, v207
    v_lshlrev_b32 v213, 4, v209
    v_lshl_add_u32 v213, v210, 3, v213
    v_lshl_add_u32 v213, v211, 2, v213
    v_add_u32 v213, v213, v212
    v_mul_u32_u24 v213, 1280, v213
    v_add_u32 v183, v213, v208
    v_mul_u32_u24 v213, 20, v209
    v_lshl_add_u32 v213, v210, 2, v213
    v_lshl_add_u32 v213, v211, 3, v213
    v_add_u32 v213, v213, v212
    v_mul_u32_u24 v213, 1280, v213
    v_add_u32 v188, v213, v208
    v_lshl_add_u32 v213, v209, 1, v210
    v_mul_u32_u24 v213, 20, v213
    v_add3_u32 v213, v213, v212, 16
    v_mul_u32_u24 v213, 1280, v213
    v_add_u32 v213, v213, v208
    v_cmp_eq_u32 vcc, 0, v211
    v_mov_b32 v212, 0x40000000
    s_nop 0
    v_cndmask_b32 v193, v212, v213, vcc
    s_mul_i32 s60, s3, 320
    s_add_u32 s60, s60, 256
    v_add_u32 v206, s60, v1
    v_mul_u32_u24 v207, 3277, v206
    v_lshrrev_b32 v207, 18, v207
    v_mul_u32_u24 v208, 80, v207
    v_sub_u32 v208, v206, v208
    v_and_b32 v209, 7, v207
    v_lshlrev_b32 v209, 1, v209
    v_xor_b32 v208, v208, v209
    v_lshlrev_b32 v208, 4, v208
    v_lshrrev_b32 v209, 4, v207
    v_bfe_u32 v210, v207, 2, 1
    v_bfe_u32 v211, v207, 3, 1
    v_and_b32 v212, 3, v207
    v_lshlrev_b32 v213, 4, v209
    v_lshl_add_u32 v213, v210, 3, v213
    v_lshl_add_u32 v213, v211, 2, v213
    v_add_u32 v213, v213, v212
    v_mul_u32_u24 v213, 1280, v213
    v_add_u32 v184, v213, v208
    v_mul_u32_u24 v213, 20, v209
    v_lshl_add_u32 v213, v210, 2, v213
    v_lshl_add_u32 v213, v211, 3, v213
    v_add_u32 v213, v213, v212
    v_mul_u32_u24 v213, 1280, v213
    v_add_u32 v189, v213, v208
    v_lshl_add_u32 v213, v209, 1, v210
    v_mul_u32_u24 v213, 20, v213
    v_add3_u32 v213, v213, v212, 16
    v_mul_u32_u24 v213, 1280, v213
    v_add_u32 v213, v213, v208
    v_cmp_eq_u32 vcc, 0, v211
    v_mov_b32 v212, 0x40000000
    s_nop 0
    v_cndmask_b32 v194, v212, v213, vcc
    v_lshrrev_b32 v206, 4, v1
    v_and_b32 v207, 15, v1
    v_lshrrev_b32 v208, 2, v207
    v_and_b32 v209, 3, v207
    v_and_b32 v210, 1, v206
    v_lshl_add_u32 v210, v210, 2, v208
    v_lshrrev_b32 v206, 1, v206
    v_lshl_add_u32 v206, v206, 4, v210
    v_mul_u32_u24 v206, 1280, v206
    v_lshlrev_b32 v210, 1, v210
    v_lshrrev_b32 v211, 1, v209
    v_and_b32 v209, 1, v209
    v_lshl_add_u32 v206, v209, 3, v206
    v_lshl_add_u32 v206, v211, 4, v206
    s_mul_i32 s60, s3, 10
    s_add_u32 s61, s60, 0
    v_xor_b32 v212, s61, v210
    v_lshl_add_u32 v195, v212, 4, v206
    v_add_u32 v200, 81920, v195
    s_add_u32 s61, s60, 2
    v_xor_b32 v212, s61, v210
    v_lshl_add_u32 v196, v212, 4, v206
    v_add_u32 v201, 81920, v196
    s_add_u32 s61, s60, 4
    v_xor_b32 v212, s61, v210
    v_lshl_add_u32 v197, v212, 4, v206
    v_add_u32 v202, 81920, v197
    s_add_u32 s61, s60, 6
    v_xor_b32 v212, s61, v210
    v_lshl_add_u32 v198, v212, 4, v206
    v_add_u32 v203, 81920, v198
    s_add_u32 s61, s60, 8
    v_xor_b32 v212, s61, v210
    v_lshl_add_u32 v199, v212, 4, v206
    v_add_u32 v204, 81920, v199
    v_lshlrev_b32 v205, 4, v1
    s_add_u32 s47, s44, 0
    s_mul_i32 s60, s3, 5120
    s_add_u32 s60, s60, 0
    s_cmp_lt_u32 s47, 54
    s_cbranch_scc1 rp_26_h
    s_cmp_lt_u32 s47, 70
    s_cbranch_scc1 rp_26_m
    s_sub_u32 s48, s47, 70
    s_mul_i32 s48, s48, 102400
    s_add_u32 m0, s60, 0
    s_nop 0
    buffer_load_dwordx4 v190, s[96:99], s48 offen nt lds
    s_add_u32 m0, s60, 1024
    s_nop 0
    buffer_load_dwordx4 v191, s[96:99], s48 offen nt lds
    s_add_u32 m0, s60, 2048
    s_nop 0
    buffer_load_dwordx4 v192, s[96:99], s48 offen nt lds
    s_add_u32 m0, s60, 3072
    s_nop 0
    buffer_load_dwordx4 v193, s[96:99], s48 offen nt lds
    s_add_u32 m0, s60, 4096
    s_nop 0
    buffer_load_dwordx4 v194, s[96:99], s48 offen nt lds
    s_branch rp_26_e
rp_26_m:
    s_sub_u32 s48, s47, 54
    s_mul_i32 s48, s48, 51200
    s_add_u32 m0, s60, 0
    s_nop 0
    buffer_load_dwordx4 v185, s[96:99], s48 offen nt lds
    s_add_u32 m0, s60, 1024
    s_nop 0
    buffer_load_dwordx4 v186, s[96:99], s48 offen nt lds
    s_add_u32 m0, s60, 2048
    s_nop 0
    buffer_load_dwordx4 v187, s[96:99], s48 offen nt lds
    s_add_u32 m0, s60, 3072
    s_nop 0
    buffer_load_dwordx4 v188, s[96:99], s48 offen nt lds
    s_add_u32 m0, s60, 4096
    s_nop 0
    buffer_load_dwordx4 v189, s[96:99], s48 offen nt lds
    s_branch rp_26_e
rp_26_h:
    s_mul_i32 s48, s47, 40960
    s_add_u32 m0, s60, 0
    s_nop 0
    buffer_load_dwordx4 v180, s[92:95], s48 offen nt lds
    s_add_u32 m0, s60, 1024
    s_nop 0
    buffer_load_dwordx4 v181, s[92:95], s48 offen nt lds
    s_add_u32 m0, s60, 2048
    s_nop 0
    buffer_load_dwordx4 v182, s[92:95], s48 offen nt lds
    s_add_u32 m0, s60, 3072
    s_nop 0
    buffer_load_dwordx4 v183, s[92:95], s48 offen nt lds
    s_add_u32 m0, s60, 4096
    s_nop 0
    buffer_load_dwordx4 v184, s[92:95], s48 offen nt lds
rp_26_e:
    s_add_u32 s47, s44, 16
    s_mul_i32 s60, s3, 5120
    s_add_u32 s60, s60, 40960
    s_cmp_lt_u32 s47, 54
    s_cbranch_scc1 rp_27_h
    s_cmp_lt_u32 s47, 70
    s_cbranch_scc1 rp_27_m
    s_sub_u32 s48, s47, 70
    s_mul_i32 s48, s48, 102400
    s_add_u32 m0, s60, 0
    s_nop 0
    buffer_load_dwordx4 v190, s[96:99], s48 offen nt lds
    s_add_u32 m0, s60, 1024
    s_nop 0
    buffer_load_dwordx4 v191, s[96:99], s48 offen nt lds
    s_add_u32 m0, s60, 2048
    s_nop 0
    buffer_load_dwordx4 v192, s[96:99], s48 offen nt lds
    s_add_u32 m0, s60, 3072
    s_nop 0
    buffer_load_dwordx4 v193, s[96:99], s48 offen nt lds
    s_add_u32 m0, s60, 4096
    s_nop 0
    buffer_load_dwordx4 v194, s[96:99], s48 offen nt lds
    s_branch rp_27_e
rp_27_m:
    s_sub_u32 s48, s47, 54
    s_mul_i32 s48, s48, 51200
    s_add_u32 m0, s60, 0
    s_nop 0
    buffer_load_dwordx4 v185, s[96:99], s48 offen nt lds
    s_add_u32 m0, s60, 1024
    s_nop 0
    buffer_load_dwordx4 v186, s[96:99], s48 offen nt lds
    s_add_u32 m0, s60, 2048
    s_nop 0
    buffer_load_dwordx4 v187, s[96:99], s48 offen nt lds
    s_add_u32 m0, s60, 3072
    s_nop 0
    buffer_load_dwordx4 v188, s[96:99], s48 offen nt lds
    s_add_u32 m0, s60, 4096
    s_nop 0
    buffer_load_dwordx4 v189, s[96:99], s48 offen nt lds
    s_branch rp_27_e
rp_27_h:
    s_mul_i32 s48, s47, 40960
    s_add_u32 m0, s60, 0
    s_nop 0
    buffer_load_dwordx4 v180, s[92:95], s48 offen nt lds
    s_add_u32 m0, s60, 1024
    s_nop 0
    buffer_load_dwordx4 v181, s[92:95], s48 offen nt lds
    s_add_u32 m0, s60, 2048
    s_nop 0
    buffer_load_dwordx4 v182, s[92:95], s48 offen nt lds
    s_add_u32 m0, s60, 3072
    s_nop 0
    buffer_load_dwordx4 v183, s[92:95], s48 offen nt lds
    s_add_u32 m0, s60, 4096
    s_nop 0
    buffer_load_dwordx4 v184, s[92:95], s48 offen nt lds
rp_27_e:
    s_add_u32 s47, s44, 32
    s_mul_i32 s60, s3, 5120
    s_add_u32 s60, s60, 81920
    s_cmp_lt_u32 s47, 54
    s_cbranch_scc1 rp_28_h
    s_cmp_lt_u32 s47, 70
    s_cbranch_scc1 rp_28_m
    s_sub_u32 s48, s47, 70
    s_mul_i32 s48, s48, 102400
    s_add_u32 m0, s60, 0
    s_nop 0
    buffer_load_dwordx4 v190, s[96:99], s48 offen nt lds
    s_add_u32 m0, s60, 1024
    s_nop 0
    buffer_load_dwordx4 v191, s[96:99], s48 offen nt lds
    s_add_u32 m0, s60, 2048
    s_nop 0
    buffer_load_dwordx4 v192, s[96:99], s48 offen nt lds
    s_add_u32 m0, s60, 3072
    s_nop 0
    buffer_load_dwordx4 v193, s[96:99], s48 offen nt lds
    s_add_u32 m0, s60, 4096
    s_nop 0
    buffer_load_dwordx4 v194, s[96:99], s48 offen nt lds
    s_branch rp_28_e
rp_28_m:
    s_sub_u32 s48, s47, 54
    s_mul_i32 s48, s48, 51200
    s_add_u32 m0, s60, 0
    s_nop 0
    buffer_load_dwordx4 v185, s[96:99], s48 offen nt lds
    s_add_u32 m0, s60, 1024
    s_nop 0
    buffer_load_dwordx4 v186, s[96:99], s48 offen nt lds
    s_add_u32 m0, s60, 2048
    s_nop 0
    buffer_load_dwordx4 v187, s[96:99], s48 offen nt lds
    s_add_u32 m0, s60, 3072
    s_nop 0
    buffer_load_dwordx4 v188, s[96:99], s48 offen nt lds
    s_add_u32 m0, s60, 4096
    s_nop 0
    buffer_load_dwordx4 v189, s[96:99], s48 offen nt lds
    s_branch rp_28_e
rp_28_h:
    s_mul_i32 s48, s47, 40960
    s_add_u32 m0, s60, 0
    s_nop 0
    buffer_load_dwordx4 v180, s[92:95], s48 offen nt lds
    s_add_u32 m0, s60, 1024
    s_nop 0
    buffer_load_dwordx4 v181, s[92:95], s48 offen nt lds
    s_add_u32 m0, s60, 2048
    s_nop 0
    buffer_load_dwordx4 v182, s[92:95], s48 offen nt lds
    s_add_u32 m0, s60, 3072
    s_nop 0
    buffer_load_dwordx4 v183, s[92:95], s48 offen nt lds
    s_add_u32 m0, s60, 4096
    s_nop 0
    buffer_load_dwordx4 v184, s[92:95], s48 offen nt lds
rp_28_e:
    s_add_u32 s47, s44, 48
    s_mul_i32 s60, s3, 5120
    s_add_u32 s60, s60, 122880
    s_cmp_lt_u32 s47, 54
    s_cbranch_scc1 rp_29_h
    s_cmp_lt_u32 s47, 70
    s_cbranch_scc1 rp_29_m
    s_sub_u32 s48, s47, 70
    s_mul_i32 s48, s48, 102400
    s_add_u32 m0, s60, 0
    s_nop 0
    buffer_load_dwordx4 v190, s[96:99], s48 offen nt lds
    s_add_u32 m0, s60, 1024
    s_nop 0
    buffer_load_dwordx4 v191, s[96:99], s48 offen nt lds
    s_add_u32 m0, s60, 2048
    s_nop 0
    buffer_load_dwordx4 v192, s[96:99], s48 offen nt lds
    s_add_u32 m0, s60, 3072
    s_nop 0
    buffer_load_dwordx4 v193, s[96:99], s48 offen nt lds
    s_add_u32 m0, s60, 4096
    s_nop 0
    buffer_load_dwordx4 v194, s[96:99], s48 offen nt lds
    s_branch rp_29_e
rp_29_m:
    s_sub_u32 s48, s47, 54
    s_mul_i32 s48, s48, 51200
    s_add_u32 m0, s60, 0
    s_nop 0
    buffer_load_dwordx4 v185, s[96:99], s48 offen nt lds
    s_add_u32 m0, s60, 1024
    s_nop 0
    buffer_load_dwordx4 v186, s[96:99], s48 offen nt lds
    s_add_u32 m0, s60, 2048
    s_nop 0
    buffer_load_dwordx4 v187, s[96:99], s48 offen nt lds
    s_add_u32 m0, s60, 3072
    s_nop 0
    buffer_load_dwordx4 v188, s[96:99], s48 offen nt lds
    s_add_u32 m0, s60, 4096
    s_nop 0
    buffer_load_dwordx4 v189, s[96:99], s48 offen nt lds
    s_branch rp_29_e
rp_29_h:
    s_mul_i32 s48, s47, 40960
    s_add_u32 m0, s60, 0
    s_nop 0
    buffer_load_dwordx4 v180, s[92:95], s48 offen nt lds
    s_add_u32 m0, s60, 1024
    s_nop 0
    buffer_load_dwordx4 v181, s[92:95], s48 offen nt lds
    s_add_u32 m0, s60, 2048
    s_nop 0
    buffer_load_dwordx4 v182, s[92:95], s48 offen nt lds
    s_add_u32 m0, s60, 3072
    s_nop 0
    buffer_load_dwordx4 v183, s[92:95], s48 offen nt lds
    s_add_u32 m0, s60, 4096
    s_nop 0
    buffer_load_dwordx4 v184, s[92:95], s48 offen nt lds
rp_29_e:
    s_waitcnt vmcnt(40)
    v_lshlrev_b32 v40, 16, v8
    v_and_b32 v41, 0xffff0000, v8
    v_lshlrev_b32 v42, 16, v9
    v_and_b32 v43, 0xffff0000, v9
    v_lshlrev_b32 v44, 16, v10
    v_and_b32 v45, 0xffff0000, v10
    v_lshlrev_b32 v46, 16, v11
    v_and_b32 v47, 0xffff0000, v11
    v_lshlrev_b32 v48, 16, v12
    v_and_b32 v49, 0xffff0000, v12
    v_lshlrev_b32 v50, 16, v13
    v_and_b32 v51, 0xffff0000, v13
    v_lshlrev_b32 v52, 16, v14
    v_and_b32 v53, 0xffff0000, v14
    v_lshlrev_b32 v54, 16, v15
    v_and_b32 v55, 0xffff0000, v15
    v_lshlrev_b32 v56, 16, v16
    v_and_b32 v57, 0xffff0000, v16
    v_lshlrev_b32 v58, 16, v17
    v_and_b32 v59, 0xffff0000, v17
    v_lshlrev_b32 v60, 16, v18
    v_and_b32 v61, 0xffff0000, v18
    v_lshlrev_b32 v62, 16, v19
    v_and_b32 v63, 0xffff0000, v19
    v_lshlrev_b32 v64, 16, v20
    v_and_b32 v65, 0xffff0000, v20
    v_lshlrev_b32 v66, 16, v21
    v_and_b32 v67, 0xffff0000, v21
    v_lshlrev_b32 v68, 16, v22
    v_and_b32 v69, 0xffff0000, v22
    v_lshlrev_b32 v70, 16, v23
    v_and_b32 v71, 0xffff0000, v23
    v_lshlrev_b32 v72, 16, v24
    v_and_b32 v73, 0xffff0000, v24
    v_lshlrev_b32 v74, 16, v25
    v_and_b32 v75, 0xffff0000, v25
    v_lshlrev_b32 v76, 16, v26
    v_and_b32 v77, 0xffff0000, v26
    v_lshlrev_b32 v78, 16, v27
    v_and_b32 v79, 0xffff0000, v27
    v_mov_b32 v37, 0
    s_waitcnt vmcnt(35)
    v_mov_b32 v30, 0
    v_mov_b32 v31, 0
    v_lshlrev_b32 v32, 16, v100
    v_and_b32 v33, 0xffff0000, v100
    v_fmac_f32 v30, v32, v40
    v_fmac_f32 v31, v33, v41
    v_lshlrev_b32 v32, 16, v101
    v_and_b32 v33, 0xffff0000, v101
    v_fmac_f32 v30, v32, v42
    v_fmac_f32 v31, v33, v43
    v_lshlrev_b32 v32, 16, v102
    v_and_b32 v33, 0xffff0000, v102
    v_fmac_f32 v30, v32, v44
    v_fmac_f32 v31, v33, v45
    v_lshlrev_b32 v32, 16, v103
    v_and_b32 v33, 0xffff0000, v103
    v_fmac_f32 v30, v32, v46
    v_fmac_f32 v31, v33, v47
    v_lshlrev_b32 v32, 16, v104
    v_and_b32 v33, 0xffff0000, v104
    v_fmac_f32 v30, v32, v48
    v_fmac_f32 v31, v33, v49
    v_lshlrev_b32 v32, 16, v105
    v_and_b32 v33, 0xffff0000, v105
    v_fmac_f32 v30, v32, v50
    v_fmac_f32 v31, v33, v51
    v_lshlrev_b32 v32, 16, v106
    v_and_b32 v33, 0xffff0000, v106
    v_fmac_f32 v30, v32, v52
    v_fmac_f32 v31, v33, v53
    v_lshlrev_b32 v32, 16, v107
    v_and_b32 v33, 0xffff0000, v107
    v_fmac_f32 v30, v32, v54
    v_fmac_f32 v31, v33, v55
    v_lshlrev_b32 v32, 16, v108
    v_and_b32 v33, 0xffff0000, v108
    v_fmac_f32 v30, v32, v56
    v_fmac_f32 v31, v33, v57
    v_lshlrev_b32 v32, 16, v109
    v_and_b32 v33, 0xffff0000, v109
    v_fmac_f32 v30, v32, v58
    v_fmac_f32 v31, v33, v59
    v_lshlrev_b32 v32, 16, v110
    v_and_b32 v33, 0xffff0000, v110
    v_fmac_f32 v30, v32, v60
    v_fmac_f32 v31, v33, v61
    v_lshlrev_b32 v32, 16, v111
    v_and_b32 v33, 0xffff0000, v111
    v_fmac_f32 v30, v32, v62
    v_fmac_f32 v31, v33, v63
    v_lshlrev_b32 v32, 16, v112
    v_and_b32 v33, 0xffff0000, v112
    v_fmac_f32 v30, v32, v64
    v_fmac_f32 v31, v33, v65
    v_lshlrev_b32 v32, 16, v113
    v_and_b32 v33, 0xffff0000, v113
    v_fmac_f32 v30, v32, v66
    v_fmac_f32 v31, v33, v67
    v_lshlrev_b32 v32, 16, v114
    v_and_b32 v33, 0xffff0000, v114
    v_fmac_f32 v30, v32, v68
    v_fmac_f32 v31, v33, v69
    v_lshlrev_b32 v32, 16, v115
    v_and_b32 v33, 0xffff0000, v115
    v_fmac_f32 v30, v32, v70
    v_fmac_f32 v31, v33, v71
    v_lshlrev_b32 v32, 16, v116
    v_and_b32 v33, 0xffff0000, v116
    v_fmac_f32 v30, v32, v72
    v_fmac_f32 v31, v33, v73
    v_lshlrev_b32 v32, 16, v117
    v_and_b32 v33, 0xffff0000, v117
    v_fmac_f32 v30, v32, v74
    v_fmac_f32 v31, v33, v75
    v_lshlrev_b32 v32, 16, v118
    v_and_b32 v33, 0xffff0000, v118
    v_fmac_f32 v30, v32, v76
    v_fmac_f32 v31, v33, v77
    v_lshlrev_b32 v32, 16, v119
    v_and_b32 v33, 0xffff0000, v119
    v_fmac_f32 v30, v32, v78
    v_fmac_f32 v31, v33, v79
    v_add_f32 v30, v30, v31
    s_nop 1
    v_add_f32_dpp v30, v30, v30 row_ror:8 row_mask:0xf bank_mask:0xf
    s_nop 1
    v_add_f32_dpp v30, v30, v30 row_ror:4 row_mask:0xf bank_mask:0xf
    s_nop 1
    v_add_f32_dpp v30, v30, v30 row_ror:2 row_mask:0xf bank_mask:0xf
    s_nop 1
    v_add_f32_dpp v30, v30, v30 row_ror:1 row_mask:0xf bank_mask:0xf
    v_cmp_eq_u32 vcc, 0, v2
    s_nop 1
    v_cndmask_b32 v37, v37, v30, vcc
    s_waitcnt vmcnt(30)
    v_mov_b32 v30, 0
    v_mov_b32 v31, 0
    v_lshlrev_b32 v32, 16, v120
    v_and_b32 v33, 0xffff0000, v120
    v_fmac_f32 v30, v32, v40
    v_fmac_f32 v31, v33, v41
    v_lshlrev_b32 v32, 16, v121
    v_and_b32 v33, 0xffff0000, v121
    v_fmac_f32 v30, v32, v42
    v_fmac_f32 v31, v33, v43
    v_lshlrev_b32 v32, 16, v122
    v_and_b32 v33, 0xffff0000, v122
    v_fmac_f32 v30, v32, v44
    v_fmac_f32 v31, v33, v45
    v_lshlrev_b32 v32, 16, v123
    v_and_b32 v33, 0xffff0000, v123
    v_fmac_f32 v30, v32, v46
    v_fmac_f32 v31, v33, v47
    v_lshlrev_b32 v32, 16, v124
    v_and_b32 v33, 0xffff0000, v124
    v_fmac_f32 v30, v32, v48
    v_fmac_f32 v31, v33, v49
    v_lshlrev_b32 v32, 16, v125
    v_and_b32 v33, 0xffff0000, v125
    v_fmac_f32 v30, v32, v50
    v_fmac_f32 v31, v33, v51
    v_lshlrev_b32 v32, 16, v126
    v_and_b32 v33, 0xffff0000, v126
    v_fmac_f32 v30, v32, v52
    v_fmac_f32 v31, v33, v53
    v_lshlrev_b32 v32, 16, v127
    v_and_b32 v33, 0xffff0000, v127
    v_fmac_f32 v30, v32, v54
    v_fmac_f32 v31, v33, v55
    v_lshlrev_b32 v32, 16, v128
    v_and_b32 v33, 0xffff0000, v128
    v_fmac_f32 v30, v32, v56
    v_fmac_f32 v31, v33, v57
    v_lshlrev_b32 v32, 16, v129
    v_and_b32 v33, 0xffff0000, v129
    v_fmac_f32 v30, v32, v58
    v_fmac_f32 v31, v33, v59
    v_lshlrev_b32 v32, 16, v130
    v_and_b32 v33, 0xffff0000, v130
    v_fmac_f32 v30, v32, v60
    v_fmac_f32 v31, v33, v61
    v_lshlrev_b32 v32, 16, v131
    v_and_b32 v33, 0xffff0000, v131
    v_fmac_f32 v30, v32, v62
    v_fmac_f32 v31, v33, v63
    v_lshlrev_b32 v32, 16, v132
    v_and_b32 v33, 0xffff0000, v132
    v_fmac_f32 v30, v32, v64
    v_fmac_f32 v31, v33, v65
    v_lshlrev_b32 v32, 16, v133
    v_and_b32 v33, 0xffff0000, v133
    v_fmac_f32 v30, v32, v66
    v_fmac_f32 v31, v33, v67
    v_lshlrev_b32 v32, 16, v134
    v_and_b32 v33, 0xffff0000, v134
    v_fmac_f32 v30, v32, v68
    v_fmac_f32 v31, v33, v69
    v_lshlrev_b32 v32, 16, v135
    v_and_b32 v33, 0xffff0000, v135
    v_fmac_f32 v30, v32, v70
    v_fmac_f32 v31, v33, v71
    v_lshlrev_b32 v32, 16, v136
    v_and_b32 v33, 0xffff0000, v136
    v_fmac_f32 v30, v32, v72
    v_fmac_f32 v31, v33, v73
    v_lshlrev_b32 v32, 16, v137
    v_and_b32 v33, 0xffff0000, v137
    v_fmac_f32 v30, v32, v74
    v_fmac_f32 v31, v33, v75
    v_lshlrev_b32 v32, 16, v138
    v_and_b32 v33, 0xffff0000, v138
    v_fmac_f32 v30, v32, v76
    v_fmac_f32 v31, v33, v77
    v_lshlrev_b32 v32, 16, v139
    v_and_b32 v33, 0xffff0000, v139
    v_fmac_f32 v30, v32, v78
    v_fmac_f32 v31, v33, v79
    v_add_f32 v30, v30, v31
    s_nop 1
    v_add_f32_dpp v30, v30, v30 row_ror:8 row_mask:0xf bank_mask:0xf
    s_nop 1
    v_add_f32_dpp v30, v30, v30 row_ror:4 row_mask:0xf bank_mask:0xf
    s_nop 1
    v_add_f32_dpp v30, v30, v30 row_ror:2 row_mask:0xf bank_mask:0xf
    s_nop 1
    v_add_f32_dpp v30, v30, v30 row_ror:1 row_mask:0xf bank_mask:0xf
    v_cmp_eq_u32 vcc, 1, v2
    s_nop 1
    v_cndmask_b32 v37, v37, v30, vcc
    s_waitcnt vmcnt(25)
    v_mov_b32 v30, 0
    v_mov_b32 v31, 0
    v_lshlrev_b32 v32, 16, v140
    v_and_b32 v33, 0xffff0000, v140
    v_fmac_f32 v30, v32, v40
    v_fmac_f32 v31, v33, v41
    v_lshlrev_b32 v32, 16, v141
    v_and_b32 v33, 0xffff0000, v141
    v_fmac_f32 v30, v32, v42
    v_fmac_f32 v31, v33, v43
    v_lshlrev_b32 v32, 16, v142
    v_and_b32 v33, 0xffff0000, v142
    v_fmac_f32 v30, v32, v44
    v_fmac_f32 v31, v33, v45
    v_lshlrev_b32 v32, 16, v143
    v_and_b32 v33, 0xffff0000, v143
    v_fmac_f32 v30, v32, v46
    v_fmac_f32 v31, v33, v47
    v_lshlrev_b32 v32, 16, v144
    v_and_b32 v33, 0xffff0000, v144
    v_fmac_f32 v30, v32, v48
    v_fmac_f32 v31, v33, v49
    v_lshlrev_b32 v32, 16, v145
    v_and_b32 v33, 0xffff0000, v145
    v_fmac_f32 v30, v32, v50
    v_fmac_f32 v31, v33, v51
    v_lshlrev_b32 v32, 16, v146
    v_and_b32 v33, 0xffff0000, v146
    v_fmac_f32 v30, v32, v52
    v_fmac_f32 v31, v33, v53
    v_lshlrev_b32 v32, 16, v147
    v_and_b32 v33, 0xffff0000, v147
    v_fmac_f32 v30, v32, v54
    v_fmac_f32 v31, v33, v55
    v_lshlrev_b32 v32, 16, v148
    v_and_b32 v33, 0xffff0000, v148
    v_fmac_f32 v30, v32, v56
    v_fmac_f32 v31, v33, v57
    v_lshlrev_b32 v32, 16, v149
    v_and_b32 v33, 0xffff0000, v149
    v_fmac_f32 v30, v32, v58
    v_fmac_f32 v31, v33, v59
    v_lshlrev_b32 v32, 16, v150
    v_and_b32 v33, 0xffff0000, v150
    v_fmac_f32 v30, v32, v60
    v_fmac_f32 v31, v33, v61
    v_lshlrev_b32 v32, 16, v151
    v_and_b32 v33, 0xffff0000, v151
    v_fmac_f32 v30, v32, v62
    v_fmac_f32 v31, v33, v63
    v_lshlrev_b32 v32, 16, v152
    v_and_b32 v33, 0xffff0000, v152
    v_fmac_f32 v30, v32, v64
    v_fmac_f32 v31, v33, v65
    v_lshlrev_b32 v32, 16, v153
    v_and_b32 v33, 0xffff0000, v153
    v_fmac_f32 v30, v32, v66
    v_fmac_f32 v31, v33, v67
    v_lshlrev_b32 v32, 16, v154
    v_and_b32 v33, 0xffff0000, v154
    v_fmac_f32 v30, v32, v68
    v_fmac_f32 v31, v33, v69
    v_lshlrev_b32 v32, 16, v155
    v_and_b32 v33, 0xffff0000, v155
    v_fmac_f32 v30, v32, v70
    v_fmac_f32 v31, v33, v71
    v_lshlrev_b32 v32, 16, v156
    v_and_b32 v33, 0xffff0000, v156
    v_fmac_f32 v30, v32, v72
    v_fmac_f32 v31, v33, v73
    v_lshlrev_b32 v32, 16, v157
    v_and_b32 v33, 0xffff0000, v157
    v_fmac_f32 v30, v32, v74
    v_fmac_f32 v31, v33, v75
    v_lshlrev_b32 v32, 16, v158
    v_and_b32 v33, 0xffff0000, v158
    v_fmac_f32 v30, v32, v76
    v_fmac_f32 v31, v33, v77
    v_lshlrev_b32 v32, 16, v159
    v_and_b32 v33, 0xffff0000, v159
    v_fmac_f32 v30, v32, v78
    v_fmac_f32 v31, v33, v79
    v_add_f32 v30, v30, v31
    s_nop 1
    v_add_f32_dpp v30, v30, v30 row_ror:8 row_mask:0xf bank_mask:0xf
    s_nop 1
    v_add_f32_dpp v30, v30, v30 row_ror:4 row_mask:0xf bank_mask:0xf
    s_nop 1
    v_add_f32_dpp v30, v30, v30 row_ror:2 row_mask:0xf bank_mask:0xf
    s_nop 1
    v_add_f32_dpp v30, v30, v30 row_ror:1 row_mask:0xf bank_mask:0xf
    v_cmp_eq_u32 vcc, 2, v2
    s_nop 1
    v_cndmask_b32 v37, v37, v30, vcc
    s_waitcnt vmcnt(20)
    v_mov_b32 v30, 0
    v_mov_b32 v31, 0
    v_lshlrev_b32 v32, 16, v160
    v_and_b32 v33, 0xffff0000, v160
    v_fmac_f32 v30, v32, v40
    v_fmac_f32 v31, v33, v41
    v_lshlrev_b32 v32, 16, v161
    v_and_b32 v33, 0xffff0000, v161
    v_fmac_f32 v30, v32, v42
    v_fmac_f32 v31, v33, v43
    v_lshlrev_b32 v32, 16, v162
    v_and_b32 v33, 0xffff0000, v162
    v_fmac_f32 v30, v32, v44
    v_fmac_f32 v31, v33, v45
    v_lshlrev_b32 v32, 16, v163
    v_and_b32 v33, 0xffff0000, v163
    v_fmac_f32 v30, v32, v46
    v_fmac_f32 v31, v33, v47
    v_lshlrev_b32 v32, 16, v164
    v_and_b32 v33, 0xffff0000, v164
    v_fmac_f32 v30, v32, v48
    v_fmac_f32 v31, v33, v49
    v_lshlrev_b32 v32, 16, v165
    v_and_b32 v33, 0xffff0000, v165
    v_fmac_f32 v30, v32, v50
    v_fmac_f32 v31, v33, v51
    v_lshlrev_b32 v32, 16, v166
    v_and_b32 v33, 0xffff0000, v166
    v_fmac_f32 v30, v32, v52
    v_fmac_f32 v31, v33, v53
    v_lshlrev_b32 v32, 16, v167
    v_and_b32 v33, 0xffff0000, v167
    v_fmac_f32 v30, v32, v54
    v_fmac_f32 v31, v33, v55
    v_lshlrev_b32 v32, 16, v168
    v_and_b32 v33, 0xffff0000, v168
    v_fmac_f32 v30, v32, v56
    v_fmac_f32 v31, v33, v57
    v_lshlrev_b32 v32, 16, v169
    v_and_b32 v33, 0xffff0000, v169
    v_fmac_f32 v30, v32, v58
    v_fmac_f32 v31, v33, v59
    v_lshlrev_b32 v32, 16, v170
    v_and_b32 v33, 0xffff0000, v170
    v_fmac_f32 v30, v32, v60
    v_fmac_f32 v31, v33, v61
    v_lshlrev_b32 v32, 16, v171
    v_and_b32 v33, 0xffff0000, v171
    v_fmac_f32 v30, v32, v62
    v_fmac_f32 v31, v33, v63
    v_lshlrev_b32 v32, 16, v172
    v_and_b32 v33, 0xffff0000, v172
    v_fmac_f32 v30, v32, v64
    v_fmac_f32 v31, v33, v65
    v_lshlrev_b32 v32, 16, v173
    v_and_b32 v33, 0xffff0000, v173
    v_fmac_f32 v30, v32, v66
    v_fmac_f32 v31, v33, v67
    v_lshlrev_b32 v32, 16, v174
    v_and_b32 v33, 0xffff0000, v174
    v_fmac_f32 v30, v32, v68
    v_fmac_f32 v31, v33, v69
    v_lshlrev_b32 v32, 16, v175
    v_and_b32 v33, 0xffff0000, v175
    v_fmac_f32 v30, v32, v70
    v_fmac_f32 v31, v33, v71
    v_lshlrev_b32 v32, 16, v176
    v_and_b32 v33, 0xffff0000, v176
    v_fmac_f32 v30, v32, v72
    v_fmac_f32 v31, v33, v73
    v_lshlrev_b32 v32, 16, v177
    v_and_b32 v33, 0xffff0000, v177
    v_fmac_f32 v30, v32, v74
    v_fmac_f32 v31, v33, v75
    v_lshlrev_b32 v32, 16, v178
    v_and_b32 v33, 0xffff0000, v178
    v_fmac_f32 v30, v32, v76
    v_fmac_f32 v31, v33, v77
    v_lshlrev_b32 v32, 16, v179
    v_and_b32 v33, 0xffff0000, v179
    v_fmac_f32 v30, v32, v78
    v_fmac_f32 v31, v33, v79
    v_add_f32 v30, v30, v31
    s_nop 1
    v_add_f32_dpp v30, v30, v30 row_ror:8 row_mask:0xf bank_mask:0xf
    s_nop 1
    v_add_f32_dpp v30, v30, v30 row_ror:4 row_mask:0xf bank_mask:0xf
    s_nop 1
    v_add_f32_dpp v30, v30, v30 row_ror:2 row_mask:0xf bank_mask:0xf
    s_nop 1
    v_add_f32_dpp v30, v30, v30 row_ror:1 row_mask:0xf bank_mask:0xf
    v_cmp_eq_u32 vcc, 3, v2
    s_nop 1
    v_cndmask_b32 v37, v37, v30, vcc
    v_cvt_pk_bf16_f32 v31, v37, v37
    v_lshlrev_b32 v30, 16, v31
    v_mul_f32 v30, 0xbfb8aa3b, v30
    v_exp_f32 v30, v30
    s_nop 0
    v_add_f32 v30, 1.0, v30
    v_rcp_f32 v30, v30
    s_nop 0
    v_cvt_pk_bf16_f32 v31, v30, v30
    v_lshlrev_b32 v34, 16, v31
    v_sub_f32 v35, 1.0, v34
    v_cvt_pk_bf16_f32 v31, v35, v35
    v_lshlrev_b32 v35, 16, v31
    v_lshl_add_u32 v36, v2, 2, v3
    v_add_u32 v36, s51, v36
    v_lshlrev_b32 v36, 3, v36
    v_cmp_gt_u32 vcc, 4, v2
    s_and_saveexec_b64 s[62:63], vcc
    buffer_store_dwordx2 v[34:35], v36, s[40:43], 0 offen sc1
    s_mov_b64 exec, s[62:63]
    s_waitcnt vmcnt(0)
    s_barrier
    s_cmp_lg_u32 s3, 0
    s_cbranch_scc1 sig_30
    s_mov_b32 s26, 0x40000
sig_30_p:
    v_readfirstlane_b32 s27, v7
    s_sub_u32 s26, s26, 1
    s_cmp_eq_u32 s26, 0
    s_cbranch_scc1 sig_30_go
    s_cmp_lg_u32 s27, 0
    s_cbranch_scc1 sig_30_go
    v_mov_b32 v7, 0
    global_load_dword v7, v7, s[20:21] sc1
    s_waitcnt vmcnt(0)
    s_branch sig_30_p
sig_30_go:
    s_mov_b64 s[24:25], exec
    s_mov_b64 exec, 255
    v_add_u32 v8, 0, v1
    v_lshlrev_b32 v8, 8, v8
    v_add_u32 v8, 8126464, v8
    v_mov_b32 v9, 1
    global_atomic_add v8, v9, s[22:23]
    s_mov_b64 exec, s[24:25]
sig_30:
    ds_read_b64_tr_b16 v[216:217], v195 offset:0
    ds_read_b64_tr_b16 v[218:219], v195 offset:10240
    ds_read_b64_tr_b16 v[220:221], v196 offset:0
    ds_read_b64_tr_b16 v[222:223], v196 offset:10240
    ds_read_b64_tr_b16 v[224:225], v197 offset:0
    ds_read_b64_tr_b16 v[226:227], v197 offset:10240
    ds_read_b64_tr_b16 v[228:229], v198 offset:0
    ds_read_b64_tr_b16 v[230:231], v198 offset:10240
    ds_read_b64_tr_b16 v[232:233], v199 offset:0
    ds_read_b64_tr_b16 v[234:235], v199 offset:10240
    s_add_u32 s61, s44, 0
    s_mul_i32 s61, s61, 40960
    s_mul_i32 s62, s3, 5120
    s_add_u32 s61, s61, s62
    s_waitcnt lgkmcnt(0)
    buffer_store_dwordx4 v[216:219], v205, s[64:67], s61 offen offset:0 sc1
    buffer_store_dwordx4 v[220:223], v205, s[64:67], s61 offen offset:1024 sc1
    buffer_store_dwordx4 v[224:227], v205, s[64:67], s61 offen offset:2048 sc1
    buffer_store_dwordx4 v[228:231], v205, s[64:67], s61 offen offset:3072 sc1
    s_add_u32 s61, s61, 4096
    buffer_store_dwordx4 v[232:235], v205, s[64:67], s61 offen offset:0 sc1
    s_barrier
    s_add_u32 s47, s44, 64
    s_cmp_ge_u32 s47, 78
    s_cbranch_scc1 rp5_31
    s_mul_i32 s60, s3, 5120
    s_add_u32 s60, s60, 0
    s_cmp_lt_u32 s47, 54
    s_cbranch_scc1 rp_32_h
    s_cmp_lt_u32 s47, 70
    s_cbranch_scc1 rp_32_m
    s_sub_u32 s48, s47, 70
    s_mul_i32 s48, s48, 102400
    s_add_u32 m0, s60, 0
    s_nop 0
    buffer_load_dwordx4 v190, s[96:99], s48 offen nt lds
    s_add_u32 m0, s60, 1024
    s_nop 0
    buffer_load_dwordx4 v191, s[96:99], s48 offen nt lds
    s_add_u32 m0, s60, 2048
    s_nop 0
    buffer_load_dwordx4 v192, s[96:99], s48 offen nt lds
    s_add_u32 m0, s60, 3072
    s_nop 0
    buffer_load_dwordx4 v193, s[96:99], s48 offen nt lds
    s_add_u32 m0, s60, 4096
    s_nop 0
    buffer_load_dwordx4 v194, s[96:99], s48 offen nt lds
    s_branch rp_32_e
rp_32_m:
    s_sub_u32 s48, s47, 54
    s_mul_i32 s48, s48, 51200
    s_add_u32 m0, s60, 0
    s_nop 0
    buffer_load_dwordx4 v185, s[96:99], s48 offen nt lds
    s_add_u32 m0, s60, 1024
    s_nop 0
    buffer_load_dwordx4 v186, s[96:99], s48 offen nt lds
    s_add_u32 m0, s60, 2048
    s_nop 0
    buffer_load_dwordx4 v187, s[96:99], s48 offen nt lds
    s_add_u32 m0, s60, 3072
    s_nop 0
    buffer_load_dwordx4 v188, s[96:99], s48 offen nt lds
    s_add_u32 m0, s60, 4096
    s_nop 0
    buffer_load_dwordx4 v189, s[96:99], s48 offen nt lds
    s_branch rp_32_e
rp_32_h:
    s_mul_i32 s48, s47, 40960
    s_add_u32 m0, s60, 0
    s_nop 0
    buffer_load_dwordx4 v180, s[92:95], s48 offen nt lds
    s_add_u32 m0, s60, 1024
    s_nop 0
    buffer_load_dwordx4 v181, s[92:95], s48 offen nt lds
    s_add_u32 m0, s60, 2048
    s_nop 0
    buffer_load_dwordx4 v182, s[92:95], s48 offen nt lds
    s_add_u32 m0, s60, 3072
    s_nop 0
    buffer_load_dwordx4 v183, s[92:95], s48 offen nt lds
    s_add_u32 m0, s60, 4096
    s_nop 0
    buffer_load_dwordx4 v184, s[92:95], s48 offen nt lds
rp_32_e:
rp5_31:
    ds_read_b64_tr_b16 v[236:237], v195 offset:40960
    ds_read_b64_tr_b16 v[238:239], v195 offset:51200
    ds_read_b64_tr_b16 v[240:241], v196 offset:40960
    ds_read_b64_tr_b16 v[242:243], v196 offset:51200
    ds_read_b64_tr_b16 v[244:245], v197 offset:40960
    ds_read_b64_tr_b16 v[246:247], v197 offset:51200
    ds_read_b64_tr_b16 v[248:249], v198 offset:40960
    ds_read_b64_tr_b16 v[250:251], v198 offset:51200
    ds_read_b64_tr_b16 v[252:253], v199 offset:40960
    ds_read_b64_tr_b16 v[254:255], v199 offset:51200
    s_add_u32 s61, s44, 16
    s_mul_i32 s61, s61, 40960
    s_mul_i32 s62, s3, 5120
    s_add_u32 s61, s61, s62
    s_waitcnt lgkmcnt(0)
    buffer_store_dwordx4 v[236:239], v205, s[64:67], s61 offen offset:0 sc1
    buffer_store_dwordx4 v[240:243], v205, s[64:67], s61 offen offset:1024 sc1
    buffer_store_dwordx4 v[244:247], v205, s[64:67], s61 offen offset:2048 sc1
    buffer_store_dwordx4 v[248:251], v205, s[64:67], s61 offen offset:3072 sc1
    s_add_u32 s61, s61, 4096
    buffer_store_dwordx4 v[252:255], v205, s[64:67], s61 offen offset:0 sc1
    ds_read_b64_tr_b16 v[216:217], v200 offset:0
    ds_read_b64_tr_b16 v[218:219], v200 offset:10240
    ds_read_b64_tr_b16 v[220:221], v201 offset:0
    ds_read_b64_tr_b16 v[222:223], v201 offset:10240
    ds_read_b64_tr_b16 v[224:225], v202 offset:0
    ds_read_b64_tr_b16 v[226:227], v202 offset:10240
    ds_read_b64_tr_b16 v[228:229], v203 offset:0
    ds_read_b64_tr_b16 v[230:231], v203 offset:10240
    ds_read_b64_tr_b16 v[232:233], v204 offset:0
    ds_read_b64_tr_b16 v[234:235], v204 offset:10240
    s_add_u32 s61, s44, 32
    s_mul_i32 s61, s61, 40960
    s_mul_i32 s62, s3, 5120
    s_add_u32 s61, s61, s62
    s_waitcnt lgkmcnt(0)
    buffer_store_dwordx4 v[216:219], v205, s[64:67], s61 offen offset:0 sc1
    buffer_store_dwordx4 v[220:223], v205, s[64:67], s61 offen offset:1024 sc1
    buffer_store_dwordx4 v[224:227], v205, s[64:67], s61 offen offset:2048 sc1
    buffer_store_dwordx4 v[228:231], v205, s[64:67], s61 offen offset:3072 sc1
    s_add_u32 s61, s61, 4096
    buffer_store_dwordx4 v[232:235], v205, s[64:67], s61 offen offset:0 sc1
    ds_read_b64_tr_b16 v[236:237], v200 offset:40960
    ds_read_b64_tr_b16 v[238:239], v200 offset:51200
    ds_read_b64_tr_b16 v[240:241], v201 offset:40960
    ds_read_b64_tr_b16 v[242:243], v201 offset:51200
    ds_read_b64_tr_b16 v[244:245], v202 offset:40960
    ds_read_b64_tr_b16 v[246:247], v202 offset:51200
    ds_read_b64_tr_b16 v[248:249], v203 offset:40960
    ds_read_b64_tr_b16 v[250:251], v203 offset:51200
    ds_read_b64_tr_b16 v[252:253], v204 offset:40960
    ds_read_b64_tr_b16 v[254:255], v204 offset:51200
    s_add_u32 s61, s44, 48
    s_mul_i32 s61, s61, 40960
    s_mul_i32 s62, s3, 5120
    s_add_u32 s61, s61, s62
    s_waitcnt lgkmcnt(0)
    buffer_store_dwordx4 v[236:239], v205, s[64:67], s61 offen offset:0 sc1
    buffer_store_dwordx4 v[240:243], v205, s[64:67], s61 offen offset:1024 sc1
    buffer_store_dwordx4 v[244:247], v205, s[64:67], s61 offen offset:2048 sc1
    buffer_store_dwordx4 v[248:251], v205, s[64:67], s61 offen offset:3072 sc1
    s_add_u32 s61, s61, 4096
    buffer_store_dwordx4 v[252:255], v205, s[64:67], s61 offen offset:0 sc1
    s_cmp_ge_u32 s47, 78
    s_cbranch_scc1 rp5_31_d
    s_waitcnt vmcnt(0)
    s_barrier
    ds_read_b64_tr_b16 v[216:217], v195 offset:0
    ds_read_b64_tr_b16 v[218:219], v195 offset:10240
    ds_read_b64_tr_b16 v[220:221], v196 offset:0
    ds_read_b64_tr_b16 v[222:223], v196 offset:10240
    ds_read_b64_tr_b16 v[224:225], v197 offset:0
    ds_read_b64_tr_b16 v[226:227], v197 offset:10240
    ds_read_b64_tr_b16 v[228:229], v198 offset:0
    ds_read_b64_tr_b16 v[230:231], v198 offset:10240
    ds_read_b64_tr_b16 v[232:233], v199 offset:0
    ds_read_b64_tr_b16 v[234:235], v199 offset:10240
    s_add_u32 s61, s44, 64
    s_mul_i32 s61, s61, 40960
    s_mul_i32 s62, s3, 5120
    s_add_u32 s61, s61, s62
    s_waitcnt lgkmcnt(0)
    buffer_store_dwordx4 v[216:219], v205, s[64:67], s61 offen offset:0 sc1
    buffer_store_dwordx4 v[220:223], v205, s[64:67], s61 offen offset:1024 sc1
    buffer_store_dwordx4 v[224:227], v205, s[64:67], s61 offen offset:2048 sc1
    buffer_store_dwordx4 v[228:231], v205, s[64:67], s61 offen offset:3072 sc1
    s_add_u32 s61, s61, 4096
    buffer_store_dwordx4 v[232:235], v205, s[64:67], s61 offen offset:0 sc1
rp5_31_d:
    s_barrier
    s_mov_b32 s54, 24
    v_mov_b32 v99, 1
    s_mov_b32 s47, 0
    s_branch after_p1
after_p1:
    s_and_b32 s61, s2, 7
    s_lshr_b32 s60, s2, 3
    s_and_b32 s44, s60, 3
    s_lshl_b32 s61, s61, 2
    s_add_u32 s44, s44, s61
    s_lshr_b32 s45, s60, 2
    s_mul_i32 s50, s44, 163840
    s_mov_b32 s28, s22
    s_mov_b32 s29, s23
    s_mov_b32 s30, 2621440
    s_mov_b32 s31, 0x20000
    s_add_u32 s32, s22, 2621440
    s_addc_u32 s33, s23, 0
    s_mov_b32 s34, 5242880
    s_mov_b32 s35, 0x20000
    s_add_u32 s36, s22, 7864320
    s_addc_u32 s37, s23, 0
    s_mov_b32 s38, 16384
    s_mov_b32 s39, 0x20000
    s_add_u32 s40, s22, 8388608
    s_addc_u32 s41, s23, 0
    s_mov_b32 s42, 3145728
    s_mov_b32 s43, 0x20000
    s_and_b32 s60, s2, 7
    s_lshr_b32 s61, s2, 3
    s_lshr_b32 s53, s60, 1
    s_lshl_b32 s53, s53, 3
    s_lshr_b32 s62, s61, 2
    s_add_u32 s53, s53, s62
    s_and_b32 s56, s60, 1
    s_lshl_b32 s56, s56, 2
    s_and_b32 s62, s61, 3
    s_add_u32 s56, s56, s62
    s_add_u32 s64, s22, 11534336
    s_addc_u32 s65, s23, 0
    s_mov_b32 s66, 7077888
    s_mov_b32 s67, 0x20000
    s_add_u32 s92, s22, 18874368
    s_addc_u32 s93, s23, 0
    s_mov_b32 s94, 2211840
    s_mov_b32 s95, 0x20000
    s_add_u32 s68, s22, 8388608
    s_addc_u32 s69, s23, 0
    s_mov_b32 s70, 3145728
    s_mov_b32 s71, 0x20000
    s_add_u32 s96, s22, 21086208
    s_addc_u32 s97, s23, 0
    s_mov_b32 s98, 983040
    s_mov_b32 s99, 0x20000
    v_and_b32 v245, 15, v1
    v_lshrrev_b32 v246, 4, v1
    s_lshl_b32 s60, s53, 6
    v_add_u32 v247, s60, v245
    v_lshrrev_b32 v248, 1, v246
    v_and_b32 v249, 1, v246
    v_lshlrev_b32 v250, 16, v248
    v_lshl_add_u32 v250, v247, 5, v250
    v_lshl_add_u32 v236, v249, 4, v250
    s_lshl_b32 s60, s53, 1
    s_mul_i32 s60, s60, 1536
    v_lshlrev_b32 v250, 4, v245
    v_add_u32 v250, s60, v250
    s_mov_b32 s61, 98304
    v_mul_lo_u32 v251, v248, s61
    v_lshl_add_u32 v251, v249, 9, v251
    v_add_u32 v237, v251, v250
    v_mul_lo_u32 v251, v246, s61
    v_add3_u32 v238, v251, v250, 0
    v_add_u32 v238, 1024, v238
    v_lshlrev_b32 v239, 4, v1
    s_mul_i32 s60, s56, 5120
    v_add_u32 v239, s60, v239
    v_add_u32 v240, 4096, v239
    v_add_u32 v252, 512, v236
    v_add_u32 v253, 1024, v236
    v_add_u32 v254, 1536, v236
    s_mov_b32 s57, 0
    v_lshlrev_b32 v94, 4, v1
    v_and_b32 v2, 31, v1
    v_lshrrev_b32 v3, 5, v1
    v_lshlrev_b32 v88, 4, v1
    v_lshlrev_b32 v89, 3, v2
    v_add_u32 v89, 1024, v89
    v_lshrrev_b32 v95, 4, v2
    v_xor_b32 v95, v95, v3
    v_lshl_add_u32 v95, v2, 1, v95
    v_lshlrev_b32 v90, 4, v95
    v_add_u32 v90, 1280, v90
    s_mov_b32 s48, 0xfffff
    s_mov_b32 s49, 0xfffff
    v_mov_b32 v20, 0x3f803f80
    v_mov_b32 v21, 0x3f803f80
    v_mov_b32 v22, 0x3f803f80
    v_mov_b32 v23, 0x3f803f80
    v_mov_b32 v24, 0x3f803f80
    v_mov_b32 v25, 0x3f803f80
    v_mov_b32 v26, 0x3f803f80
    v_mov_b32 v27, 0x3f803f80
    v_mov_b32 v28, 0x3f803f80
    v_mov_b32 v29, 0x3f803f80
    v_mov_b32 v30, 0x3f803f80
    v_mov_b32 v31, 0x3f803f80
    v_mov_b32 v32, 0
    v_mov_b32 v33, 0
    v_mov_b32 v34, 0
    v_mov_b32 v35, 0
    v_mov_b32 v36, 0
    v_mov_b32 v37, 0
    v_mov_b32 v38, 0
    v_mov_b32 v39, 0
    v_mov_b32 v40, 0
    v_mov_b32 v41, 0
    v_mov_b32 v42, 0
    v_mov_b32 v43, 0
    v_mov_b32 v44, 0
    v_mov_b32 v45, 0
    v_mov_b32 v46, 0
    v_mov_b32 v47, 0
    v_mov_b32 v48, 0
    v_mov_b32 v49, 0
    v_mov_b32 v50, 0
    v_mov_b32 v51, 0
    v_mov_b32 v52, 0
    v_mov_b32 v53, 0
    v_mov_b32 v54, 0
    v_mov_b32 v55, 0
    v_mov_b32 v18, 0
    v_mov_b32 v19, 0
    v_mov_b32 v102, 0
    v_mov_b32 v103, 0
    v_mov_b32 v104, 0x3f803f80
    v_mov_b32 v105, 0x3f803f80
    v_mov_b32 v106, 0x3f803f80
    v_mov_b32 v107, 0x3f803f80
    s_cmp_lg_u32 s3, 4
    s_cbranch_scc1 fdone_33
    s_and_b32 s60, s2, 7
    s_lshl_b32 s60, s60, 8
    s_add_u32 s60, s60, 8126464
    s_mov_b32 s26, 0x40000
wi_34:
    v_mov_b32 v110, 0
    global_load_dword v110, v110, s[20:21] sc1
    s_waitcnt vmcnt(0)
    v_readfirstlane_b32 s27, v110
    s_sub_u32 s26, s26, 1
    s_cmp_eq_u32 s26, 0
    s_cbranch_scc1 wi_34_o
    s_cmp_eq_u32 s27, 0
    s_cbranch_scc1 wi_34
wi_34_o:
    s_mov_b64 s[24:25], exec
    s_mov_b64 exec, 1
    v_mov_b32 v110, s60
    s_mov_b32 s26, 0x40000
    global_load_dword v111, v110, s[22:23] sc1
pf_35:
    global_load_dword v112, v110, s[22:23] sc1
    s_waitcnt vmcnt(1)
    v_readfirstlane_b32 s27, v111
    s_cmp_ge_u32 s27, 40
    s_cbranch_scc1 pf_35_out
    global_load_dword v111, v110, s[22:23] sc1
    s_waitcnt vmcnt(1)
    v_readfirstlane_b32 s27, v112
    s_cmp_ge_u32 s27, 40
    s_cbranch_scc1 pf_35_out
    s_sub_u32 s26, s26, 1
    s_cmp_lg_u32 s26, 0
    s_cbranch_scc1 pf_35
pf_35_out:
    s_waitcnt vmcnt(0)
    s_mov_b64 exec, s[24:25]
    v_lshlrev_b32 v110, 4, v1
    s_mov_b32 s61, s50
    s_mov_b32 m0, 0
    s_nop 0
    buffer_load_dwordx4 v110, s[32:35], s61 offen offset:0 sc1 lds
    buffer_load_dwordx4 v110, s[32:35], s61 offen offset:1024 sc1 lds
    buffer_load_dwordx4 v110, s[32:35], s61 offen offset:2048 sc1 lds
    buffer_load_dwordx4 v110, s[32:35], s61 offen offset:3072 sc1 lds
    s_add_u32 m0, m0, 4096
    s_add_u32 s61, s61, 4096
    buffer_load_dwordx4 v110, s[32:35], s61 offen offset:0 sc1 lds
    buffer_load_dwordx4 v110, s[32:35], s61 offen offset:1024 sc1 lds
    buffer_load_dwordx4 v110, s[32:35], s61 offen offset:2048 sc1 lds
    buffer_load_dwordx4 v110, s[32:35], s61 offen offset:3072 sc1 lds
    s_mul_i32 s61, s44, 81920
    s_mul_i32 s62, s45, 10240
    s_add_u32 s61, s61, s62
    s_mov_b32 m0, 151552
    s_nop 0
    buffer_load_dwordx4 v110, s[28:31], s61 offen offset:0 sc1 lds
    buffer_load_dwordx4 v110, s[28:31], s61 offen offset:1024 sc1 lds
    buffer_load_dwordx4 v110, s[28:31], s61 offen offset:2048 sc1 lds
    buffer_load_dwordx4 v110, s[28:31], s61 offen offset:3072 sc1 lds
    s_add_u32 m0, m0, 4096
    s_add_u32 s61, s61, 4096
    buffer_load_dwordx4 v110, s[28:31], s61 offen offset:0 sc1 lds
    buffer_load_dwordx4 v110, s[28:31], s61 offen offset:1024 sc1 lds
    buffer_load_dwordx4 v110, s[28:31], s61 offen offset:2048 sc1 lds
    buffer_load_dwordx4 v110, s[28:31], s61 offen offset:3072 sc1 lds
    s_add_u32 m0, m0, 4096
    s_add_u32 s61, s61, 4096
    buffer_load_dwordx4 v110, s[28:31], s61 offen offset:0 sc1 lds
    buffer_load_dwordx4 v110, s[28:31], s61 offen offset:1024 sc1 lds
    s_lshl_b32 s61, s45, 11
    s_mov_b32 m0, 161792
    s_nop 0
    buffer_load_dwordx4 v110, s[36:39], s61 offen offset:0 sc1 lds
    buffer_load_dwordx4 v110, s[36:39], s61 offen offset:1024 sc1 lds
    s_add_u32 s61, s50, 8192
    s_mov_b32 m0, 8192
    s_nop 0
    buffer_load_dwordx4 v110, s[32:35], s61 offen offset:0 sc1 lds
    buffer_load_dwordx4 v110, s[32:35], s61 offen offset:1024 sc1 lds
    buffer_load_dwordx4 v110, s[32:35], s61 offen offset:2048 sc1 lds
    buffer_load_dwordx4 v110, s[32:35], s61 offen offset:3072 sc1 lds
    s_add_u32 m0, m0, 4096
    s_add_u32 s61, s61, 4096
    buffer_load_dwordx4 v110, s[32:35], s61 offen offset:0 sc1 lds
    buffer_load_dwordx4 v110, s[32:35], s61 offen offset:1024 sc1 lds
    buffer_load_dwordx4 v110, s[32:35], s61 offen offset:2048 sc1 lds
    buffer_load_dwordx4 v110, s[32:35], s61 offen offset:3072 sc1 lds
    s_add_u32 m0, m0, 4096
    s_add_u32 s61, s61, 4096
    buffer_load_dwordx4 v110, s[32:35], s61 offen offset:0 sc1 lds
    buffer_load_dwordx4 v110, s[32:35], s61 offen offset:1024 sc1 lds
    buffer_load_dwordx4 v110, s[32:35], s61 offen offset:2048 sc1 lds
    buffer_load_dwordx4 v110, s[32:35], s61 offen offset:3072 sc1 lds
    s_add_u32 m0, m0, 4096
    s_add_u32 s61, s61, 4096
    buffer_load_dwordx4 v110, s[32:35], s61 offen offset:0 sc1 lds
    buffer_load_dwordx4 v110, s[32:35], s61 offen offset:1024 sc1 lds
    buffer_load_dwordx4 v110, s[32:35], s61 offen offset:2048 sc1 lds
    buffer_load_dwordx4 v110, s[32:35], s61 offen offset:3072 sc1 lds
    s_add_u32 m0, m0, 4096
    s_add_u32 s61, s61, 4096
    buffer_load_dwordx4 v110, s[32:35], s61 offen offset:0 sc1 lds
    buffer_load_dwordx4 v110, s[32:35], s61 offen offset:1024 sc1 lds
    buffer_load_dwordx4 v110, s[32:35], s61 offen offset:2048 sc1 lds
    buffer_load_dwordx4 v110, s[32:35], s61 offen offset:3072 sc1 lds
    s_add_u32 m0, m0, 4096
    s_add_u32 s61, s61, 4096
    buffer_load_dwordx4 v110, s[32:35], s61 offen offset:0 sc1 lds
    buffer_load_dwordx4 v110, s[32:35], s61 offen offset:1024 sc1 lds
    buffer_load_dwordx4 v110, s[32:35], s61 offen offset:2048 sc1 lds
    buffer_load_dwordx4 v110, s[32:35], s61 offen offset:3072 sc1 lds
    s_add_u32 m0, m0, 4096
    s_add_u32 s61, s61, 4096
    buffer_load_dwordx4 v110, s[32:35], s61 offen offset:0 sc1 lds
    buffer_load_dwordx4 v110, s[32:35], s61 offen offset:1024 sc1 lds
    buffer_load_dwordx4 v110, s[32:35], s61 offen offset:2048 sc1 lds
    buffer_load_dwordx4 v110, s[32:35], s61 offen offset:3072 sc1 lds
    s_add_u32 m0, m0, 4096
    s_add_u32 s61, s61, 4096
    buffer_load_dwordx4 v110, s[32:35], s61 offen offset:0 sc1 lds
    buffer_load_dwordx4 v110, s[32:35], s61 offen offset:1024 sc1 lds
    buffer_load_dwordx4 v110, s[32:35], s61 offen offset:2048 sc1 lds
    buffer_load_dwordx4 v110, s[32:35], s61 offen offset:3072 sc1 lds
    s_waitcnt vmcnt(0)
fdone_33:
    s_barrier
    s_cmp_eq_u32 s47, 0
    s_cbranch_scc1 hst_37
    v_lshlrev_b32 v95, 5, v2
    v_lshl_add_u32 v95, v3, 4, v95
    s_add_u32 s60, s55, 0
    buffer_store_dwordx4 v[136:139], v95, s[64:67], s60 offen sc1
    s_add_u32 s60, s55, 1024
    buffer_store_dwordx4 v[140:143], v95, s[64:67], s60 offen sc1
    s_add_u32 s60, s55, 65536
    buffer_store_dwordx4 v[144:147], v95, s[64:67], s60 offen sc1
    s_add_u32 s60, s55, 66560
    buffer_store_dwordx4 v[148:151], v95, s[64:67], s60 offen sc1
    s_add_u32 s60, s55, 131072
    buffer_store_dwordx4 v[168:171], v95, s[64:67], s60 offen sc1
    s_add_u32 s60, s55, 132096
    buffer_store_dwordx4 v[172:175], v95, s[64:67], s60 offen sc1
    s_add_u32 s60, s55, 196608
    buffer_store_dwordx4 v[128:131], v95, s[64:67], s60 offen sc1
    s_add_u32 s60, s55, 197632
    buffer_store_dwordx4 v[132:135], v95, s[64:67], s60 offen sc1
    s_add_u32 s60, s55, 262144
    buffer_store_dwordx4 v[152:155], v95, s[64:67], s60 offen sc1
    s_add_u32 s60, s55, 263168
    buffer_store_dwordx4 v[156:159], v95, s[64:67], s60 offen sc1
    s_add_u32 s60, s55, 327680
    buffer_store_dwordx4 v[160:163], v95, s[64:67], s60 offen sc1
    s_add_u32 s60, s55, 328704
    buffer_store_dwordx4 v[164:167], v95, s[64:67], s60 offen sc1
hst_37:
    s_mul_i32 s51, s3, 5120
    s_add_u32 s51, s51, 40960
    s_add_u32 s52, s51, s50
    s_mul_i32 s60, s3, 1280
    s_add_u32 s60, s60, 151552
    v_lshlrev_b32 v95, 4, v1
    v_add_u32 v95, s60, v95
    ds_read_b128 v[4:7], v95
    v_lshlrev_b32 v96, 3, v2
    v_add_u32 v96, s60, v96
    v_mov_b32 v8, 0
    v_mov_b32 v9, 0
    v_mov_b32 v10, 0
    v_mov_b32 v11, 0
    s_mov_b32 exec_hi, 0
    ds_read_b64 v[8:9], v96 offset:1024
    s_mov_b32 exec_hi, -1
    s_lshl_b32 s60, s3, 8
    s_add_u32 s60, s60, 161792
    v_lshlrev_b32 v97, 3, v2
    v_add_u32 v97, s60, v97
    ds_read_b32 v98, v97
    ds_read_b128 v[12:15], v88
    ds_read_b64 v[16:17], v89
    s_waitcnt lgkmcnt(0)
    v_mfma_f32_32x32x16_bf16 v[56:71], v[12:15], v[4:7], 0
    ds_read_b128 v[12:15], v88 offset:2560
    v_mfma_f32_32x32x8_bf16 v[56:71], v[16:17], v[8:9], v[56:71]
    ds_read_b64 v[16:17], v89 offset:2560
    s_mov_b64 exec, s[48:49]
    ds_read_b128 v[20:23], v90
    s_mov_b64 exec, -1
    s_mov_b32 s46, 0
    s_nop 7
.p2align 6
p2_loop:
    s_setprio 3
    s_waitcnt lgkmcnt(0)
    v_mfma_f32_32x32x16_bf16 v[72:87], v[12:15], v[4:7], 0
    ds_read_b128 v[12:15], v88 offset:5120
    ds_read_b64 v[100:101], v89 offset:5120
    s_mov_b64 exec, s[48:49]
    ds_read_b128 v[104:107], v90 offset:2560
    ds_read_b128 v[24:27], v90 offset:640
    s_mov_b64 exec, -1
    v_exp_f32 v56, v56
    v_exp_f32 v57, v57
    v_exp_f32 v58, v58
    v_exp_f32 v59, v59
    v_cvt_pk_bf16_f32 v32, v56, v57
    v_cvt_pk_bf16_f32 v33, v58, v59
    v_mfma_f32_32x32x16_bf16 v[40:55], v[28:31], v[36:39], v[40:55]
    s_mov_b32 m0, s51
    s_nop 0
    buffer_load_dwordx4 v94, s[32:35], s52 offen offset:0 sc1 lds
    v_exp_f32 v60, v60
    v_exp_f32 v61, v61
    v_exp_f32 v62, v62
    v_exp_f32 v63, v63
    v_cvt_pk_bf16_f32 v34, v60, v61
    v_cvt_pk_bf16_f32 v35, v62, v63
    v_mfma_f32_32x32x8_bf16 v[72:87], v[16:17], v[8:9], v[72:87]
    v_exp_f32 v64, v64
    v_exp_f32 v65, v65
    v_exp_f32 v66, v66
    v_exp_f32 v67, v67
    v_cvt_pk_bf16_f32 v36, v64, v65
    v_cvt_pk_bf16_f32 v37, v66, v67
    v_mfma_f32_32x32x16_bf16 v[40:55], v[20:23], v[32:35], v[40:55]
    v_exp_f32 v68, v68
    v_exp_f32 v69, v69
    v_exp_f32 v70, v70
    v_exp_f32 v71, v71
    v_cvt_pk_bf16_f32 v38, v68, v69
    v_cvt_pk_bf16_f32 v39, v70, v71
    s_waitcnt lgkmcnt(0)
    v_mfma_f32_32x32x16_bf16 v[56:71], v[12:15], v[4:7], 0
    ds_read_b128 v[12:15], v88 offset:7680
    ds_read_b64 v[16:17], v89 offset:7680
    s_mov_b64 exec, s[48:49]
    ds_read_b128 v[20:23], v90 offset:5120
    ds_read_b128 v[28:31], v90 offset:3200
    s_mov_b64 exec, -1
    v_exp_f32 v72, v72
    v_exp_f32 v73, v73
    v_exp_f32 v74, v74
    v_exp_f32 v75, v75
    v_cvt_pk_bf16_f32 v32, v72, v73
    v_cvt_pk_bf16_f32 v33, v74, v75
    v_mfma_f32_32x32x16_bf16 v[40:55], v[24:27], v[36:39], v[40:55]
    v_exp_f32 v76, v76
    v_exp_f32 v77, v77
    v_exp_f32 v78, v78
    v_exp_f32 v79, v79
    v_cvt_pk_bf16_f32 v34, v76, v77
    v_cvt_pk_bf16_f32 v35, v78, v79
    v_mfma_f32_32x32x8_bf16 v[56:71], v[100:101], v[8:9], v[56:71]
    v_exp_f32 v80, v80
    v_exp_f32 v81, v81
    v_exp_f32 v82, v82
    v_exp_f32 v83, v83
    v_cvt_pk_bf16_f32 v36, v80, v81
    v_cvt_pk_bf16_f32 v37, v82, v83
    v_mfma_f32_32x32x16_bf16 v[40:55], v[104:107], v[32:35], v[40:55]
    v_exp_f32 v84, v84
    v_exp_f32 v85, v85
    v_exp_f32 v86, v86
    v_exp_f32 v87, v87
    v_cvt_pk_bf16_f32 v38, v84, v85
    v_cvt_pk_bf16_f32 v39, v86, v87
    s_setprio 2
    s_waitcnt lgkmcnt(0)
    v_mfma_f32_32x32x16_bf16 v[72:87], v[12:15], v[4:7], 0
    ds_read_b128 v[12:15], v88 offset:10240
    ds_read_b64 v[100:101], v89 offset:10240
    s_mov_b64 exec, s[48:49]
    ds_read_b128 v[104:107], v90 offset:7680
    ds_read_b128 v[24:27], v90 offset:5760
    s_mov_b64 exec, -1
    v_exp_f32 v56, v56
    v_exp_f32 v57, v57
    v_exp_f32 v58, v58
    v_exp_f32 v59, v59
    v_cvt_pk_bf16_f32 v32, v56, v57
    v_cvt_pk_bf16_f32 v33, v58, v59
    v_mfma_f32_32x32x16_bf16 v[40:55], v[28:31], v[36:39], v[40:55]
    buffer_load_dwordx4 v94, s[32:35], s52 offen offset:1024 sc1 lds
    v_exp_f32 v60, v60
    v_exp_f32 v61, v61
    v_exp_f32 v62, v62
    v_exp_f32 v63, v63
    v_cvt_pk_bf16_f32 v34, v60, v61
    v_cvt_pk_bf16_f32 v35, v62, v63
    v_mfma_f32_32x32x8_bf16 v[72:87], v[16:17], v[8:9], v[72:87]
    v_exp_f32 v64, v64
    v_exp_f32 v65, v65
    v_exp_f32 v66, v66
    v_exp_f32 v67, v67
    v_cvt_pk_bf16_f32 v36, v64, v65
    v_cvt_pk_bf16_f32 v37, v66, v67
    v_mfma_f32_32x32x16_bf16 v[40:55], v[20:23], v[32:35], v[40:55]
    v_exp_f32 v68, v68
    v_exp_f32 v69, v69
    v_exp_f32 v70, v70
    v_exp_f32 v71, v71
    v_cvt_pk_bf16_f32 v38, v68, v69
    v_cvt_pk_bf16_f32 v39, v70, v71
    s_waitcnt lgkmcnt(0)
    v_mfma_f32_32x32x16_bf16 v[56:71], v[12:15], v[4:7], 0
    ds_read_b128 v[12:15], v88 offset:12800
    ds_read_b64 v[16:17], v89 offset:12800
    s_mov_b64 exec, s[48:49]
    ds_read_b128 v[20:23], v90 offset:10240
    ds_read_b128 v[28:31], v90 offset:8320
    s_mov_b64 exec, -1
    v_exp_f32 v72, v72
    v_exp_f32 v73, v73
    v_exp_f32 v74, v74
    v_exp_f32 v75, v75
    v_cvt_pk_bf16_f32 v32, v72, v73
    v_cvt_pk_bf16_f32 v33, v74, v75
    v_mfma_f32_32x32x16_bf16 v[40:55], v[24:27], v[36:39], v[40:55]
    v_exp_f32 v76, v76
    v_exp_f32 v77, v77
    v_exp_f32 v78, v78
    v_exp_f32 v79, v79
    v_cvt_pk_bf16_f32 v34, v76, v77
    v_cvt_pk_bf16_f32 v35, v78, v79
    v_mfma_f32_32x32x8_bf16 v[56:71], v[100:101], v[8:9], v[56:71]
    v_exp_f32 v80, v80
    v_exp_f32 v81, v81
    v_exp_f32 v82, v82
    v_exp_f32 v83, v83
    v_cvt_pk_bf16_f32 v36, v80, v81
    v_cvt_pk_bf16_f32 v37, v82, v83
    v_mfma_f32_32x32x16_bf16 v[40:55], v[104:107], v[32:35], v[40:55]
    v_exp_f32 v84, v84
    v_exp_f32 v85, v85
    v_exp_f32 v86, v86
    v_exp_f32 v87, v87
    v_cvt_pk_bf16_f32 v38, v84, v85
    v_cvt_pk_bf16_f32 v39, v86, v87
    s_setprio 1
    s_waitcnt lgkmcnt(0)
    v_mfma_f32_32x32x16_bf16 v[72:87], v[12:15], v[4:7], 0
    ds_read_b128 v[12:15], v88 offset:15360
    ds_read_b64 v[100:101], v89 offset:15360
    s_mov_b64 exec, s[48:49]
    ds_read_b128 v[104:107], v90 offset:12800
    ds_read_b128 v[24:27], v90 offset:10880
    s_mov_b64 exec, -1
    v_exp_f32 v56, v56
    v_exp_f32 v57, v57
    v_exp_f32 v58, v58
    v_exp_f32 v59, v59
    v_cvt_pk_bf16_f32 v32, v56, v57
    v_cvt_pk_bf16_f32 v33, v58, v59
    v_mfma_f32_32x32x16_bf16 v[40:55], v[28:31], v[36:39], v[40:55]
    buffer_load_dwordx4 v94, s[32:35], s52 offen offset:2048 sc1 lds
    v_exp_f32 v60, v60
    v_exp_f32 v61, v61
    v_exp_f32 v62, v62
    v_exp_f32 v63, v63
    v_cvt_pk_bf16_f32 v34, v60, v61
    v_cvt_pk_bf16_f32 v35, v62, v63
    v_mfma_f32_32x32x8_bf16 v[72:87], v[16:17], v[8:9], v[72:87]
    v_exp_f32 v64, v64
    v_exp_f32 v65, v65
    v_exp_f32 v66, v66
    v_exp_f32 v67, v67
    v_cvt_pk_bf16_f32 v36, v64, v65
    v_cvt_pk_bf16_f32 v37, v66, v67
    v_mfma_f32_32x32x16_bf16 v[40:55], v[20:23], v[32:35], v[40:55]
    v_exp_f32 v68, v68
    v_exp_f32 v69, v69
    v_exp_f32 v70, v70
    v_exp_f32 v71, v71
    v_cvt_pk_bf16_f32 v38, v68, v69
    v_cvt_pk_bf16_f32 v39, v70, v71
    s_waitcnt lgkmcnt(0)
    v_mfma_f32_32x32x16_bf16 v[56:71], v[12:15], v[4:7], 0
    ds_read_b128 v[12:15], v88 offset:17920
    ds_read_b64 v[16:17], v89 offset:17920
    s_mov_b64 exec, s[48:49]
    ds_read_b128 v[20:23], v90 offset:15360
    ds_read_b128 v[28:31], v90 offset:13440
    s_mov_b64 exec, -1
    v_exp_f32 v72, v72
    v_exp_f32 v73, v73
    v_exp_f32 v74, v74
    v_exp_f32 v75, v75
    v_cvt_pk_bf16_f32 v32, v72, v73
    v_cvt_pk_bf16_f32 v33, v74, v75
    v_mfma_f32_32x32x16_bf16 v[40:55], v[24:27], v[36:39], v[40:55]
    v_exp_f32 v76, v76
    v_exp_f32 v77, v77
    v_exp_f32 v78, v78
    v_exp_f32 v79, v79
    v_cvt_pk_bf16_f32 v34, v76, v77
    v_cvt_pk_bf16_f32 v35, v78, v79
    v_mfma_f32_32x32x8_bf16 v[56:71], v[100:101], v[8:9], v[56:71]
    v_exp_f32 v80, v80
    v_exp_f32 v81, v81
    v_exp_f32 v82, v82
    v_exp_f32 v83, v83
    v_cvt_pk_bf16_f32 v36, v80, v81
    v_cvt_pk_bf16_f32 v37, v82, v83
    v_mfma_f32_32x32x16_bf16 v[40:55], v[104:107], v[32:35], v[40:55]
    v_exp_f32 v84, v84
    v_exp_f32 v85, v85
    v_exp_f32 v86, v86
    v_exp_f32 v87, v87
    v_cvt_pk_bf16_f32 v38, v84, v85
    v_cvt_pk_bf16_f32 v39, v86, v87
    s_setprio 0
    s_waitcnt lgkmcnt(0)
    v_mfma_f32_32x32x16_bf16 v[72:87], v[12:15], v[4:7], 0
    ds_read_b128 v[12:15], v88 offset:20480
    ds_read_b64 v[100:101], v89 offset:20480
    s_mov_b64 exec, s[48:49]
    ds_read_b128 v[104:107], v90 offset:17920
    ds_read_b128 v[24:27], v90 offset:16000
    s_mov_b64 exec, -1
    v_exp_f32 v56, v56
    v_exp_f32 v57, v57
    v_exp_f32 v58, v58
    v_exp_f32 v59, v59
    v_cvt_pk_bf16_f32 v32, v56, v57
    v_cvt_pk_bf16_f32 v33, v58, v59
    v_mfma_f32_32x32x16_bf16 v[40:55], v[28:31], v[36:39], v[40:55]
    buffer_load_dwordx4 v94, s[32:35], s52 offen offset:3072 sc1 lds
    v_exp_f32 v60, v60
    v_exp_f32 v61, v61
    v_exp_f32 v62, v62
    v_exp_f32 v63, v63
    v_cvt_pk_bf16_f32 v34, v60, v61
    v_cvt_pk_bf16_f32 v35, v62, v63
    v_mfma_f32_32x32x8_bf16 v[72:87], v[16:17], v[8:9], v[72:87]
    v_exp_f32 v64, v64
    v_exp_f32 v65, v65
    v_exp_f32 v66, v66
    v_exp_f32 v67, v67
    v_cvt_pk_bf16_f32 v36, v64, v65
    v_cvt_pk_bf16_f32 v37, v66, v67
    v_mfma_f32_32x32x16_bf16 v[40:55], v[20:23], v[32:35], v[40:55]
    v_exp_f32 v68, v68
    v_exp_f32 v69, v69
    v_exp_f32 v70, v70
    v_exp_f32 v71, v71
    v_cvt_pk_bf16_f32 v38, v68, v69
    v_cvt_pk_bf16_f32 v39, v70, v71
    s_waitcnt lgkmcnt(0)
    v_mfma_f32_32x32x16_bf16 v[56:71], v[12:15], v[4:7], 0
    ds_read_b128 v[12:15], v88 offset:23040
    ds_read_b64 v[16:17], v89 offset:23040
    s_mov_b64 exec, s[48:49]
    ds_read_b128 v[20:23], v90 offset:20480
    ds_read_b128 v[28:31], v90 offset:18560
    s_mov_b64 exec, -1
    v_exp_f32 v72, v72
    v_exp_f32 v73, v73
    v_exp_f32 v74, v74
    v_exp_f32 v75, v75
    v_cvt_pk_bf16_f32 v32, v72, v73
    v_cvt_pk_bf16_f32 v33, v74, v75
    v_mfma_f32_32x32x16_bf16 v[40:55], v[24:27], v[36:39], v[40:55]
    v_exp_f32 v76, v76
    v_exp_f32 v77, v77
    v_exp_f32 v78, v78
    v_exp_f32 v79, v79
    v_cvt_pk_bf16_f32 v34, v76, v77
    v_cvt_pk_bf16_f32 v35, v78, v79
    v_mfma_f32_32x32x8_bf16 v[56:71], v[100:101], v[8:9], v[56:71]
    v_exp_f32 v80, v80
    v_exp_f32 v81, v81
    v_exp_f32 v82, v82
    v_exp_f32 v83, v83
    v_cvt_pk_bf16_f32 v36, v80, v81
    v_cvt_pk_bf16_f32 v37, v82, v83
    v_mfma_f32_32x32x16_bf16 v[40:55], v[104:107], v[32:35], v[40:55]
    v_exp_f32 v84, v84
    v_exp_f32 v85, v85
    v_exp_f32 v86, v86
    v_exp_f32 v87, v87
    v_cvt_pk_bf16_f32 v38, v84, v85
    v_cvt_pk_bf16_f32 v39, v86, v87
    s_setprio 3
    s_waitcnt lgkmcnt(0)
    v_mfma_f32_32x32x16_bf16 v[72:87], v[12:15], v[4:7], 0
    ds_read_b128 v[12:15], v88 offset:25600
    ds_read_b64 v[100:101], v89 offset:25600
    s_mov_b64 exec, s[48:49]
    ds_read_b128 v[104:107], v90 offset:23040
    ds_read_b128 v[24:27], v90 offset:21120
    s_mov_b64 exec, -1
    v_exp_f32 v56, v56
    v_exp_f32 v57, v57
    v_exp_f32 v58, v58
    v_exp_f32 v59, v59
    v_cvt_pk_bf16_f32 v32, v56, v57
    v_cvt_pk_bf16_f32 v33, v58, v59
    v_mfma_f32_32x32x16_bf16 v[40:55], v[28:31], v[36:39], v[40:55]
    s_add_u32 m0, s51, 4096
    s_add_u32 s60, s52, 4096
    buffer_load_dwordx4 v94, s[32:35], s60 offen sc1 lds
    v_exp_f32 v60, v60
    v_exp_f32 v61, v61
    v_exp_f32 v62, v62
    v_exp_f32 v63, v63
    v_cvt_pk_bf16_f32 v34, v60, v61
    v_cvt_pk_bf16_f32 v35, v62, v63
    v_mfma_f32_32x32x8_bf16 v[72:87], v[16:17], v[8:9], v[72:87]
    v_exp_f32 v64, v64
    v_exp_f32 v65, v65
    v_exp_f32 v66, v66
    v_exp_f32 v67, v67
    v_cvt_pk_bf16_f32 v36, v64, v65
    v_cvt_pk_bf16_f32 v37, v66, v67
    v_mfma_f32_32x32x16_bf16 v[40:55], v[20:23], v[32:35], v[40:55]
    v_exp_f32 v68, v68
    v_exp_f32 v69, v69
    v_exp_f32 v70, v70
    v_exp_f32 v71, v71
    v_cvt_pk_bf16_f32 v38, v68, v69
    v_cvt_pk_bf16_f32 v39, v70, v71
    s_waitcnt lgkmcnt(0)
    v_mfma_f32_32x32x16_bf16 v[56:71], v[12:15], v[4:7], 0
    ds_read_b128 v[12:15], v88 offset:28160
    ds_read_b64 v[16:17], v89 offset:28160
    s_mov_b64 exec, s[48:49]
    ds_read_b128 v[20:23], v90 offset:25600
    ds_read_b128 v[28:31], v90 offset:23680
    s_mov_b64 exec, -1
    v_exp_f32 v72, v72
    v_exp_f32 v73, v73
    v_exp_f32 v74, v74
    v_exp_f32 v75, v75
    v_cvt_pk_bf16_f32 v32, v72, v73
    v_cvt_pk_bf16_f32 v33, v74, v75
    v_mfma_f32_32x32x16_bf16 v[40:55], v[24:27], v[36:39], v[40:55]
    v_exp_f32 v76, v76
    v_exp_f32 v77, v77
    v_exp_f32 v78, v78
    v_exp_f32 v79, v79
    v_cvt_pk_bf16_f32 v34, v76, v77
    v_cvt_pk_bf16_f32 v35, v78, v79
    v_mfma_f32_32x32x8_bf16 v[56:71], v[100:101], v[8:9], v[56:71]
    v_exp_f32 v80, v80
    v_exp_f32 v81, v81
    v_exp_f32 v82, v82
    v_exp_f32 v83, v83
    v_cvt_pk_bf16_f32 v36, v80, v81
    v_cvt_pk_bf16_f32 v37, v82, v83
    v_mfma_f32_32x32x16_bf16 v[40:55], v[104:107], v[32:35], v[40:55]
    v_exp_f32 v84, v84
    v_exp_f32 v85, v85
    v_exp_f32 v86, v86
    v_exp_f32 v87, v87
    v_cvt_pk_bf16_f32 v38, v84, v85
    v_cvt_pk_bf16_f32 v39, v86, v87
    s_setprio 2
    s_waitcnt lgkmcnt(0)
    v_mfma_f32_32x32x16_bf16 v[72:87], v[12:15], v[4:7], 0
    ds_read_b128 v[12:15], v88 offset:30720
    ds_read_b64 v[100:101], v89 offset:30720
    s_mov_b64 exec, s[48:49]
    ds_read_b128 v[104:107], v90 offset:28160
    ds_read_b128 v[24:27], v90 offset:26240
    s_mov_b64 exec, -1
    v_exp_f32 v56, v56
    v_exp_f32 v57, v57
    v_exp_f32 v58, v58
    v_exp_f32 v59, v59
    v_cvt_pk_bf16_f32 v32, v56, v57
    v_cvt_pk_bf16_f32 v33, v58, v59
    v_mfma_f32_32x32x16_bf16 v[40:55], v[28:31], v[36:39], v[40:55]
    v_exp_f32 v60, v60
    v_exp_f32 v61, v61
    v_exp_f32 v62, v62
    v_exp_f32 v63, v63
    v_cvt_pk_bf16_f32 v34, v60, v61
    v_cvt_pk_bf16_f32 v35, v62, v63
    v_mfma_f32_32x32x8_bf16 v[72:87], v[16:17], v[8:9], v[72:87]
    v_exp_f32 v64, v64
    v_exp_f32 v65, v65
    v_exp_f32 v66, v66
    v_exp_f32 v67, v67
    v_cvt_pk_bf16_f32 v36, v64, v65
    v_cvt_pk_bf16_f32 v37, v66, v67
    v_mfma_f32_32x32x16_bf16 v[40:55], v[20:23], v[32:35], v[40:55]
    v_exp_f32 v68, v68
    v_exp_f32 v69, v69
    v_exp_f32 v70, v70
    v_exp_f32 v71, v71
    v_cvt_pk_bf16_f32 v38, v68, v69
    v_cvt_pk_bf16_f32 v39, v70, v71
    s_waitcnt lgkmcnt(0)
    v_mfma_f32_32x32x16_bf16 v[56:71], v[12:15], v[4:7], 0
    ds_read_b128 v[12:15], v88 offset:33280
    ds_read_b64 v[16:17], v89 offset:33280
    s_mov_b64 exec, s[48:49]
    ds_read_b128 v[20:23], v90 offset:30720
    ds_read_b128 v[28:31], v90 offset:28800
    s_mov_b64 exec, -1
    v_exp_f32 v72, v72
    v_exp_f32 v73, v73
    v_exp_f32 v74, v74
    v_exp_f32 v75, v75
    v_cvt_pk_bf16_f32 v32, v72, v73
    v_cvt_pk_bf16_f32 v33, v74, v75
    v_mfma_f32_32x32x16_bf16 v[40:55], v[24:27], v[36:39], v[40:55]
    v_exp_f32 v76, v76
    v_exp_f32 v77, v77
    v_exp_f32 v78, v78
    v_exp_f32 v79, v79
    v_cvt_pk_bf16_f32 v34, v76, v77
    v_cvt_pk_bf16_f32 v35, v78, v79
    v_mfma_f32_32x32x8_bf16 v[56:71], v[100:101], v[8:9], v[56:71]
    v_exp_f32 v80, v80
    v_exp_f32 v81, v81
    v_exp_f32 v82, v82
    v_exp_f32 v83, v83
    v_cvt_pk_bf16_f32 v36, v80, v81
    v_cvt_pk_bf16_f32 v37, v82, v83
    v_mfma_f32_32x32x16_bf16 v[40:55], v[104:107], v[32:35], v[40:55]
    v_exp_f32 v84, v84
    v_exp_f32 v85, v85
    v_exp_f32 v86, v86
    v_exp_f32 v87, v87
    v_cvt_pk_bf16_f32 v38, v84, v85
    v_cvt_pk_bf16_f32 v39, v86, v87
    s_setprio 1
    s_waitcnt lgkmcnt(0)
    v_mfma_f32_32x32x16_bf16 v[72:87], v[12:15], v[4:7], 0
    ds_read_b128 v[12:15], v88 offset:35840
    ds_read_b64 v[100:101], v89 offset:35840
    s_mov_b64 exec, s[48:49]
    ds_read_b128 v[104:107], v90 offset:33280
    ds_read_b128 v[24:27], v90 offset:31360
    s_mov_b64 exec, -1
    v_exp_f32 v56, v56
    v_exp_f32 v57, v57
    v_exp_f32 v58, v58
    v_exp_f32 v59, v59
    v_cvt_pk_bf16_f32 v32, v56, v57
    v_cvt_pk_bf16_f32 v33, v58, v59
    v_mfma_f32_32x32x16_bf16 v[40:55], v[28:31], v[36:39], v[40:55]
    v_exp_f32 v60, v60
    v_exp_f32 v61, v61
    v_exp_f32 v62, v62
    v_exp_f32 v63, v63
    v_cvt_pk_bf16_f32 v34, v60, v61
    v_cvt_pk_bf16_f32 v35, v62, v63
    v_mfma_f32_32x32x8_bf16 v[72:87], v[16:17], v[8:9], v[72:87]
    v_exp_f32 v64, v64
    v_exp_f32 v65, v65
    v_exp_f32 v66, v66
    v_exp_f32 v67, v67
    v_cvt_pk_bf16_f32 v36, v64, v65
    v_cvt_pk_bf16_f32 v37, v66, v67
    v_mfma_f32_32x32x16_bf16 v[40:55], v[20:23], v[32:35], v[40:55]
    v_exp_f32 v68, v68
    v_exp_f32 v69, v69
    v_exp_f32 v70, v70
    v_exp_f32 v71, v71
    v_cvt_pk_bf16_f32 v38, v68, v69
    v_cvt_pk_bf16_f32 v39, v70, v71
    s_waitcnt lgkmcnt(0)
    v_mfma_f32_32x32x16_bf16 v[56:71], v[12:15], v[4:7], 0
    ds_read_b128 v[12:15], v88 offset:38400
    ds_read_b64 v[16:17], v89 offset:38400
    s_mov_b64 exec, s[48:49]
    ds_read_b128 v[20:23], v90 offset:35840
    ds_read_b128 v[28:31], v90 offset:33920
    s_mov_b64 exec, -1
    v_exp_f32 v72, v72
    v_exp_f32 v73, v73
    v_exp_f32 v74, v74
    v_exp_f32 v75, v75
    v_cvt_pk_bf16_f32 v32, v72, v73
    v_cvt_pk_bf16_f32 v33, v74, v75
    v_mfma_f32_32x32x16_bf16 v[40:55], v[24:27], v[36:39], v[40:55]
    v_exp_f32 v76, v76
    v_exp_f32 v77, v77
    v_exp_f32 v78, v78
    v_exp_f32 v79, v79
    v_cvt_pk_bf16_f32 v34, v76, v77
    v_cvt_pk_bf16_f32 v35, v78, v79
    v_mfma_f32_32x32x8_bf16 v[56:71], v[100:101], v[8:9], v[56:71]
    v_exp_f32 v80, v80
    v_exp_f32 v81, v81
    v_exp_f32 v82, v82
    v_exp_f32 v83, v83
    v_cvt_pk_bf16_f32 v36, v80, v81
    v_cvt_pk_bf16_f32 v37, v82, v83
    v_mfma_f32_32x32x16_bf16 v[40:55], v[104:107], v[32:35], v[40:55]
    v_exp_f32 v84, v84
    v_exp_f32 v85, v85
    v_exp_f32 v86, v86
    v_exp_f32 v87, v87
    v_cvt_pk_bf16_f32 v38, v84, v85
    v_cvt_pk_bf16_f32 v39, v86, v87
    s_setprio 0
    s_waitcnt vmcnt(0)
    s_barrier
    s_cmp_lg_u32 s46, 0
    s_cbranch_scc1 hk_38_e
    s_cmp_eq_u32 s54, -1
    s_cbranch_scc1 hk_38_e
    s_cmp_lg_u32 s3, 0
    s_cbranch_scc1 sig_39
    s_mov_b32 s26, 0x40000
sig_39_p:
    v_readfirstlane_b32 s27, v99
    s_sub_u32 s26, s26, 1
    s_cmp_eq_u32 s26, 0
    s_cbranch_scc1 sig_39_go
    s_cmp_lg_u32 s27, 0
    s_cbranch_scc1 sig_39_go
    v_mov_b32 v99, 0
    global_load_dword v99, v99, s[20:21] sc1
    s_waitcnt vmcnt(0)
    s_branch sig_39_p
sig_39_go:
    s_mov_b64 s[24:25], exec
    s_mov_b64 exec, 1
    v_add_u32 v108, s54, v1
    v_lshlrev_b32 v108, 8, v108
    v_add_u32 v108, 8126464, v108
    v_mov_b32 v109, 1
    global_atomic_add v108, v109, s[22:23]
    s_mov_b64 exec, s[24:25]
sig_39:
hk_38_e:
    s_cmp_lg_u32 s46, 1
    s_cbranch_scc1 cr_40
    s_and_b32 s60, s2, 6
    s_add_u32 s60, s60, 8
    v_and_b32 v108, 1, v1
    v_add_u32 v108, s60, v108
    v_mov_b32 v109, 24
    v_cmp_eq_u32 vcc, 2, v1
    s_lshr_b32 s60, s53, 2
    s_add_u32 s60, s60, 8
    v_cndmask_b32 v108, v108, v109, vcc
    v_mov_b32 v109, s60
    v_cmp_eq_u32 vcc, 3, v1
    s_nop 1
    v_cndmask_b32 v108, v108, v109, vcc
    v_lshlrev_b32 v108, 8, v108
    v_add_u32 v108, 8126464, v108
    global_load_dword v112, v108, s[22:23] sc1
cr_40:
    s_waitcnt lgkmcnt(0)
    v_mfma_f32_32x32x16_bf16 v[72:87], v[12:15], v[4:7], 0
    ds_read_b128 v[12:15], v88 offset:40960
    ds_read_b64 v[100:101], v89 offset:40960
    s_mov_b64 exec, s[48:49]
    ds_read_b128 v[104:107], v90 offset:38400
    ds_read_b128 v[24:27], v90 offset:36480
    s_mov_b64 exec, -1
    v_exp_f32 v56, v56
    v_exp_f32 v57, v57
    v_exp_f32 v58, v58
    v_exp_f32 v59, v59
    v_cvt_pk_bf16_f32 v32, v56, v57
    v_cvt_pk_bf16_f32 v33, v58, v59
    v_mfma_f32_32x32x16_bf16 v[40:55], v[28:31], v[36:39], v[40:55]
    v_exp_f32 v60, v60
    v_exp_f32 v61, v61
    v_exp_f32 v62, v62
    v_exp_f32 v63, v63
    v_cvt_pk_bf16_f32 v34, v60, v61
    v_cvt_pk_bf16_f32 v35, v62, v63
    v_mfma_f32_32x32x8_bf16 v[72:87], v[16:17], v[8:9], v[72:87]
    v_exp_f32 v64, v64
    v_exp_f32 v65, v65
    v_exp_f32 v66, v66
    v_exp_f32 v67, v67
    v_cvt_pk_bf16_f32 v36, v64, v65
    v_cvt_pk_bf16_f32 v37, v66, v67
    v_mfma_f32_32x32x16_bf16 v[40:55], v[20:23], v[32:35], v[40:55]
    v_exp_f32 v68, v68
    v_exp_f32 v69, v69
    v_exp_f32 v70, v70
    v_exp_f32 v71, v71
    v_cvt_pk_bf16_f32 v38, v68, v69
    v_cvt_pk_bf16_f32 v39, v70, v71
    s_waitcnt lgkmcnt(0)
    v_mfma_f32_32x32x16_bf16 v[56:71], v[12:15], v[4:7], 0
    ds_read_b128 v[12:15], v88 offset:43520
    ds_read_b64 v[16:17], v89 offset:43520
    s_mov_b64 exec, s[48:49]
    ds_read_b128 v[20:23], v90 offset:40960
    ds_read_b128 v[28:31], v90 offset:39040
    s_mov_b64 exec, -1
    v_exp_f32 v72, v72
    v_exp_f32 v73, v73
    v_exp_f32 v74, v74
    v_exp_f32 v75, v75
    v_cvt_pk_bf16_f32 v32, v72, v73
    v_cvt_pk_bf16_f32 v33, v74, v75
    v_mfma_f32_32x32x16_bf16 v[40:55], v[24:27], v[36:39], v[40:55]
    v_exp_f32 v76, v76
    v_exp_f32 v77, v77
    v_exp_f32 v78, v78
    v_exp_f32 v79, v79
    v_cvt_pk_bf16_f32 v34, v76, v77
    v_cvt_pk_bf16_f32 v35, v78, v79
    v_mfma_f32_32x32x8_bf16 v[56:71], v[100:101], v[8:9], v[56:71]
    v_exp_f32 v80, v80
    v_exp_f32 v81, v81
    v_exp_f32 v82, v82
    v_exp_f32 v83, v83
    v_cvt_pk_bf16_f32 v36, v80, v81
    v_cvt_pk_bf16_f32 v37, v82, v83
    v_mfma_f32_32x32x16_bf16 v[40:55], v[104:107], v[32:35], v[40:55]
    v_exp_f32 v84, v84
    v_exp_f32 v85, v85
    v_exp_f32 v86, v86
    v_exp_f32 v87, v87
    v_cvt_pk_bf16_f32 v38, v84, v85
    v_cvt_pk_bf16_f32 v39, v86, v87
    v_add_u32 v88, 40960, v88
    v_add_u32 v89, 40960, v89
    v_add_u32 v90, 40960, v90
    s_add_u32 s51, s51, 40960
    s_add_u32 s52, s52, 40960
    s_add_u32 s46, s46, 1
    s_cmp_lt_u32 s46, 3
    s_cbranch_scc1 p2_loop
    v_readlane_b32 s60, v112, 0
    v_readlane_b32 s61, v112, 1
    v_readlane_b32 s62, v112, 3
    s_min_u32 s60, s60, s61
    s_min_u32 s60, s60, s62
    v_readlane_b32 s61, v112, 2
    s_cmp_lt_u32 s60, 18
    s_cbranch_scc1 hc_41
    s_cmp_lt_u32 s61, 16
    s_cbranch_scc1 hc_41
    s_mov_b32 s57, 1
hc_41:
    s_cmp_eq_u32 s57, 0
    s_cbranch_scc1 p2_plain
    s_mov_b32 s57, 4
    s_setprio 0
    s_cmp_lt_u32 s3, 4
    s_cbranch_scc1 lp_42
    s_setprio 1
lp_42:
    s_waitcnt lgkmcnt(0)
    v_mfma_f32_32x32x16_bf16 v[72:87], v[12:15], v[4:7], 0
    ds_read_b128 v[12:15], v88 offset:5120
    ds_read_b64 v[100:101], v89 offset:5120
    s_mov_b64 exec, s[48:49]
    ds_read_b128 v[104:107], v90 offset:2560
    ds_read_b128 v[24:27], v90 offset:640
    s_mov_b64 exec, -1
    v_exp_f32 v56, v56
    v_exp_f32 v57, v57
    v_exp_f32 v58, v58
    v_exp_f32 v59, v59
    v_cvt_pk_bf16_f32 v32, v56, v57
    v_cvt_pk_bf16_f32 v33, v58, v59
    v_mfma_f32_32x32x16_bf16 v[40:55], v[28:31], v[36:39], v[40:55]
    s_add_u32 s59, s3, 0
    s_mul_i32 s59, s59, 40960
    buffer_load_dwordx4 v[144:147], v239, s[92:95], s59 offen offset:0 sc1
    v_exp_f32 v60, v60
    v_exp_f32 v61, v61
    v_exp_f32 v62, v62
    v_exp_f32 v63, v63
    v_cvt_pk_bf16_f32 v34, v60, v61
    v_cvt_pk_bf16_f32 v35, v62, v63
    v_mfma_f32_32x32x8_bf16 v[72:87], v[16:17], v[8:9], v[72:87]
    buffer_load_dwordx4 v[148:151], v239, s[92:95], s59 offen offset:1024 sc1
    v_exp_f32 v64, v64
    v_exp_f32 v65, v65
    v_exp_f32 v66, v66
    v_exp_f32 v67, v67
    v_cvt_pk_bf16_f32 v36, v64, v65
    v_cvt_pk_bf16_f32 v37, v66, v67
    v_mfma_f32_32x32x16_bf16 v[40:55], v[20:23], v[32:35], v[40:55]
    v_exp_f32 v68, v68
    v_exp_f32 v69, v69
    v_exp_f32 v70, v70
    v_exp_f32 v71, v71
    v_cvt_pk_bf16_f32 v38, v68, v69
    v_cvt_pk_bf16_f32 v39, v70, v71
    s_waitcnt lgkmcnt(0)
    v_mfma_f32_32x32x16_bf16 v[56:71], v[12:15], v[4:7], 0
    ds_read_b128 v[12:15], v88 offset:7680
    ds_read_b64 v[16:17], v89 offset:7680
    s_mov_b64 exec, s[48:49]
    ds_read_b128 v[20:23], v90 offset:5120
    ds_read_b128 v[28:31], v90 offset:3200
    s_mov_b64 exec, -1
    v_exp_f32 v72, v72
    v_exp_f32 v73, v73
    v_exp_f32 v74, v74
    v_exp_f32 v75, v75
    v_cvt_pk_bf16_f32 v32, v72, v73
    v_cvt_pk_bf16_f32 v33, v74, v75
    v_mfma_f32_32x32x16_bf16 v[40:55], v[24:27], v[36:39], v[40:55]
    buffer_load_dwordx4 v[152:155], v239, s[92:95], s59 offen offset:2048 sc1
    v_exp_f32 v76, v76
    v_exp_f32 v77, v77
    v_exp_f32 v78, v78
    v_exp_f32 v79, v79
    v_cvt_pk_bf16_f32 v34, v76, v77
    v_cvt_pk_bf16_f32 v35, v78, v79
    v_mfma_f32_32x32x8_bf16 v[56:71], v[100:101], v[8:9], v[56:71]
    buffer_load_dwordx4 v[156:159], v239, s[92:95], s59 offen offset:3072 sc1
    buffer_load_dwordx4 v[160:163], v240, s[92:95], s59 offen offset:0 sc1
    v_exp_f32 v80, v80
    v_exp_f32 v81, v81
    v_exp_f32 v82, v82
    v_exp_f32 v83, v83
    v_cvt_pk_bf16_f32 v36, v80, v81
    v_cvt_pk_bf16_f32 v37, v82, v83
    v_mfma_f32_32x32x16_bf16 v[40:55], v[104:107], v[32:35], v[40:55]
    v_exp_f32 v84, v84
    v_exp_f32 v85, v85
    v_exp_f32 v86, v86
    v_exp_f32 v87, v87
    v_cvt_pk_bf16_f32 v38, v84, v85
    v_cvt_pk_bf16_f32 v39, v86, v87
    s_waitcnt lgkmcnt(0)
    v_mfma_f32_32x32x16_bf16 v[72:87], v[12:15], v[4:7], 0
    ds_read_b128 v[12:15], v88 offset:10240
    ds_read_b64 v[100:101], v89 offset:10240
    s_mov_b64 exec, s[48:49]
    ds_read_b128 v[104:107], v90 offset:7680
    ds_read_b128 v[24:27], v90 offset:5760
    s_mov_b64 exec, -1
    v_exp_f32 v56, v56
    v_exp_f32 v57, v57
    v_exp_f32 v58, v58
    v_exp_f32 v59, v59
    v_cvt_pk_bf16_f32 v32, v56, v57
    v_cvt_pk_bf16_f32 v33, v58, v59
    v_mfma_f32_32x32x16_bf16 v[40:55], v[28:31], v[36:39], v[40:55]
    s_add_u32 s58, s3, 0
    s_mul_i32 s58, s58, 131072
    buffer_load_dwordx4 v[128:131], v236, s[64:67], s58 offen offset:0 sc1
    v_exp_f32 v60, v60
    v_exp_f32 v61, v61
    v_exp_f32 v62, v62
    v_exp_f32 v63, v63
    v_cvt_pk_bf16_f32 v34, v60, v61
    v_cvt_pk_bf16_f32 v35, v62, v63
    v_mfma_f32_32x32x8_bf16 v[72:87], v[16:17], v[8:9], v[72:87]
    buffer_load_dwordx4 v[132:135], v236, s[64:67], s58 offen offset:512 sc1
    v_exp_f32 v64, v64
    v_exp_f32 v65, v65
    v_exp_f32 v66, v66
    v_exp_f32 v67, v67
    v_cvt_pk_bf16_f32 v36, v64, v65
    v_cvt_pk_bf16_f32 v37, v66, v67
    v_mfma_f32_32x32x16_bf16 v[40:55], v[20:23], v[32:35], v[40:55]
    v_exp_f32 v68, v68
    v_exp_f32 v69, v69
    v_exp_f32 v70, v70
    v_exp_f32 v71, v71
    v_cvt_pk_bf16_f32 v38, v68, v69
    v_cvt_pk_bf16_f32 v39, v70, v71
    s_waitcnt lgkmcnt(0)
    v_mfma_f32_32x32x16_bf16 v[56:71], v[12:15], v[4:7], 0
    ds_read_b128 v[12:15], v88 offset:12800
    ds_read_b64 v[16:17], v89 offset:12800
    s_mov_b64 exec, s[48:49]
    ds_read_b128 v[20:23], v90 offset:10240
    ds_read_b128 v[28:31], v90 offset:8320
    s_mov_b64 exec, -1
    v_exp_f32 v72, v72
    v_exp_f32 v73, v73
    v_exp_f32 v74, v74
    v_exp_f32 v75, v75
    v_cvt_pk_bf16_f32 v32, v72, v73
    v_cvt_pk_bf16_f32 v33, v74, v75
    v_mfma_f32_32x32x16_bf16 v[40:55], v[24:27], v[36:39], v[40:55]
    buffer_load_dwordx4 v[136:139], v236, s[64:67], s58 offen offset:1024 sc1
    v_exp_f32 v76, v76
    v_exp_f32 v77, v77
    v_exp_f32 v78, v78
    v_exp_f32 v79, v79
    v_cvt_pk_bf16_f32 v34, v76, v77
    v_cvt_pk_bf16_f32 v35, v78, v79
    v_mfma_f32_32x32x8_bf16 v[56:71], v[100:101], v[8:9], v[56:71]
    buffer_load_dwordx4 v[140:143], v236, s[64:67], s58 offen offset:1536 sc1
    s_add_u32 s59, s3, 8
    s_mul_i32 s59, s59, 40960
    buffer_load_dwordx4 v[180:183], v239, s[92:95], s59 offen offset:0 sc1
    v_exp_f32 v80, v80
    v_exp_f32 v81, v81
    v_exp_f32 v82, v82
    v_exp_f32 v83, v83
    v_cvt_pk_bf16_f32 v36, v80, v81
    v_cvt_pk_bf16_f32 v37, v82, v83
    v_mfma_f32_32x32x16_bf16 v[40:55], v[104:107], v[32:35], v[40:55]
    v_exp_f32 v84, v84
    v_exp_f32 v85, v85
    v_exp_f32 v86, v86
    v_exp_f32 v87, v87
    v_cvt_pk_bf16_f32 v38, v84, v85
    v_cvt_pk_bf16_f32 v39, v86, v87
    s_waitcnt lgkmcnt(0)
    v_mfma_f32_32x32x16_bf16 v[72:87], v[12:15], v[4:7], 0
    ds_read_b128 v[12:15], v88 offset:15360
    ds_read_b64 v[100:101], v89 offset:15360
    s_mov_b64 exec, s[48:49]
    ds_read_b128 v[104:107], v90 offset:12800
    ds_read_b128 v[24:27], v90 offset:10880
    s_mov_b64 exec, -1
    v_exp_f32 v56, v56
    v_exp_f32 v57, v57
    v_exp_f32 v58, v58
    v_exp_f32 v59, v59
    v_cvt_pk_bf16_f32 v32, v56, v57
    v_cvt_pk_bf16_f32 v33, v58, v59
    v_mfma_f32_32x32x16_bf16 v[40:55], v[28:31], v[36:39], v[40:55]
    buffer_load_dwordx4 v[184:187], v239, s[92:95], s59 offen offset:1024 sc1
    v_exp_f32 v60, v60
    v_exp_f32 v61, v61
    v_exp_f32 v62, v62
    v_exp_f32 v63, v63
    v_cvt_pk_bf16_f32 v34, v60, v61
    v_cvt_pk_bf16_f32 v35, v62, v63
    v_mfma_f32_32x32x8_bf16 v[72:87], v[16:17], v[8:9], v[72:87]
    buffer_load_dwordx4 v[188:191], v239, s[92:95], s59 offen offset:2048 sc1
    v_exp_f32 v64, v64
    v_exp_f32 v65, v65
    v_exp_f32 v66, v66
    v_exp_f32 v67, v67
    v_cvt_pk_bf16_f32 v36, v64, v65
    v_cvt_pk_bf16_f32 v37, v66, v67
    v_mfma_f32_32x32x16_bf16 v[40:55], v[20:23], v[32:35], v[40:55]
    v_exp_f32 v68, v68
    v_exp_f32 v69, v69
    v_exp_f32 v70, v70
    v_exp_f32 v71, v71
    v_cvt_pk_bf16_f32 v38, v68, v69
    v_cvt_pk_bf16_f32 v39, v70, v71
    s_waitcnt lgkmcnt(0)
    v_mfma_f32_32x32x16_bf16 v[56:71], v[12:15], v[4:7], 0
    ds_read_b128 v[12:15], v88 offset:17920
    ds_read_b64 v[16:17], v89 offset:17920
    s_mov_b64 exec, s[48:49]
    ds_read_b128 v[20:23], v90 offset:15360
    ds_read_b128 v[28:31], v90 offset:13440
    s_mov_b64 exec, -1
    v_exp_f32 v72, v72
    v_exp_f32 v73, v73
    v_exp_f32 v74, v74
    v_exp_f32 v75, v75
    v_cvt_pk_bf16_f32 v32, v72, v73
    v_cvt_pk_bf16_f32 v33, v74, v75
    v_mfma_f32_32x32x16_bf16 v[40:55], v[24:27], v[36:39], v[40:55]
    buffer_load_dwordx4 v[192:195], v239, s[92:95], s59 offen offset:3072 sc1
    buffer_load_dwordx4 v[196:199], v240, s[92:95], s59 offen offset:0 sc1
    v_exp_f32 v76, v76
    v_exp_f32 v77, v77
    v_exp_f32 v78, v78
    v_exp_f32 v79, v79
    v_cvt_pk_bf16_f32 v34, v76, v77
    v_cvt_pk_bf16_f32 v35, v78, v79
    v_mfma_f32_32x32x8_bf16 v[56:71], v[100:101], v[8:9], v[56:71]
    s_add_u32 s58, s3, 8
    s_mul_i32 s58, s58, 131072
    buffer_load_dwordx4 v[164:167], v236, s[64:67], s58 offen offset:0 sc1
    v_exp_f32 v80, v80
    v_exp_f32 v81, v81
    v_exp_f32 v82, v82
    v_exp_f32 v83, v83
    v_cvt_pk_bf16_f32 v36, v80, v81
    v_cvt_pk_bf16_f32 v37, v82, v83
    v_mfma_f32_32x32x16_bf16 v[40:55], v[104:107], v[32:35], v[40:55]
    v_exp_f32 v84, v84
    v_exp_f32 v85, v85
    v_exp_f32 v86, v86
    v_exp_f32 v87, v87
    v_cvt_pk_bf16_f32 v38, v84, v85
    v_cvt_pk_bf16_f32 v39, v86, v87
    s_waitcnt lgkmcnt(0)
    v_mfma_f32_32x32x16_bf16 v[72:87], v[12:15], v[4:7], 0
    ds_read_b128 v[12:15], v88 offset:20480
    ds_read_b64 v[100:101], v89 offset:20480
    s_mov_b64 exec, s[48:49]
    ds_read_b128 v[104:107], v90 offset:17920
    ds_read_b128 v[24:27], v90 offset:16000
    s_mov_b64 exec, -1
    v_exp_f32 v56, v56
    v_exp_f32 v57, v57
    v_exp_f32 v58, v58
    v_exp_f32 v59, v59
    v_cvt_pk_bf16_f32 v32, v56, v57
    v_cvt_pk_bf16_f32 v33, v58, v59
    v_mfma_f32_32x32x16_bf16 v[40:55], v[28:31], v[36:39], v[40:55]
    buffer_load_dwordx4 v[168:171], v236, s[64:67], s58 offen offset:512 sc1
    v_exp_f32 v60, v60
    v_exp_f32 v61, v61
    v_exp_f32 v62, v62
    v_exp_f32 v63, v63
    v_cvt_pk_bf16_f32 v34, v60, v61
    v_cvt_pk_bf16_f32 v35, v62, v63
    v_mfma_f32_32x32x8_bf16 v[72:87], v[16:17], v[8:9], v[72:87]
    buffer_load_dwordx4 v[172:175], v236, s[64:67], s58 offen offset:1024 sc1
    v_exp_f32 v64, v64
    v_exp_f32 v65, v65
    v_exp_f32 v66, v66
    v_exp_f32 v67, v67
    v_cvt_pk_bf16_f32 v36, v64, v65
    v_cvt_pk_bf16_f32 v37, v66, v67
    v_mfma_f32_32x32x16_bf16 v[40:55], v[20:23], v[32:35], v[40:55]
    v_exp_f32 v68, v68
    v_exp_f32 v69, v69
    v_exp_f32 v70, v70
    v_exp_f32 v71, v71
    v_cvt_pk_bf16_f32 v38, v68, v69
    v_cvt_pk_bf16_f32 v39, v70, v71
    s_waitcnt lgkmcnt(0)
    v_mfma_f32_32x32x16_bf16 v[56:71], v[12:15], v[4:7], 0
    ds_read_b128 v[12:15], v88 offset:23040
    ds_read_b64 v[16:17], v89 offset:23040
    s_mov_b64 exec, s[48:49]
    ds_read_b128 v[20:23], v90 offset:20480
    ds_read_b128 v[28:31], v90 offset:18560
    s_mov_b64 exec, -1
    v_exp_f32 v72, v72
    v_exp_f32 v73, v73
    v_exp_f32 v74, v74
    v_exp_f32 v75, v75
    v_cvt_pk_bf16_f32 v32, v72, v73
    v_cvt_pk_bf16_f32 v33, v74, v75
    v_mfma_f32_32x32x16_bf16 v[40:55], v[24:27], v[36:39], v[40:55]
    buffer_load_dwordx4 v[176:179], v236, s[64:67], s58 offen offset:1536 sc1
    s_add_u32 s59, s3, 16
    s_mul_i32 s59, s59, 40960
    buffer_load_dwordx4 v[216:219], v239, s[92:95], s59 offen offset:0 sc1
    v_exp_f32 v76, v76
    v_exp_f32 v77, v77
    v_exp_f32 v78, v78
    v_exp_f32 v79, v79
    v_cvt_pk_bf16_f32 v34, v76, v77
    v_cvt_pk_bf16_f32 v35, v78, v79
    v_mfma_f32_32x32x8_bf16 v[56:71], v[100:101], v[8:9], v[56:71]
    buffer_load_dwordx4 v[220:223], v239, s[92:95], s59 offen offset:1024 sc1
    v_exp_f32 v80, v80
    v_exp_f32 v81, v81
    v_exp_f32 v82, v82
    v_exp_f32 v83, v83
    v_cvt_pk_bf16_f32 v36, v80, v81
    v_cvt_pk_bf16_f32 v37, v82, v83
    v_mfma_f32_32x32x16_bf16 v[40:55], v[104:107], v[32:35], v[40:55]
    v_exp_f32 v84, v84
    v_exp_f32 v85, v85
    v_exp_f32 v86, v86
    v_exp_f32 v87, v87
    v_cvt_pk_bf16_f32 v38, v84, v85
    v_cvt_pk_bf16_f32 v39, v86, v87
    s_waitcnt lgkmcnt(0)
    v_mfma_f32_32x32x16_bf16 v[72:87], v[12:15], v[4:7], 0
    ds_read_b128 v[12:15], v88 offset:25600
    ds_read_b64 v[100:101], v89 offset:25600
    s_mov_b64 exec, s[48:49]
    ds_read_b128 v[104:107], v90 offset:23040
    ds_read_b128 v[24:27], v90 offset:21120
    s_mov_b64 exec, -1
    v_exp_f32 v56, v56
    v_exp_f32 v57, v57
    v_exp_f32 v58, v58
    v_exp_f32 v59, v59
    v_cvt_pk_bf16_f32 v32, v56, v57
    v_cvt_pk_bf16_f32 v33, v58, v59
    v_mfma_f32_32x32x16_bf16 v[40:55], v[28:31], v[36:39], v[40:55]
    buffer_load_dwordx4 v[224:227], v239, s[92:95], s59 offen offset:2048 sc1
    v_exp_f32 v60, v60
    v_exp_f32 v61, v61
    v_exp_f32 v62, v62
    v_exp_f32 v63, v63
    v_cvt_pk_bf16_f32 v34, v60, v61
    v_cvt_pk_bf16_f32 v35, v62, v63
    v_mfma_f32_32x32x8_bf16 v[72:87], v[16:17], v[8:9], v[72:87]
    buffer_load_dwordx4 v[228:231], v239, s[92:95], s59 offen offset:3072 sc1
    buffer_load_dwordx4 v[232:235], v240, s[92:95], s59 offen offset:0 sc1
    v_exp_f32 v64, v64
    v_exp_f32 v65, v65
    v_exp_f32 v66, v66
    v_exp_f32 v67, v67
    v_cvt_pk_bf16_f32 v36, v64, v65
    v_cvt_pk_bf16_f32 v37, v66, v67
    v_mfma_f32_32x32x16_bf16 v[40:55], v[20:23], v[32:35], v[40:55]
    v_exp_f32 v68, v68
    v_exp_f32 v69, v69
    v_exp_f32 v70, v70
    v_exp_f32 v71, v71
    v_cvt_pk_bf16_f32 v38, v68, v69
    v_cvt_pk_bf16_f32 v39, v70, v71
    s_waitcnt lgkmcnt(0)
    v_mfma_f32_32x32x16_bf16 v[56:71], v[12:15], v[4:7], 0
    ds_read_b128 v[12:15], v88 offset:28160
    ds_read_b64 v[16:17], v89 offset:28160
    s_mov_b64 exec, s[48:49]
    ds_read_b128 v[20:23], v90 offset:25600
    ds_read_b128 v[28:31], v90 offset:23680
    s_mov_b64 exec, -1
    v_exp_f32 v72, v72
    v_exp_f32 v73, v73
    v_exp_f32 v74, v74
    v_exp_f32 v75, v75
    v_cvt_pk_bf16_f32 v32, v72, v73
    v_cvt_pk_bf16_f32 v33, v74, v75
    v_mfma_f32_32x32x16_bf16 v[40:55], v[24:27], v[36:39], v[40:55]
    s_add_u32 s58, s3, 16
    s_mul_i32 s58, s58, 131072
    buffer_load_dwordx4 v[200:203], v236, s[64:67], s58 offen offset:0 sc1
    v_exp_f32 v76, v76
    v_exp_f32 v77, v77
    v_exp_f32 v78, v78
    v_exp_f32 v79, v79
    v_cvt_pk_bf16_f32 v34, v76, v77
    v_cvt_pk_bf16_f32 v35, v78, v79
    v_mfma_f32_32x32x8_bf16 v[56:71], v[100:101], v[8:9], v[56:71]
    buffer_load_dwordx4 v[204:207], v236, s[64:67], s58 offen offset:512 sc1
    v_exp_f32 v80, v80
    v_exp_f32 v81, v81
    v_exp_f32 v82, v82
    v_exp_f32 v83, v83
    v_cvt_pk_bf16_f32 v36, v80, v81
    v_cvt_pk_bf16_f32 v37, v82, v83
    v_mfma_f32_32x32x16_bf16 v[40:55], v[104:107], v[32:35], v[40:55]
    v_exp_f32 v84, v84
    v_exp_f32 v85, v85
    v_exp_f32 v86, v86
    v_exp_f32 v87, v87
    v_cvt_pk_bf16_f32 v38, v84, v85
    v_cvt_pk_bf16_f32 v39, v86, v87
    s_waitcnt lgkmcnt(0)
    v_mfma_f32_32x32x16_bf16 v[72:87], v[12:15], v[4:7], 0
    ds_read_b128 v[12:15], v88 offset:30720
    ds_read_b64 v[100:101], v89 offset:30720
    s_mov_b64 exec, s[48:49]
    ds_read_b128 v[104:107], v90 offset:28160
    ds_read_b128 v[24:27], v90 offset:26240
    s_mov_b64 exec, -1
    v_exp_f32 v56, v56
    v_exp_f32 v57, v57
    v_exp_f32 v58, v58
    v_exp_f32 v59, v59
    v_cvt_pk_bf16_f32 v32, v56, v57
    v_cvt_pk_bf16_f32 v33, v58, v59
    v_mfma_f32_32x32x16_bf16 v[40:55], v[28:31], v[36:39], v[40:55]
    buffer_load_dwordx4 v[208:211], v236, s[64:67], s58 offen offset:1024 sc1
    v_exp_f32 v60, v60
    v_exp_f32 v61, v61
    v_exp_f32 v62, v62
    v_exp_f32 v63, v63
    v_cvt_pk_bf16_f32 v34, v60, v61
    v_cvt_pk_bf16_f32 v35, v62, v63
    v_mfma_f32_32x32x8_bf16 v[72:87], v[16:17], v[8:9], v[72:87]
    buffer_load_dwordx4 v[212:215], v236, s[64:67], s58 offen offset:1536 sc1
    s_add_u32 s59, s3, 24
    s_mul_i32 s59, s59, 40960
    buffer_load_dwordx4 v[108:111], v239, s[92:95], s59 offen offset:0 sc1
    v_exp_f32 v64, v64
    v_exp_f32 v65, v65
    v_exp_f32 v66, v66
    v_exp_f32 v67, v67
    v_cvt_pk_bf16_f32 v36, v64, v65
    v_cvt_pk_bf16_f32 v37, v66, v67
    v_mfma_f32_32x32x16_bf16 v[40:55], v[20:23], v[32:35], v[40:55]
    v_exp_f32 v68, v68
    v_exp_f32 v69, v69
    v_exp_f32 v70, v70
    v_exp_f32 v71, v71
    v_cvt_pk_bf16_f32 v38, v68, v69
    v_cvt_pk_bf16_f32 v39, v70, v71
    s_waitcnt lgkmcnt(0)
    v_mfma_f32_32x32x16_bf16 v[56:71], v[12:15], v[4:7], 0
    ds_read_b128 v[12:15], v88 offset:33280
    ds_read_b64 v[16:17], v89 offset:33280
    s_mov_b64 exec, s[48:49]
    ds_read_b128 v[20:23], v90 offset:30720
    ds_read_b128 v[28:31], v90 offset:28800
    s_mov_b64 exec, -1
    v_exp_f32 v72, v72
    v_exp_f32 v73, v73
    v_exp_f32 v74, v74
    v_exp_f32 v75, v75
    v_cvt_pk_bf16_f32 v32, v72, v73
    v_cvt_pk_bf16_f32 v33, v74, v75
    v_mfma_f32_32x32x16_bf16 v[40:55], v[24:27], v[36:39], v[40:55]
    buffer_load_dwordx4 v[112:115], v239, s[92:95], s59 offen offset:1024 sc1
    v_exp_f32 v76, v76
    v_exp_f32 v77, v77
    v_exp_f32 v78, v78
    v_exp_f32 v79, v79
    v_cvt_pk_bf16_f32 v34, v76, v77
    v_cvt_pk_bf16_f32 v35, v78, v79
    v_mfma_f32_32x32x8_bf16 v[56:71], v[100:101], v[8:9], v[56:71]
    buffer_load_dwordx4 v[116:119], v239, s[92:95], s59 offen offset:2048 sc1
    v_exp_f32 v80, v80
    v_exp_f32 v81, v81
    v_exp_f32 v82, v82
    v_exp_f32 v83, v83
    v_cvt_pk_bf16_f32 v36, v80, v81
    v_cvt_pk_bf16_f32 v37, v82, v83
    v_mfma_f32_32x32x16_bf16 v[40:55], v[104:107], v[32:35], v[40:55]
    v_exp_f32 v84, v84
    v_exp_f32 v85, v85
    v_exp_f32 v86, v86
    v_exp_f32 v87, v87
    v_cvt_pk_bf16_f32 v38, v84, v85
    v_cvt_pk_bf16_f32 v39, v86, v87
    s_waitcnt lgkmcnt(0)
    v_mfma_f32_32x32x16_bf16 v[72:87], v[12:15], v[4:7], 0
    ds_read_b128 v[12:15], v88 offset:35840
    ds_read_b64 v[100:101], v89 offset:35840
    s_mov_b64 exec, s[48:49]
    ds_read_b128 v[104:107], v90 offset:33280
    ds_read_b128 v[24:27], v90 offset:31360
    s_mov_b64 exec, -1
    v_exp_f32 v56, v56
    v_exp_f32 v57, v57
    v_exp_f32 v58, v58
    v_exp_f32 v59, v59
    v_cvt_pk_bf16_f32 v32, v56, v57
    v_cvt_pk_bf16_f32 v33, v58, v59
    v_mfma_f32_32x32x16_bf16 v[40:55], v[28:31], v[36:39], v[40:55]
    buffer_load_dwordx4 v[120:123], v239, s[92:95], s59 offen offset:3072 sc1
    buffer_load_dwordx4 v[124:127], v240, s[92:95], s59 offen offset:0 sc1
    v_exp_f32 v60, v60
    v_exp_f32 v61, v61
    v_exp_f32 v62, v62
    v_exp_f32 v63, v63
    v_cvt_pk_bf16_f32 v34, v60, v61
    v_cvt_pk_bf16_f32 v35, v62, v63
    v_mfma_f32_32x32x8_bf16 v[72:87], v[16:17], v[8:9], v[72:87]
    s_add_u32 s59, s3, 32
    s_mul_i32 s59, s59, 40960
    s_mul_i32 s60, s3, 9216
    s_mov_b32 m0, s60
    s_nop 0
    buffer_load_dwordx4 v239, s[92:95], s59 offen offset:0 sc1 lds
    v_exp_f32 v64, v64
    v_exp_f32 v65, v65
    v_exp_f32 v66, v66
    v_exp_f32 v67, v67
    v_cvt_pk_bf16_f32 v36, v64, v65
    v_cvt_pk_bf16_f32 v37, v66, v67
    v_mfma_f32_32x32x16_bf16 v[40:55], v[20:23], v[32:35], v[40:55]
    v_exp_f32 v68, v68
    v_exp_f32 v69, v69
    v_exp_f32 v70, v70
    v_exp_f32 v71, v71
    v_cvt_pk_bf16_f32 v38, v68, v69
    v_cvt_pk_bf16_f32 v39, v70, v71
    s_setprio 0
    s_waitcnt lgkmcnt(0)
    v_mfma_f32_32x32x16_bf16 v[56:71], v[12:15], v[4:7], 0
    ds_read_b128 v[12:15], v88 offset:38400
    ds_read_b64 v[16:17], v89 offset:38400
    s_mov_b64 exec, s[48:49]
    ds_read_b128 v[20:23], v90 offset:35840
    ds_read_b128 v[28:31], v90 offset:33920
    s_mov_b64 exec, -1
    v_exp_f32 v72, v72
    v_exp_f32 v73, v73
    v_exp_f32 v74, v74
    v_exp_f32 v75, v75
    v_cvt_pk_bf16_f32 v32, v72, v73
    v_cvt_pk_bf16_f32 v33, v74, v75
    v_mfma_f32_32x32x16_bf16 v[40:55], v[24:27], v[36:39], v[40:55]
    buffer_load_dwordx4 v239, s[92:95], s59 offen offset:1024 sc1 lds
    v_exp_f32 v76, v76
    v_exp_f32 v77, v77
    v_exp_f32 v78, v78
    v_exp_f32 v79, v79
    v_cvt_pk_bf16_f32 v34, v76, v77
    v_cvt_pk_bf16_f32 v35, v78, v79
    v_mfma_f32_32x32x8_bf16 v[56:71], v[100:101], v[8:9], v[56:71]
    buffer_load_dwordx4 v239, s[92:95], s59 offen offset:2048 sc1 lds
    v_exp_f32 v80, v80
    v_exp_f32 v81, v81
    v_exp_f32 v82, v82
    v_exp_f32 v83, v83
    v_cvt_pk_bf16_f32 v36, v80, v81
    v_cvt_pk_bf16_f32 v37, v82, v83
    v_mfma_f32_32x32x16_bf16 v[40:55], v[104:107], v[32:35], v[40:55]
    v_exp_f32 v84, v84
    v_exp_f32 v85, v85
    v_exp_f32 v86, v86
    v_exp_f32 v87, v87
    v_cvt_pk_bf16_f32 v38, v84, v85
    v_cvt_pk_bf16_f32 v39, v86, v87
    s_waitcnt lgkmcnt(0)
    v_mfma_f32_32x32x16_bf16 v[72:87], v[12:15], v[4:7], 0
    ds_read_b128 v[12:15], v88 offset:0
    ds_read_b64 v[100:101], v89 offset:0
    s_mov_b64 exec, s[48:49]
    ds_read_b128 v[104:107], v90 offset:38400
    ds_read_b128 v[24:27], v90 offset:36480
    s_mov_b64 exec, -1
    v_exp_f32 v56, v56
    v_exp_f32 v57, v57
    v_exp_f32 v58, v58
    v_exp_f32 v59, v59
    v_cvt_pk_bf16_f32 v32, v56, v57
    v_cvt_pk_bf16_f32 v33, v58, v59
    v_mfma_f32_32x32x16_bf16 v[40:55], v[28:31], v[36:39], v[40:55]
    buffer_load_dwordx4 v239, s[92:95], s59 offen offset:3072 sc1 lds
    s_add_u32 m0, m0, 4096
    s_nop 0
    buffer_load_dwordx4 v240, s[92:95], s59 offen sc1 lds
    v_exp_f32 v60, v60
    v_exp_f32 v61, v61
    v_exp_f32 v62, v62
    v_exp_f32 v63, v63
    v_cvt_pk_bf16_f32 v34, v60, v61
    v_cvt_pk_bf16_f32 v35, v62, v63
    v_mfma_f32_32x32x8_bf16 v[72:87], v[16:17], v[8:9], v[72:87]
    s_add_u32 s58, s3, 32
    s_mul_i32 s58, s58, 131072
    s_add_u32 m0, m0, 1024
    s_nop 0
    buffer_load_dwordx4 v236, s[64:67], s58 offen sc1 lds
    v_exp_f32 v64, v64
    v_exp_f32 v65, v65
    v_exp_f32 v66, v66
    v_exp_f32 v67, v67
    v_cvt_pk_bf16_f32 v36, v64, v65
    v_cvt_pk_bf16_f32 v37, v66, v67
    v_mfma_f32_32x32x16_bf16 v[40:55], v[20:23], v[32:35], v[40:55]
    v_exp_f32 v68, v68
    v_exp_f32 v69, v69
    v_exp_f32 v70, v70
    v_exp_f32 v71, v71
    v_cvt_pk_bf16_f32 v38, v68, v69
    v_cvt_pk_bf16_f32 v39, v70, v71
    s_waitcnt lgkmcnt(0)
    v_mfma_f32_32x32x16_bf16 v[56:71], v[12:15], v[4:7], 0
    ds_read_b128 v[12:15], v88 offset:2560
    ds_read_b64 v[16:17], v89 offset:2560
    s_mov_b64 exec, s[48:49]
    ds_read_b128 v[20:23], v90 offset:0
    ds_read_b128 v[28:31], v90 offset:39040
    s_mov_b64 exec, -1
    v_exp_f32 v72, v72
    v_exp_f32 v73, v73
    v_exp_f32 v74, v74
    v_exp_f32 v75, v75
    v_cvt_pk_bf16_f32 v32, v72, v73
    v_cvt_pk_bf16_f32 v33, v74, v75
    v_mfma_f32_32x32x16_bf16 v[40:55], v[24:27], v[36:39], v[40:55]
    s_add_u32 m0, m0, 1024
    s_nop 0
    buffer_load_dwordx4 v252, s[64:67], s58 offen sc1 lds
    v_exp_f32 v76, v76
    v_exp_f32 v77, v77
    v_exp_f32 v78, v78
    v_exp_f32 v79, v79
    v_cvt_pk_bf16_f32 v34, v76, v77
    v_cvt_pk_bf16_f32 v35, v78, v79
    v_mfma_f32_32x32x8_bf16 v[56:71], v[100:101], v[8:9], v[56:71]
    s_add_u32 m0, m0, 1024
    s_nop 0
    buffer_load_dwordx4 v253, s[64:67], s58 offen sc1 lds
    s_add_u32 m0, m0, 1024
    s_nop 0
    buffer_load_dwordx4 v254, s[64:67], s58 offen sc1 lds
    v_exp_f32 v80, v80
    v_exp_f32 v81, v81
    v_exp_f32 v82, v82
    v_exp_f32 v83, v83
    v_cvt_pk_bf16_f32 v36, v80, v81
    v_cvt_pk_bf16_f32 v37, v82, v83
    v_mfma_f32_32x32x16_bf16 v[40:55], v[104:107], v[32:35], v[40:55]
    v_exp_f32 v84, v84
    v_exp_f32 v85, v85
    v_exp_f32 v86, v86
    v_exp_f32 v87, v87
    v_cvt_pk_bf16_f32 v38, v84, v85
    v_cvt_pk_bf16_f32 v39, v86, v87
    s_branch p2_tail
p2_plain:
    s_setprio 0
    s_cmp_lt_u32 s3, 4
    s_cbranch_scc1 lp_43
    s_setprio 1
lp_43:
    s_waitcnt lgkmcnt(0)
    v_mfma_f32_32x32x16_bf16 v[72:87], v[12:15], v[4:7], 0
    ds_read_b128 v[12:15], v88 offset:5120
    ds_read_b64 v[100:101], v89 offset:5120
    s_mov_b64 exec, s[48:49]
    ds_read_b128 v[104:107], v90 offset:2560
    ds_read_b128 v[24:27], v90 offset:640
    s_mov_b64 exec, -1
    v_exp_f32 v56, v56
    v_exp_f32 v57, v57
    v_exp_f32 v58, v58
    v_exp_f32 v59, v59
    v_cvt_pk_bf16_f32 v32, v56, v57
    v_cvt_pk_bf16_f32 v33, v58, v59
    v_mfma_f32_32x32x16_bf16 v[40:55], v[28:31], v[36:39], v[40:55]
    v_exp_f32 v60, v60
    v_exp_f32 v61, v61
    v_exp_f32 v62, v62
    v_exp_f32 v63, v63
    v_cvt_pk_bf16_f32 v34, v60, v61
    v_cvt_pk_bf16_f32 v35, v62, v63
    v_mfma_f32_32x32x8_bf16 v[72:87], v[16:17], v[8:9], v[72:87]
    v_exp_f32 v64, v64
    v_exp_f32 v65, v65
    v_exp_f32 v66, v66
    v_exp_f32 v67, v67
    v_cvt_pk_bf16_f32 v36, v64, v65
    v_cvt_pk_bf16_f32 v37, v66, v67
    v_mfma_f32_32x32x16_bf16 v[40:55], v[20:23], v[32:35], v[40:55]
    v_exp_f32 v68, v68
    v_exp_f32 v69, v69
    v_exp_f32 v70, v70
    v_exp_f32 v71, v71
    v_cvt_pk_bf16_f32 v38, v68, v69
    v_cvt_pk_bf16_f32 v39, v70, v71
    s_waitcnt lgkmcnt(0)
    v_mfma_f32_32x32x16_bf16 v[56:71], v[12:15], v[4:7], 0
    ds_read_b128 v[12:15], v88 offset:7680
    ds_read_b64 v[16:17], v89 offset:7680
    s_mov_b64 exec, s[48:49]
    ds_read_b128 v[20:23], v90 offset:5120
    ds_read_b128 v[28:31], v90 offset:3200
    s_mov_b64 exec, -1
    v_exp_f32 v72, v72
    v_exp_f32 v73, v73
    v_exp_f32 v74, v74
    v_exp_f32 v75, v75
    v_cvt_pk_bf16_f32 v32, v72, v73
    v_cvt_pk_bf16_f32 v33, v74, v75
    v_mfma_f32_32x32x16_bf16 v[40:55], v[24:27], v[36:39], v[40:55]
    v_exp_f32 v76, v76
    v_exp_f32 v77, v77
    v_exp_f32 v78, v78
    v_exp_f32 v79, v79
    v_cvt_pk_bf16_f32 v34, v76, v77
    v_cvt_pk_bf16_f32 v35, v78, v79
    v_mfma_f32_32x32x8_bf16 v[56:71], v[100:101], v[8:9], v[56:71]
    v_exp_f32 v80, v80
    v_exp_f32 v81, v81
    v_exp_f32 v82, v82
    v_exp_f32 v83, v83
    v_cvt_pk_bf16_f32 v36, v80, v81
    v_cvt_pk_bf16_f32 v37, v82, v83
    v_mfma_f32_32x32x16_bf16 v[40:55], v[104:107], v[32:35], v[40:55]
    v_exp_f32 v84, v84
    v_exp_f32 v85, v85
    v_exp_f32 v86, v86
    v_exp_f32 v87, v87
    v_cvt_pk_bf16_f32 v38, v84, v85
    v_cvt_pk_bf16_f32 v39, v86, v87
    s_waitcnt lgkmcnt(0)
    v_mfma_f32_32x32x16_bf16 v[72:87], v[12:15], v[4:7], 0
    ds_read_b128 v[12:15], v88 offset:10240
    ds_read_b64 v[100:101], v89 offset:10240
    s_mov_b64 exec, s[48:49]
    ds_read_b128 v[104:107], v90 offset:7680
    ds_read_b128 v[24:27], v90 offset:5760
    s_mov_b64 exec, -1
    v_exp_f32 v56, v56
    v_exp_f32 v57, v57
    v_exp_f32 v58, v58
    v_exp_f32 v59, v59
    v_cvt_pk_bf16_f32 v32, v56, v57
    v_cvt_pk_bf16_f32 v33, v58, v59
    v_mfma_f32_32x32x16_bf16 v[40:55], v[28:31], v[36:39], v[40:55]
    v_exp_f32 v60, v60
    v_exp_f32 v61, v61
    v_exp_f32 v62, v62
    v_exp_f32 v63, v63
    v_cvt_pk_bf16_f32 v34, v60, v61
    v_cvt_pk_bf16_f32 v35, v62, v63
    v_mfma_f32_32x32x8_bf16 v[72:87], v[16:17], v[8:9], v[72:87]
    v_exp_f32 v64, v64
    v_exp_f32 v65, v65
    v_exp_f32 v66, v66
    v_exp_f32 v67, v67
    v_cvt_pk_bf16_f32 v36, v64, v65
    v_cvt_pk_bf16_f32 v37, v66, v67
    v_mfma_f32_32x32x16_bf16 v[40:55], v[20:23], v[32:35], v[40:55]
    v_exp_f32 v68, v68
    v_exp_f32 v69, v69
    v_exp_f32 v70, v70
    v_exp_f32 v71, v71
    v_cvt_pk_bf16_f32 v38, v68, v69
    v_cvt_pk_bf16_f32 v39, v70, v71
    s_waitcnt lgkmcnt(0)
    v_mfma_f32_32x32x16_bf16 v[56:71], v[12:15], v[4:7], 0
    ds_read_b128 v[12:15], v88 offset:12800
    ds_read_b64 v[16:17], v89 offset:12800
    s_mov_b64 exec, s[48:49]
    ds_read_b128 v[20:23], v90 offset:10240
    ds_read_b128 v[28:31], v90 offset:8320
    s_mov_b64 exec, -1
    v_exp_f32 v72, v72
    v_exp_f32 v73, v73
    v_exp_f32 v74, v74
    v_exp_f32 v75, v75
    v_cvt_pk_bf16_f32 v32, v72, v73
    v_cvt_pk_bf16_f32 v33, v74, v75
    v_mfma_f32_32x32x16_bf16 v[40:55], v[24:27], v[36:39], v[40:55]
    v_exp_f32 v76, v76
    v_exp_f32 v77, v77
    v_exp_f32 v78, v78
    v_exp_f32 v79, v79
    v_cvt_pk_bf16_f32 v34, v76, v77
    v_cvt_pk_bf16_f32 v35, v78, v79
    v_mfma_f32_32x32x8_bf16 v[56:71], v[100:101], v[8:9], v[56:71]
    v_exp_f32 v80, v80
    v_exp_f32 v81, v81
    v_exp_f32 v82, v82
    v_exp_f32 v83, v83
    v_cvt_pk_bf16_f32 v36, v80, v81
    v_cvt_pk_bf16_f32 v37, v82, v83
    v_mfma_f32_32x32x16_bf16 v[40:55], v[104:107], v[32:35], v[40:55]
    v_exp_f32 v84, v84
    v_exp_f32 v85, v85
    v_exp_f32 v86, v86
    v_exp_f32 v87, v87
    v_cvt_pk_bf16_f32 v38, v84, v85
    v_cvt_pk_bf16_f32 v39, v86, v87
    s_waitcnt lgkmcnt(0)
    v_mfma_f32_32x32x16_bf16 v[72:87], v[12:15], v[4:7], 0
    ds_read_b128 v[12:15], v88 offset:15360
    ds_read_b64 v[100:101], v89 offset:15360
    s_mov_b64 exec, s[48:49]
    ds_read_b128 v[104:107], v90 offset:12800
    ds_read_b128 v[24:27], v90 offset:10880
    s_mov_b64 exec, -1
    v_exp_f32 v56, v56
    v_exp_f32 v57, v57
    v_exp_f32 v58, v58
    v_exp_f32 v59, v59
    v_cvt_pk_bf16_f32 v32, v56, v57
    v_cvt_pk_bf16_f32 v33, v58, v59
    v_mfma_f32_32x32x16_bf16 v[40:55], v[28:31], v[36:39], v[40:55]
    v_exp_f32 v60, v60
    v_exp_f32 v61, v61
    v_exp_f32 v62, v62
    v_exp_f32 v63, v63
    v_cvt_pk_bf16_f32 v34, v60, v61
    v_cvt_pk_bf16_f32 v35, v62, v63
    v_mfma_f32_32x32x8_bf16 v[72:87], v[16:17], v[8:9], v[72:87]
    v_exp_f32 v64, v64
    v_exp_f32 v65, v65
    v_exp_f32 v66, v66
    v_exp_f32 v67, v67
    v_cvt_pk_bf16_f32 v36, v64, v65
    v_cvt_pk_bf16_f32 v37, v66, v67
    v_mfma_f32_32x32x16_bf16 v[40:55], v[20:23], v[32:35], v[40:55]
    v_exp_f32 v68, v68
    v_exp_f32 v69, v69
    v_exp_f32 v70, v70
    v_exp_f32 v71, v71
    v_cvt_pk_bf16_f32 v38, v68, v69
    v_cvt_pk_bf16_f32 v39, v70, v71
    s_waitcnt lgkmcnt(0)
    v_mfma_f32_32x32x16_bf16 v[56:71], v[12:15], v[4:7], 0
    ds_read_b128 v[12:15], v88 offset:17920
    ds_read_b64 v[16:17], v89 offset:17920
    s_mov_b64 exec, s[48:49]
    ds_read_b128 v[20:23], v90 offset:15360
    ds_read_b128 v[28:31], v90 offset:13440
    s_mov_b64 exec, -1
    v_exp_f32 v72, v72
    v_exp_f32 v73, v73
    v_exp_f32 v74, v74
    v_exp_f32 v75, v75
    v_cvt_pk_bf16_f32 v32, v72, v73
    v_cvt_pk_bf16_f32 v33, v74, v75
    v_mfma_f32_32x32x16_bf16 v[40:55], v[24:27], v[36:39], v[40:55]
    v_exp_f32 v76, v76
    v_exp_f32 v77, v77
    v_exp_f32 v78, v78
    v_exp_f32 v79, v79
    v_cvt_pk_bf16_f32 v34, v76, v77
    v_cvt_pk_bf16_f32 v35, v78, v79
    v_mfma_f32_32x32x8_bf16 v[56:71], v[100:101], v[8:9], v[56:71]
    v_exp_f32 v80, v80
    v_exp_f32 v81, v81
    v_exp_f32 v82, v82
    v_exp_f32 v83, v83
    v_cvt_pk_bf16_f32 v36, v80, v81
    v_cvt_pk_bf16_f32 v37, v82, v83
    v_mfma_f32_32x32x16_bf16 v[40:55], v[104:107], v[32:35], v[40:55]
    v_exp_f32 v84, v84
    v_exp_f32 v85, v85
    v_exp_f32 v86, v86
    v_exp_f32 v87, v87
    v_cvt_pk_bf16_f32 v38, v84, v85
    v_cvt_pk_bf16_f32 v39, v86, v87
    s_waitcnt lgkmcnt(0)
    v_mfma_f32_32x32x16_bf16 v[72:87], v[12:15], v[4:7], 0
    ds_read_b128 v[12:15], v88 offset:20480
    ds_read_b64 v[100:101], v89 offset:20480
    s_mov_b64 exec, s[48:49]
    ds_read_b128 v[104:107], v90 offset:17920
    ds_read_b128 v[24:27], v90 offset:16000
    s_mov_b64 exec, -1
    v_exp_f32 v56, v56
    v_exp_f32 v57, v57
    v_exp_f32 v58, v58
    v_exp_f32 v59, v59
    v_cvt_pk_bf16_f32 v32, v56, v57
    v_cvt_pk_bf16_f32 v33, v58, v59
    v_mfma_f32_32x32x16_bf16 v[40:55], v[28:31], v[36:39], v[40:55]
    v_exp_f32 v60, v60
    v_exp_f32 v61, v61
    v_exp_f32 v62, v62
    v_exp_f32 v63, v63
    v_cvt_pk_bf16_f32 v34, v60, v61
    v_cvt_pk_bf16_f32 v35, v62, v63
    v_mfma_f32_32x32x8_bf16 v[72:87], v[16:17], v[8:9], v[72:87]
    v_exp_f32 v64, v64
    v_exp_f32 v65, v65
    v_exp_f32 v66, v66
    v_exp_f32 v67, v67
    v_cvt_pk_bf16_f32 v36, v64, v65
    v_cvt_pk_bf16_f32 v37, v66, v67
    v_mfma_f32_32x32x16_bf16 v[40:55], v[20:23], v[32:35], v[40:55]
    v_exp_f32 v68, v68
    v_exp_f32 v69, v69
    v_exp_f32 v70, v70
    v_exp_f32 v71, v71
    v_cvt_pk_bf16_f32 v38, v68, v69
    v_cvt_pk_bf16_f32 v39, v70, v71
    s_waitcnt lgkmcnt(0)
    v_mfma_f32_32x32x16_bf16 v[56:71], v[12:15], v[4:7], 0
    ds_read_b128 v[12:15], v88 offset:23040
    ds_read_b64 v[16:17], v89 offset:23040
    s_mov_b64 exec, s[48:49]
    ds_read_b128 v[20:23], v90 offset:20480
    ds_read_b128 v[28:31], v90 offset:18560
    s_mov_b64 exec, -1
    v_exp_f32 v72, v72
    v_exp_f32 v73, v73
    v_exp_f32 v74, v74
    v_exp_f32 v75, v75
    v_cvt_pk_bf16_f32 v32, v72, v73
    v_cvt_pk_bf16_f32 v33, v74, v75
    v_mfma_f32_32x32x16_bf16 v[40:55], v[24:27], v[36:39], v[40:55]
    v_exp_f32 v76, v76
    v_exp_f32 v77, v77
    v_exp_f32 v78, v78
    v_exp_f32 v79, v79
    v_cvt_pk_bf16_f32 v34, v76, v77
    v_cvt_pk_bf16_f32 v35, v78, v79
    v_mfma_f32_32x32x8_bf16 v[56:71], v[100:101], v[8:9], v[56:71]
    v_exp_f32 v80, v80
    v_exp_f32 v81, v81
    v_exp_f32 v82, v82
    v_exp_f32 v83, v83
    v_cvt_pk_bf16_f32 v36, v80, v81
    v_cvt_pk_bf16_f32 v37, v82, v83
    v_mfma_f32_32x32x16_bf16 v[40:55], v[104:107], v[32:35], v[40:55]
    v_exp_f32 v84, v84
    v_exp_f32 v85, v85
    v_exp_f32 v86, v86
    v_exp_f32 v87, v87
    v_cvt_pk_bf16_f32 v38, v84, v85
    v_cvt_pk_bf16_f32 v39, v86, v87
    s_waitcnt lgkmcnt(0)
    v_mfma_f32_32x32x16_bf16 v[72:87], v[12:15], v[4:7], 0
    ds_read_b128 v[12:15], v88 offset:25600
    ds_read_b64 v[100:101], v89 offset:25600
    s_mov_b64 exec, s[48:49]
    ds_read_b128 v[104:107], v90 offset:23040
    ds_read_b128 v[24:27], v90 offset:21120
    s_mov_b64 exec, -1
    v_exp_f32 v56, v56
    v_exp_f32 v57, v57
    v_exp_f32 v58, v58
    v_exp_f32 v59, v59
    v_cvt_pk_bf16_f32 v32, v56, v57
    v_cvt_pk_bf16_f32 v33, v58, v59
    v_mfma_f32_32x32x16_bf16 v[40:55], v[28:31], v[36:39], v[40:55]
    v_exp_f32 v60, v60
    v_exp_f32 v61, v61
    v_exp_f32 v62, v62
    v_exp_f32 v63, v63
    v_cvt_pk_bf16_f32 v34, v60, v61
    v_cvt_pk_bf16_f32 v35, v62, v63
    v_mfma_f32_32x32x8_bf16 v[72:87], v[16:17], v[8:9], v[72:87]
    v_exp_f32 v64, v64
    v_exp_f32 v65, v65
    v_exp_f32 v66, v66
    v_exp_f32 v67, v67
    v_cvt_pk_bf16_f32 v36, v64, v65
    v_cvt_pk_bf16_f32 v37, v66, v67
    v_mfma_f32_32x32x16_bf16 v[40:55], v[20:23], v[32:35], v[40:55]
    v_exp_f32 v68, v68
    v_exp_f32 v69, v69
    v_exp_f32 v70, v70
    v_exp_f32 v71, v71
    v_cvt_pk_bf16_f32 v38, v68, v69
    v_cvt_pk_bf16_f32 v39, v70, v71
    s_waitcnt lgkmcnt(0)
    v_mfma_f32_32x32x16_bf16 v[56:71], v[12:15], v[4:7], 0
    ds_read_b128 v[12:15], v88 offset:28160
    ds_read_b64 v[16:17], v89 offset:28160
    s_mov_b64 exec, s[48:49]
    ds_read_b128 v[20:23], v90 offset:25600
    ds_read_b128 v[28:31], v90 offset:23680
    s_mov_b64 exec, -1
    v_exp_f32 v72, v72
    v_exp_f32 v73, v73
    v_exp_f32 v74, v74
    v_exp_f32 v75, v75
    v_cvt_pk_bf16_f32 v32, v72, v73
    v_cvt_pk_bf16_f32 v33, v74, v75
    v_mfma_f32_32x32x16_bf16 v[40:55], v[24:27], v[36:39], v[40:55]
    v_exp_f32 v76, v76
    v_exp_f32 v77, v77
    v_exp_f32 v78, v78
    v_exp_f32 v79, v79
    v_cvt_pk_bf16_f32 v34, v76, v77
    v_cvt_pk_bf16_f32 v35, v78, v79
    v_mfma_f32_32x32x8_bf16 v[56:71], v[100:101], v[8:9], v[56:71]
    v_exp_f32 v80, v80
    v_exp_f32 v81, v81
    v_exp_f32 v82, v82
    v_exp_f32 v83, v83
    v_cvt_pk_bf16_f32 v36, v80, v81
    v_cvt_pk_bf16_f32 v37, v82, v83
    v_mfma_f32_32x32x16_bf16 v[40:55], v[104:107], v[32:35], v[40:55]
    v_exp_f32 v84, v84
    v_exp_f32 v85, v85
    v_exp_f32 v86, v86
    v_exp_f32 v87, v87
    v_cvt_pk_bf16_f32 v38, v84, v85
    v_cvt_pk_bf16_f32 v39, v86, v87
    s_waitcnt lgkmcnt(0)
    v_mfma_f32_32x32x16_bf16 v[72:87], v[12:15], v[4:7], 0
    ds_read_b128 v[12:15], v88 offset:30720
    ds_read_b64 v[100:101], v89 offset:30720
    s_mov_b64 exec, s[48:49]
    ds_read_b128 v[104:107], v90 offset:28160
    ds_read_b128 v[24:27], v90 offset:26240
    s_mov_b64 exec, -1
    v_exp_f32 v56, v56
    v_exp_f32 v57, v57
    v_exp_f32 v58, v58
    v_exp_f32 v59, v59
    v_cvt_pk_bf16_f32 v32, v56, v57
    v_cvt_pk_bf16_f32 v33, v58, v59
    v_mfma_f32_32x32x16_bf16 v[40:55], v[28:31], v[36:39], v[40:55]
    v_exp_f32 v60, v60
    v_exp_f32 v61, v61
    v_exp_f32 v62, v62
    v_exp_f32 v63, v63
    v_cvt_pk_bf16_f32 v34, v60, v61
    v_cvt_pk_bf16_f32 v35, v62, v63
    v_mfma_f32_32x32x8_bf16 v[72:87], v[16:17], v[8:9], v[72:87]
    v_exp_f32 v64, v64
    v_exp_f32 v65, v65
    v_exp_f32 v66, v66
    v_exp_f32 v67, v67
    v_cvt_pk_bf16_f32 v36, v64, v65
    v_cvt_pk_bf16_f32 v37, v66, v67
    v_mfma_f32_32x32x16_bf16 v[40:55], v[20:23], v[32:35], v[40:55]
    v_exp_f32 v68, v68
    v_exp_f32 v69, v69
    v_exp_f32 v70, v70
    v_exp_f32 v71, v71
    v_cvt_pk_bf16_f32 v38, v68, v69
    v_cvt_pk_bf16_f32 v39, v70, v71
    s_waitcnt lgkmcnt(0)
    v_mfma_f32_32x32x16_bf16 v[56:71], v[12:15], v[4:7], 0
    ds_read_b128 v[12:15], v88 offset:33280
    ds_read_b64 v[16:17], v89 offset:33280
    s_mov_b64 exec, s[48:49]
    ds_read_b128 v[20:23], v90 offset:30720
    ds_read_b128 v[28:31], v90 offset:28800
    s_mov_b64 exec, -1
    v_exp_f32 v72, v72
    v_exp_f32 v73, v73
    v_exp_f32 v74, v74
    v_exp_f32 v75, v75
    v_cvt_pk_bf16_f32 v32, v72, v73
    v_cvt_pk_bf16_f32 v33, v74, v75
    v_mfma_f32_32x32x16_bf16 v[40:55], v[24:27], v[36:39], v[40:55]
    v_exp_f32 v76, v76
    v_exp_f32 v77, v77
    v_exp_f32 v78, v78
    v_exp_f32 v79, v79
    v_cvt_pk_bf16_f32 v34, v76, v77
    v_cvt_pk_bf16_f32 v35, v78, v79
    v_mfma_f32_32x32x8_bf16 v[56:71], v[100:101], v[8:9], v[56:71]
    v_exp_f32 v80, v80
    v_exp_f32 v81, v81
    v_exp_f32 v82, v82
    v_exp_f32 v83, v83
    v_cvt_pk_bf16_f32 v36, v80, v81
    v_cvt_pk_bf16_f32 v37, v82, v83
    v_mfma_f32_32x32x16_bf16 v[40:55], v[104:107], v[32:35], v[40:55]
    v_exp_f32 v84, v84
    v_exp_f32 v85, v85
    v_exp_f32 v86, v86
    v_exp_f32 v87, v87
    v_cvt_pk_bf16_f32 v38, v84, v85
    v_cvt_pk_bf16_f32 v39, v86, v87
    s_waitcnt lgkmcnt(0)
    v_mfma_f32_32x32x16_bf16 v[72:87], v[12:15], v[4:7], 0
    ds_read_b128 v[12:15], v88 offset:35840
    ds_read_b64 v[100:101], v89 offset:35840
    s_mov_b64 exec, s[48:49]
    ds_read_b128 v[104:107], v90 offset:33280
    ds_read_b128 v[24:27], v90 offset:31360
    s_mov_b64 exec, -1
    v_exp_f32 v56, v56
    v_exp_f32 v57, v57
    v_exp_f32 v58, v58
    v_exp_f32 v59, v59
    v_cvt_pk_bf16_f32 v32, v56, v57
    v_cvt_pk_bf16_f32 v33, v58, v59
    v_mfma_f32_32x32x16_bf16 v[40:55], v[28:31], v[36:39], v[40:55]
    v_exp_f32 v60, v60
    v_exp_f32 v61, v61
    v_exp_f32 v62, v62
    v_exp_f32 v63, v63
    v_cvt_pk_bf16_f32 v34, v60, v61
    v_cvt_pk_bf16_f32 v35, v62, v63
    v_mfma_f32_32x32x8_bf16 v[72:87], v[16:17], v[8:9], v[72:87]
    v_exp_f32 v64, v64
    v_exp_f32 v65, v65
    v_exp_f32 v66, v66
    v_exp_f32 v67, v67
    v_cvt_pk_bf16_f32 v36, v64, v65
    v_cvt_pk_bf16_f32 v37, v66, v67
    v_mfma_f32_32x32x16_bf16 v[40:55], v[20:23], v[32:35], v[40:55]
    v_exp_f32 v68, v68
    v_exp_f32 v69, v69
    v_exp_f32 v70, v70
    v_exp_f32 v71, v71
    v_cvt_pk_bf16_f32 v38, v68, v69
    v_cvt_pk_bf16_f32 v39, v70, v71
    s_setprio 0
    s_waitcnt lgkmcnt(0)
    v_mfma_f32_32x32x16_bf16 v[56:71], v[12:15], v[4:7], 0
    ds_read_b128 v[12:15], v88 offset:38400
    ds_read_b64 v[16:17], v89 offset:38400
    s_mov_b64 exec, s[48:49]
    ds_read_b128 v[20:23], v90 offset:35840
    ds_read_b128 v[28:31], v90 offset:33920
    s_mov_b64 exec, -1
    v_exp_f32 v72, v72
    v_exp_f32 v73, v73
    v_exp_f32 v74, v74
    v_exp_f32 v75, v75
    v_cvt_pk_bf16_f32 v32, v72, v73
    v_cvt_pk_bf16_f32 v33, v74, v75
    v_mfma_f32_32x32x16_bf16 v[40:55], v[24:27], v[36:39], v[40:55]
    v_exp_f32 v76, v76
    v_exp_f32 v77, v77
    v_exp_f32 v78, v78
    v_exp_f32 v79, v79
    v_cvt_pk_bf16_f32 v34, v76, v77
    v_cvt_pk_bf16_f32 v35, v78, v79
    v_mfma_f32_32x32x8_bf16 v[56:71], v[100:101], v[8:9], v[56:71]
    v_exp_f32 v80, v80
    v_exp_f32 v81, v81
    v_exp_f32 v82, v82
    v_exp_f32 v83, v83
    v_cvt_pk_bf16_f32 v36, v80, v81
    v_cvt_pk_bf16_f32 v37, v82, v83
    v_mfma_f32_32x32x16_bf16 v[40:55], v[104:107], v[32:35], v[40:55]
    v_exp_f32 v84, v84
    v_exp_f32 v85, v85
    v_exp_f32 v86, v86
    v_exp_f32 v87, v87
    v_cvt_pk_bf16_f32 v38, v84, v85
    v_cvt_pk_bf16_f32 v39, v86, v87
    s_waitcnt lgkmcnt(0)
    v_mfma_f32_32x32x16_bf16 v[72:87], v[12:15], v[4:7], 0
    ds_read_b128 v[12:15], v88 offset:0
    ds_read_b64 v[100:101], v89 offset:0
    s_mov_b64 exec, s[48:49]
    ds_read_b128 v[104:107], v90 offset:38400
    ds_read_b128 v[24:27], v90 offset:36480
    s_mov_b64 exec, -1
    v_exp_f32 v56, v56
    v_exp_f32 v57, v57
    v_exp_f32 v58, v58
    v_exp_f32 v59, v59
    v_cvt_pk_bf16_f32 v32, v56, v57
    v_cvt_pk_bf16_f32 v33, v58, v59
    v_mfma_f32_32x32x16_bf16 v[40:55], v[28:31], v[36:39], v[40:55]
    v_exp_f32 v60, v60
    v_exp_f32 v61, v61
    v_exp_f32 v62, v62
    v_exp_f32 v63, v63
    v_cvt_pk_bf16_f32 v34, v60, v61
    v_cvt_pk_bf16_f32 v35, v62, v63
    v_mfma_f32_32x32x8_bf16 v[72:87], v[16:17], v[8:9], v[72:87]
    v_exp_f32 v64, v64
    v_exp_f32 v65, v65
    v_exp_f32 v66, v66
    v_exp_f32 v67, v67
    v_cvt_pk_bf16_f32 v36, v64, v65
    v_cvt_pk_bf16_f32 v37, v66, v67
    v_mfma_f32_32x32x16_bf16 v[40:55], v[20:23], v[32:35], v[40:55]
    v_exp_f32 v68, v68
    v_exp_f32 v69, v69
    v_exp_f32 v70, v70
    v_exp_f32 v71, v71
    v_cvt_pk_bf16_f32 v38, v68, v69
    v_cvt_pk_bf16_f32 v39, v70, v71
    s_waitcnt lgkmcnt(0)
    v_mfma_f32_32x32x16_bf16 v[56:71], v[12:15], v[4:7], 0
    ds_read_b128 v[12:15], v88 offset:2560
    ds_read_b64 v[16:17], v89 offset:2560
    s_mov_b64 exec, s[48:49]
    ds_read_b128 v[20:23], v90 offset:0
    ds_read_b128 v[28:31], v90 offset:39040
    s_mov_b64 exec, -1
    v_exp_f32 v72, v72
    v_exp_f32 v73, v73
    v_exp_f32 v74, v74
    v_exp_f32 v75, v75
    v_cvt_pk_bf16_f32 v32, v72, v73
    v_cvt_pk_bf16_f32 v33, v74, v75
    v_mfma_f32_32x32x16_bf16 v[40:55], v[24:27], v[36:39], v[40:55]
    v_exp_f32 v76, v76
    v_exp_f32 v77, v77
    v_exp_f32 v78, v78
    v_exp_f32 v79, v79
    v_cvt_pk_bf16_f32 v34, v76, v77
    v_cvt_pk_bf16_f32 v35, v78, v79
    v_mfma_f32_32x32x8_bf16 v[56:71], v[100:101], v[8:9], v[56:71]
    v_exp_f32 v80, v80
    v_exp_f32 v81, v81
    v_exp_f32 v82, v82
    v_exp_f32 v83, v83
    v_cvt_pk_bf16_f32 v36, v80, v81
    v_cvt_pk_bf16_f32 v37, v82, v83
    v_mfma_f32_32x32x16_bf16 v[40:55], v[104:107], v[32:35], v[40:55]
    v_exp_f32 v84, v84
    v_exp_f32 v85, v85
    v_exp_f32 v86, v86
    v_exp_f32 v87, v87
    v_cvt_pk_bf16_f32 v38, v84, v85
    v_cvt_pk_bf16_f32 v39, v86, v87
p2_tail:
    s_setprio 0
    s_waitcnt lgkmcnt(0)
    v_mfma_f32_32x32x16_bf16 v[40:55], v[28:31], v[36:39], v[40:55]
    s_nop 15
    v_mov_b32 v95, 0
    v_fmac_f32 v95, 0, v40
    v_fmac_f32 v95, 0, v41
    v_fmac_f32 v95, 0, v42
    v_fmac_f32 v95, 0, v43
    v_fmac_f32 v95, 0, v44
    v_fmac_f32 v95, 0, v45
    v_fmac_f32 v95, 0, v46
    v_fmac_f32 v95, 0, v47
    v_fmac_f32 v95, 0, v48
    v_fmac_f32 v95, 0, v49
    v_fmac_f32 v95, 0, v50
    v_fmac_f32 v95, 0, v51
    s_mov_b32 s60, 0x2b800000
    s_mov_b32 s61, 0x5f800000
    v_cmp_gt_f32 vcc, s60, v52
    v_add_f32 v95, v95, v52
    s_mov_b64 s[24:25], vcc
    v_cmp_nge_f32 vcc, s61, v95
    s_or_b64 s[24:25], vcc, s[24:25]
    s_cbranch_scc1 p2_slow
p2_fin:
    v_rcp_f32 v95, v52
    s_lshl_b32 s60, s45, 3
    s_add_u32 s60, s60, s3
    s_mul_i32 s60, s60, 1536
    v_mul_f32 v95, v95, v98
    s_mul_i32 s61, s44, 98304
    s_add_u32 s60, s60, s61
    v_lshlrev_b32 v96, 4, v1
    v_mul_f32 v40, v95, v40
    v_mul_f32 v41, v95, v41
    v_mul_f32 v42, v95, v42
    v_mul_f32 v43, v95, v43
    v_mul_f32 v44, v95, v44
    v_mul_f32 v45, v95, v45
    v_mul_f32 v46, v95, v46
    v_mul_f32 v47, v95, v47
    v_mul_f32 v48, v95, v48
    v_mul_f32 v49, v95, v49
    v_mul_f32 v50, v95, v50
    v_mul_f32 v51, v95, v51
    v_cvt_pk_bf16_f32 v32, v40, v41
    v_cvt_pk_bf16_f32 v33, v42, v43
    v_cvt_pk_bf16_f32 v34, v44, v45
    v_cvt_pk_bf16_f32 v35, v46, v47
    v_cvt_pk_bf16_f32 v36, v48, v49
    v_cvt_pk_bf16_f32 v37, v50, v51
    v_mov_b32 v38, 0
    v_mov_b32 v39, 0
    buffer_store_dwordx4 v[32:35], v96, s[40:43], s60 offen sc1
    s_mov_b32 exec_hi, 0
    buffer_store_dwordx4 v[36:39], v96, s[40:43], s60 offen offset:1024 sc1
    s_mov_b32 exec_hi, -1
    s_branch after_p2
p2_slow:
    v_lshlrev_b32 v94, 4, v1
    v_lshlrev_b32 v92, 3, v2
    v_lshrrev_b32 v95, 4, v2
    v_xor_b32 v95, v95, v3
    v_lshl_add_u32 v95, v2, 1, v95
    v_lshlrev_b32 v90, 4, v95
    v_mov_b32 v88, 0xff800000
    s_mov_b32 s46, s50
    s_add_u32 s47, s50, 163840
    v_mov_b32 v40, 0
    v_mov_b32 v41, 0
    v_mov_b32 v42, 0
    v_mov_b32 v43, 0
    v_mov_b32 v44, 0
    v_mov_b32 v45, 0
    v_mov_b32 v46, 0
    v_mov_b32 v47, 0
    v_mov_b32 v48, 0
    v_mov_b32 v49, 0
    v_mov_b32 v50, 0
    v_mov_b32 v51, 0
    v_mov_b32 v52, 0
    v_mov_b32 v53, 0
    v_mov_b32 v54, 0
    v_mov_b32 v55, 0
    v_mov_b32 v20, 0x3f803f80
    v_mov_b32 v21, 0x3f803f80
    v_mov_b32 v22, 0x3f803f80
    v_mov_b32 v23, 0x3f803f80
    v_mov_b32 v24, 0x3f803f80
    v_mov_b32 v25, 0x3f803f80
    v_mov_b32 v26, 0x3f803f80
    v_mov_b32 v27, 0x3f803f80
p2_sloop:
    buffer_load_dwordx4 v[12:15], v94, s[32:35], s46 offen sc1
    buffer_load_dwordx2 v[16:17], v92, s[32:35], s46 offen offset:1024 sc1
    s_mov_b64 exec, s[48:49]
    buffer_load_dwordx4 v[20:23], v90, s[32:35], s46 offen offset:1280 sc1
    buffer_load_dwordx4 v[24:27], v90, s[32:35], s46 offen offset:1920 sc1
    s_mov_b64 exec, -1
    s_waitcnt vmcnt(2)
    v_mfma_f32_32x32x16_bf16 v[56:71], v[12:15], v[4:7], 0
    v_mfma_f32_32x32x8_bf16 v[56:71], v[16:17], v[8:9], v[56:71]
    s_nop 15
    v_max3_f32 v89, v56, v57, v88
    v_max3_f32 v89, v58, v59, v89
    v_max3_f32 v89, v60, v61, v89
    v_max3_f32 v89, v62, v63, v89
    v_max3_f32 v89, v64, v65, v89
    v_max3_f32 v89, v66, v67, v89
    v_max3_f32 v89, v68, v69, v89
    v_max3_f32 v89, v70, v71, v89
    v_mov_b32 v95, v89
    s_nop 1
    v_permlane32_swap_b32 v89, v95
    s_nop 1
    v_max_f32 v89, v89, v95
    v_sub_f32 v91, v88, v89
    v_exp_f32 v91, v91
    v_mov_b32 v88, v89
    v_sub_f32 v56, v56, v89
    v_sub_f32 v57, v57, v89
    v_sub_f32 v58, v58, v89
    v_sub_f32 v59, v59, v89
    v_sub_f32 v60, v60, v89
    v_sub_f32 v61, v61, v89
    v_sub_f32 v62, v62, v89
    v_sub_f32 v63, v63, v89
    v_sub_f32 v64, v64, v89
    v_sub_f32 v65, v65, v89
    v_sub_f32 v66, v66, v89
    v_sub_f32 v67, v67, v89
    v_sub_f32 v68, v68, v89
    v_sub_f32 v69, v69, v89
    v_sub_f32 v70, v70, v89
    v_sub_f32 v71, v71, v89
    v_mul_f32 v40, v91, v40
    v_mul_f32 v41, v91, v41
    v_mul_f32 v42, v91, v42
    v_mul_f32 v43, v91, v43
    v_mul_f32 v44, v91, v44
    v_mul_f32 v45, v91, v45
    v_mul_f32 v46, v91, v46
    v_mul_f32 v47, v91, v47
    v_mul_f32 v48, v91, v48
    v_mul_f32 v49, v91, v49
    v_mul_f32 v50, v91, v50
    v_mul_f32 v51, v91, v51
    v_mul_f32 v52, v91, v52
    v_mul_f32 v53, v91, v53
    v_mul_f32 v54, v91, v54
    v_mul_f32 v55, v91, v55
    v_exp_f32 v56, v56
    v_exp_f32 v57, v57
    v_exp_f32 v58, v58
    v_exp_f32 v59, v59
    v_exp_f32 v60, v60
    v_exp_f32 v61, v61
    v_exp_f32 v62, v62
    v_exp_f32 v63, v63
    v_exp_f32 v64, v64
    v_exp_f32 v65, v65
    v_exp_f32 v66, v66
    v_exp_f32 v67, v67
    v_exp_f32 v68, v68
    v_exp_f32 v69, v69
    v_exp_f32 v70, v70
    v_exp_f32 v71, v71
    s_nop 0
    v_cvt_pk_bf16_f32 v32, v56, v57
    v_cvt_pk_bf16_f32 v33, v58, v59
    v_cvt_pk_bf16_f32 v34, v60, v61
    v_cvt_pk_bf16_f32 v35, v62, v63
    v_cvt_pk_bf16_f32 v36, v64, v65
    v_cvt_pk_bf16_f32 v37, v66, v67
    v_cvt_pk_bf16_f32 v38, v68, v69
    v_cvt_pk_bf16_f32 v39, v70, v71
    s_waitcnt vmcnt(0)
    s_nop 1
    v_mfma_f32_32x32x16_bf16 v[40:55], v[20:23], v[32:35], v[40:55]
    v_mfma_f32_32x32x16_bf16 v[40:55], v[24:27], v[36:39], v[40:55]
    s_add_u32 s46, s46, 2560
    s_nop 15
    s_cmp_lt_u32 s46, s47
    s_cbranch_scc1 p2_sloop
    s_branch p2_fin
after_p2:
    s_cmp_lg_u32 s57, 0
    s_cbranch_scc1 p3early_44_ok
    s_lshr_b32 s60, s53, 2
    s_add_u32 s60, s60, 8
    s_lshl_b32 s60, s60, 8
    s_add_u32 s60, s60, 8126464
    s_mov_b64 s[24:25], exec
    s_mov_b64 exec, 1
    v_mov_b32 v245, s60
    s_mov_b32 s26, 0x40000
pw_45:
    global_load_dword v246, v245, s[22:23] sc1
    s_waitcnt vmcnt(0)
    v_readfirstlane_b32 s27, v246
    s_sub_u32 s26, s26, 1
    s_cmp_eq_u32 s26, 0
    s_cbranch_scc1 pw_45_out
    s_cmp_ge_u32 s27, 18
    s_cbranch_scc1 pw_45_out
    s_sleep 4
    s_branch pw_45
pw_45_out:
    s_mov_b64 exec, s[24:25]
    s_mov_b32 s60, 8132608
    s_mov_b64 s[24:25], exec
    s_mov_b64 exec, 1
    v_mov_b32 v245, s60
    s_mov_b32 s26, 0x40000
pw_46:
    global_load_dword v246, v245, s[22:23] sc1
    s_waitcnt vmcnt(0)
    v_readfirstlane_b32 s27, v246
    s_sub_u32 s26, s26, 1
    s_cmp_eq_u32 s26, 0
    s_cbranch_scc1 pw_46_out
    s_cmp_ge_u32 s27, 16
    s_cbranch_scc1 pw_46_out
    s_sleep 4
    s_branch pw_46
pw_46_out:
    s_mov_b64 exec, s[24:25]
    s_add_u32 s59, s3, 0
    s_mul_i32 s59, s59, 40960
    buffer_load_dwordx4 v[144:147], v239, s[92:95], s59 offen offset:0 sc1
    buffer_load_dwordx4 v[148:151], v239, s[92:95], s59 offen offset:1024 sc1
    buffer_load_dwordx4 v[152:155], v239, s[92:95], s59 offen offset:2048 sc1
    buffer_load_dwordx4 v[156:159], v239, s[92:95], s59 offen offset:3072 sc1
    buffer_load_dwordx4 v[160:163], v240, s[92:95], s59 offen offset:0 sc1
    s_add_u32 s58, s3, 0
    s_mul_i32 s58, s58, 131072
    buffer_load_dwordx4 v[128:131], v236, s[64:67], s58 offen offset:0 sc1
    buffer_load_dwordx4 v[132:135], v236, s[64:67], s58 offen offset:512 sc1
    buffer_load_dwordx4 v[136:139], v236, s[64:67], s58 offen offset:1024 sc1
    buffer_load_dwordx4 v[140:143], v236, s[64:67], s58 offen offset:1536 sc1
    s_add_u32 s59, s3, 8
    s_mul_i32 s59, s59, 40960
    buffer_load_dwordx4 v[180:183], v239, s[92:95], s59 offen offset:0 sc1
    buffer_load_dwordx4 v[184:187], v239, s[92:95], s59 offen offset:1024 sc1
    buffer_load_dwordx4 v[188:191], v239, s[92:95], s59 offen offset:2048 sc1
    buffer_load_dwordx4 v[192:195], v239, s[92:95], s59 offen offset:3072 sc1
    buffer_load_dwordx4 v[196:199], v240, s[92:95], s59 offen offset:0 sc1
    s_add_u32 s58, s3, 8
    s_mul_i32 s58, s58, 131072
    buffer_load_dwordx4 v[164:167], v236, s[64:67], s58 offen offset:0 sc1
    buffer_load_dwordx4 v[168:171], v236, s[64:67], s58 offen offset:512 sc1
    buffer_load_dwordx4 v[172:175], v236, s[64:67], s58 offen offset:1024 sc1
    buffer_load_dwordx4 v[176:179], v236, s[64:67], s58 offen offset:1536 sc1
    s_add_u32 s59, s3, 16
    s_mul_i32 s59, s59, 40960
    buffer_load_dwordx4 v[216:219], v239, s[92:95], s59 offen offset:0 sc1
    buffer_load_dwordx4 v[220:223], v239, s[92:95], s59 offen offset:1024 sc1
    buffer_load_dwordx4 v[224:227], v239, s[92:95], s59 offen offset:2048 sc1
    buffer_load_dwordx4 v[228:231], v239, s[92:95], s59 offen offset:3072 sc1
    buffer_load_dwordx4 v[232:235], v240, s[92:95], s59 offen offset:0 sc1
    s_add_u32 s58, s3, 16
    s_mul_i32 s58, s58, 131072
    buffer_load_dwordx4 v[200:203], v236, s[64:67], s58 offen offset:0 sc1
    buffer_load_dwordx4 v[204:207], v236, s[64:67], s58 offen offset:512 sc1
    buffer_load_dwordx4 v[208:211], v236, s[64:67], s58 offen offset:1024 sc1
    buffer_load_dwordx4 v[212:215], v236, s[64:67], s58 offen offset:1536 sc1
    s_add_u32 s59, s3, 24
    s_mul_i32 s59, s59, 40960
    buffer_load_dwordx4 v[108:111], v239, s[92:95], s59 offen offset:0 sc1
    buffer_load_dwordx4 v[112:115], v239, s[92:95], s59 offen offset:1024 sc1
    buffer_load_dwordx4 v[116:119], v239, s[92:95], s59 offen offset:2048 sc1
    buffer_load_dwordx4 v[120:123], v239, s[92:95], s59 offen offset:3072 sc1
    buffer_load_dwordx4 v[124:127], v240, s[92:95], s59 offen offset:0 sc1
    s_add_u32 s59, s3, 32
    s_mul_i32 s59, s59, 40960
    s_mul_i32 s60, s3, 9216
    s_mov_b32 m0, s60
    s_nop 0
    buffer_load_dwordx4 v239, s[92:95], s59 offen offset:0 sc1 lds
    buffer_load_dwordx4 v239, s[92:95], s59 offen offset:1024 sc1 lds
    buffer_load_dwordx4 v239, s[92:95], s59 offen offset:2048 sc1 lds
    buffer_load_dwordx4 v239, s[92:95], s59 offen offset:3072 sc1 lds
    s_add_u32 m0, m0, 4096
    s_nop 0
    buffer_load_dwordx4 v240, s[92:95], s59 offen sc1 lds
    s_add_u32 s58, s3, 32
    s_mul_i32 s58, s58, 131072
    s_add_u32 m0, m0, 1024
    s_nop 0
    buffer_load_dwordx4 v236, s[64:67], s58 offen sc1 lds
    s_add_u32 m0, m0, 1024
    s_nop 0
    buffer_load_dwordx4 v252, s[64:67], s58 offen sc1 lds
    s_add_u32 m0, m0, 1024
    s_nop 0
    buffer_load_dwordx4 v253, s[64:67], s58 offen sc1 lds
    s_add_u32 m0, m0, 1024
    s_nop 0
    buffer_load_dwordx4 v254, s[64:67], s58 offen sc1 lds
    s_waitcnt vmcnt(0)
p3early_44_ok:
    s_add_u32 s32, s22, 7864320
    s_addc_u32 s33, s23, 0
    s_mov_b32 s34, 16384
    s_mov_b32 s35, 0x20000
    s_mov_b32 s28, s18
    s_mov_b32 s29, s19
    s_mov_b32 s30, 2621440
    s_mov_b32 s31, 0x20000
    v_and_b32 v2, 15, v1
    v_lshrrev_b32 v3, 4, v1
    s_lshl_b32 s60, s53, 6
    v_add_u32 v245, s60, v2
    v_lshlrev_b32 v245, 3, v245
    buffer_load_dword v241, v245, s[32:35], 0 offen offset:4 sc1
    buffer_load_dword v242, v245, s[32:35], 0 offen offset:132 sc1
    buffer_load_dword v243, v245, s[32:35], 0 offen offset:260 sc1
    buffer_load_dword v244, v245, s[32:35], 0 offen offset:388 sc1
    s_lshl_b32 s60, s3, 10
    v_lshlrev_b32 v253, 4, v1
    v_add_u32 v253, s60, v253
    v_add_u32 v254, 65536, v253
    v_add_u32 v255, 131072, v253
    s_waitcnt vmcnt(22)
    v_mfma_f32_16x16x32_bf16 v[4:7], v[144:147], v[128:131], 0
    v_mfma_f32_16x16x32_bf16 v[8:11], v[144:147], v[132:135], 0
    v_mfma_f32_16x16x32_bf16 v[12:15], v[144:147], v[136:139], 0
    v_mfma_f32_16x16x32_bf16 v[16:19], v[144:147], v[140:143], 0
    v_mfma_f32_16x16x32_bf16 v[20:23], v[148:151], v[128:131], 0
    v_mfma_f32_16x16x32_bf16 v[24:27], v[148:151], v[132:135], 0
    v_mfma_f32_16x16x32_bf16 v[28:31], v[148:151], v[136:139], 0
    v_mfma_f32_16x16x32_bf16 v[32:35], v[148:151], v[140:143], 0
    v_mfma_f32_16x16x32_bf16 v[36:39], v[152:155], v[128:131], 0
    v_mfma_f32_16x16x32_bf16 v[40:43], v[152:155], v[132:135], 0
    v_mfma_f32_16x16x32_bf16 v[44:47], v[152:155], v[136:139], 0
    v_mfma_f32_16x16x32_bf16 v[48:51], v[152:155], v[140:143], 0
    v_mfma_f32_16x16x32_bf16 v[52:55], v[156:159], v[128:131], 0
    v_mfma_f32_16x16x32_bf16 v[56:59], v[156:159], v[132:135], 0
    v_mfma_f32_16x16x32_bf16 v[60:63], v[156:159], v[136:139], 0
    v_mfma_f32_16x16x32_bf16 v[64:67], v[156:159], v[140:143], 0
    v_mfma_f32_16x16x32_bf16 v[68:71], v[160:163], v[128:131], 0
    v_mfma_f32_16x16x32_bf16 v[72:75], v[160:163], v[132:135], 0
    v_mfma_f32_16x16x32_bf16 v[76:79], v[160:163], v[136:139], 0
    v_mfma_f32_16x16x32_bf16 v[80:83], v[160:163], v[140:143], 0
    s_add_u32 s58, s3, 24
    s_mul_i32 s58, s58, 131072
    buffer_load_dwordx4 v[128:131], v236, s[64:67], s58 offen offset:0 sc1
    buffer_load_dwordx4 v[132:135], v236, s[64:67], s58 offen offset:512 sc1
    buffer_load_dwordx4 v[136:139], v236, s[64:67], s58 offen offset:1024 sc1
    buffer_load_dwordx4 v[140:143], v236, s[64:67], s58 offen offset:1536 sc1
    s_add_u32 s59, s3, 40
    s_mul_i32 s59, s59, 40960
    buffer_load_dwordx4 v[84:87], v239, s[92:95], s59 offen offset:0 sc1
    buffer_load_dwordx4 v[88:91], v239, s[92:95], s59 offen offset:1024 sc1
    buffer_load_dwordx4 v[92:95], v239, s[92:95], s59 offen offset:2048 sc1
    buffer_load_dwordx4 v[96:99], v239, s[92:95], s59 offen offset:3072 sc1
    buffer_load_dwordx4 v[100:103], v240, s[92:95], s59 offen offset:0 sc1
    s_waitcnt vmcnt(22)
    v_mfma_f32_16x16x32_bf16 v[4:7], v[180:183], v[164:167], v[4:7]
    v_mfma_f32_16x16x32_bf16 v[8:11], v[180:183], v[168:171], v[8:11]
    v_mfma_f32_16x16x32_bf16 v[12:15], v[180:183], v[172:175], v[12:15]
    v_mfma_f32_16x16x32_bf16 v[16:19], v[180:183], v[176:179], v[16:19]
    v_mfma_f32_16x16x32_bf16 v[20:23], v[184:187], v[164:167], v[20:23]
    v_mfma_f32_16x16x32_bf16 v[24:27], v[184:187], v[168:171], v[24:27]
    v_mfma_f32_16x16x32_bf16 v[28:31], v[184:187], v[172:175], v[28:31]
    v_mfma_f32_16x16x32_bf16 v[32:35], v[184:187], v[176:179], v[32:35]
    v_mfma_f32_16x16x32_bf16 v[36:39], v[188:191], v[164:167], v[36:39]
    v_mfma_f32_16x16x32_bf16 v[40:43], v[188:191], v[168:171], v[40:43]
    v_mfma_f32_16x16x32_bf16 v[44:47], v[188:191], v[172:175], v[44:47]
    v_mfma_f32_16x16x32_bf16 v[48:51], v[188:191], v[176:179], v[48:51]
    v_mfma_f32_16x16x32_bf16 v[52:55], v[192:195], v[164:167], v[52:55]
    v_mfma_f32_16x16x32_bf16 v[56:59], v[192:195], v[168:171], v[56:59]
    v_mfma_f32_16x16x32_bf16 v[60:63], v[192:195], v[172:175], v[60:63]
    v_mfma_f32_16x16x32_bf16 v[64:67], v[192:195], v[176:179], v[64:67]
    v_mfma_f32_16x16x32_bf16 v[68:71], v[196:199], v[164:167], v[68:71]
    v_mfma_f32_16x16x32_bf16 v[72:75], v[196:199], v[168:171], v[72:75]
    v_mfma_f32_16x16x32_bf16 v[76:79], v[196:199], v[172:175], v[76:79]
    v_mfma_f32_16x16x32_bf16 v[80:83], v[196:199], v[176:179], v[80:83]
    s_add_u32 s59, s3, 48
    s_mul_i32 s59, s59, 40960
    buffer_load_dwordx4 v[144:147], v239, s[92:95], s59 offen offset:0 sc1
    buffer_load_dwordx4 v[148:151], v239, s[92:95], s59 offen offset:1024 sc1
    buffer_load_dwordx4 v[152:155], v239, s[92:95], s59 offen offset:2048 sc1
    buffer_load_dwordx4 v[156:159], v239, s[92:95], s59 offen offset:3072 sc1
    buffer_load_dwordx4 v[160:163], v240, s[92:95], s59 offen offset:0 sc1
    s_waitcnt vmcnt(18)
    v_mfma_f32_16x16x32_bf16 v[4:7], v[216:219], v[200:203], v[4:7]
    v_mfma_f32_16x16x32_bf16 v[8:11], v[216:219], v[204:207], v[8:11]
    v_mfma_f32_16x16x32_bf16 v[12:15], v[216:219], v[208:211], v[12:15]
    v_mfma_f32_16x16x32_bf16 v[16:19], v[216:219], v[212:215], v[16:19]
    v_mfma_f32_16x16x32_bf16 v[20:23], v[220:223], v[200:203], v[20:23]
    v_mfma_f32_16x16x32_bf16 v[24:27], v[220:223], v[204:207], v[24:27]
    v_mfma_f32_16x16x32_bf16 v[28:31], v[220:223], v[208:211], v[28:31]
    v_mfma_f32_16x16x32_bf16 v[32:35], v[220:223], v[212:215], v[32:35]
    v_mfma_f32_16x16x32_bf16 v[36:39], v[224:227], v[200:203], v[36:39]
    v_mfma_f32_16x16x32_bf16 v[40:43], v[224:227], v[204:207], v[40:43]
    v_mfma_f32_16x16x32_bf16 v[44:47], v[224:227], v[208:211], v[44:47]
    v_mfma_f32_16x16x32_bf16 v[48:51], v[224:227], v[212:215], v[48:51]
    v_mfma_f32_16x16x32_bf16 v[52:55], v[228:231], v[200:203], v[52:55]
    v_mfma_f32_16x16x32_bf16 v[56:59], v[228:231], v[204:207], v[56:59]
    v_mfma_f32_16x16x32_bf16 v[60:63], v[228:231], v[208:211], v[60:63]
    v_mfma_f32_16x16x32_bf16 v[64:67], v[228:231], v[212:215], v[64:67]
    v_mfma_f32_16x16x32_bf16 v[68:71], v[232:235], v[200:203], v[68:71]
    v_mfma_f32_16x16x32_bf16 v[72:75], v[232:235], v[204:207], v[72:75]
    v_mfma_f32_16x16x32_bf16 v[76:79], v[232:235], v[208:211], v[76:79]
    v_mfma_f32_16x16x32_bf16 v[80:83], v[232:235], v[212:215], v[80:83]
    s_waitcnt vmcnt(0)
    s_barrier
    s_add_u32 s60, s45, 16
    v_mov_b32 v251, 1
    s_cmp_lg_u32 s3, 0
    s_cbranch_scc1 sig_47
    s_mov_b32 s26, 0x40000
sig_47_p:
    v_readfirstlane_b32 s27, v251
    s_sub_u32 s26, s26, 1
    s_cmp_eq_u32 s26, 0
    s_cbranch_scc1 sig_47_go
    s_cmp_lg_u32 s27, 0
    s_cbranch_scc1 sig_47_go
    v_mov_b32 v251, 0
    global_load_dword v251, v251, s[20:21] sc1
    s_waitcnt vmcnt(0)
    s_branch sig_47_p
sig_47_go:
    s_mov_b64 s[24:25], exec
    s_mov_b64 exec, 1
    v_add_u32 v249, s60, v1
    v_lshlrev_b32 v249, 8, v249
    v_add_u32 v249, 8126464, v249
    v_mov_b32 v250, 1
    global_atomic_add v249, v250, s[22:23]
    s_mov_b64 exec, s[24:25]
sig_47:
    s_mul_i32 s60, s3, 9216
    v_lshlrev_b32 v252, 4, v1
    v_add_u32 v252, s60, v252
    ds_read_b128 v[180:183], v252 offset:0
    ds_read_b128 v[184:187], v252 offset:1024
    ds_read_b128 v[188:191], v252 offset:2048
    ds_read_b128 v[192:195], v252 offset:3072
    ds_read_b128 v[196:199], v252 offset:4096
    ds_read_b128 v[164:167], v252 offset:5120
    ds_read_b128 v[168:171], v252 offset:6144
    ds_read_b128 v[172:175], v252 offset:7168
    ds_read_b128 v[176:179], v252 offset:8192
    s_add_u32 s58, s3, 40
    s_mul_i32 s58, s58, 131072
    buffer_load_dwordx4 v[200:203], v236, s[64:67], s58 offen offset:0 sc1
    buffer_load_dwordx4 v[204:207], v236, s[64:67], s58 offen offset:512 sc1
    buffer_load_dwordx4 v[208:211], v236, s[64:67], s58 offen offset:1024 sc1
    buffer_load_dwordx4 v[212:215], v236, s[64:67], s58 offen offset:1536 sc1
    s_waitcnt vmcnt(14)
    v_mfma_f32_16x16x32_bf16 v[4:7], v[108:111], v[128:131], v[4:7]
    v_mfma_f32_16x16x32_bf16 v[8:11], v[108:111], v[132:135], v[8:11]
    v_mfma_f32_16x16x32_bf16 v[12:15], v[108:111], v[136:139], v[12:15]
    v_mfma_f32_16x16x32_bf16 v[16:19], v[108:111], v[140:143], v[16:19]
    v_mfma_f32_16x16x32_bf16 v[20:23], v[112:115], v[128:131], v[20:23]
    v_mfma_f32_16x16x32_bf16 v[24:27], v[112:115], v[132:135], v[24:27]
    v_mfma_f32_16x16x32_bf16 v[28:31], v[112:115], v[136:139], v[28:31]
    v_mfma_f32_16x16x32_bf16 v[32:35], v[112:115], v[140:143], v[32:35]
    v_mfma_f32_16x16x32_bf16 v[36:39], v[116:119], v[128:131], v[36:39]
    v_mfma_f32_16x16x32_bf16 v[40:43], v[116:119], v[132:135], v[40:43]
    v_mfma_f32_16x16x32_bf16 v[44:47], v[116:119], v[136:139], v[44:47]
    v_mfma_f32_16x16x32_bf16 v[48:51], v[116:119], v[140:143], v[48:51]
    v_mfma_f32_16x16x32_bf16 v[52:55], v[120:123], v[128:131], v[52:55]
    v_mfma_f32_16x16x32_bf16 v[56:59], v[120:123], v[132:135], v[56:59]
    v_mfma_f32_16x16x32_bf16 v[60:63], v[120:123], v[136:139], v[60:63]
    v_mfma_f32_16x16x32_bf16 v[64:67], v[120:123], v[140:143], v[64:67]
    v_mfma_f32_16x16x32_bf16 v[68:71], v[124:127], v[128:131], v[68:71]
    v_mfma_f32_16x16x32_bf16 v[72:75], v[124:127], v[132:135], v[72:75]
    v_mfma_f32_16x16x32_bf16 v[76:79], v[124:127], v[136:139], v[76:79]
    v_mfma_f32_16x16x32_bf16 v[80:83], v[124:127], v[140:143], v[80:83]
    s_add_u32 s58, s3, 48
    s_mul_i32 s58, s58, 131072
    buffer_load_dwordx4 v[128:131], v236, s[64:67], s58 offen offset:0 sc1
    buffer_load_dwordx4 v[132:135], v236, s[64:67], s58 offen offset:512 sc1
    buffer_load_dwordx4 v[136:139], v236, s[64:67], s58 offen offset:1024 sc1
    buffer_load_dwordx4 v[140:143], v236, s[64:67], s58 offen offset:1536 sc1
    s_waitcnt lgkmcnt(0)
    v_mfma_f32_16x16x32_bf16 v[4:7], v[180:183], v[164:167], v[4:7]
    v_mfma_f32_16x16x32_bf16 v[8:11], v[180:183], v[168:171], v[8:11]
    v_mfma_f32_16x16x32_bf16 v[12:15], v[180:183], v[172:175], v[12:15]
    v_mfma_f32_16x16x32_bf16 v[16:19], v[180:183], v[176:179], v[16:19]
    v_mfma_f32_16x16x32_bf16 v[20:23], v[184:187], v[164:167], v[20:23]
    v_mfma_f32_16x16x32_bf16 v[24:27], v[184:187], v[168:171], v[24:27]
    v_mfma_f32_16x16x32_bf16 v[28:31], v[184:187], v[172:175], v[28:31]
    v_mfma_f32_16x16x32_bf16 v[32:35], v[184:187], v[176:179], v[32:35]
    v_mfma_f32_16x16x32_bf16 v[36:39], v[188:191], v[164:167], v[36:39]
    v_mfma_f32_16x16x32_bf16 v[40:43], v[188:191], v[168:171], v[40:43]
    v_mfma_f32_16x16x32_bf16 v[44:47], v[188:191], v[172:175], v[44:47]
    v_mfma_f32_16x16x32_bf16 v[48:51], v[188:191], v[176:179], v[48:51]
    v_mfma_f32_16x16x32_bf16 v[52:55], v[192:195], v[164:167], v[52:55]
    v_mfma_f32_16x16x32_bf16 v[56:59], v[192:195], v[168:171], v[56:59]
    v_mfma_f32_16x16x32_bf16 v[60:63], v[192:195], v[172:175], v[60:63]
    v_mfma_f32_16x16x32_bf16 v[64:67], v[192:195], v[176:179], v[64:67]
    v_mfma_f32_16x16x32_bf16 v[68:71], v[196:199], v[164:167], v[68:71]
    v_mfma_f32_16x16x32_bf16 v[72:75], v[196:199], v[168:171], v[72:75]
    v_mfma_f32_16x16x32_bf16 v[76:79], v[196:199], v[172:175], v[76:79]
    v_mfma_f32_16x16x32_bf16 v[80:83], v[196:199], v[176:179], v[80:83]
    s_add_u32 s59, s3, 0
    s_mul_i32 s59, s59, 40960
    buffer_load_dwordx4 v[180:183], v239, s[96:99], s59 offen offset:0 sc1
    buffer_load_dwordx4 v[184:187], v239, s[96:99], s59 offen offset:1024 sc1
    buffer_load_dwordx4 v[188:191], v239, s[96:99], s59 offen offset:2048 sc1
    buffer_load_dwordx4 v[192:195], v239, s[96:99], s59 offen offset:3072 sc1
    buffer_load_dwordx4 v[196:199], v240, s[96:99], s59 offen offset:0 sc1
    s_lshr_b32 s60, s53, 2
    s_add_u32 s60, s60, 16
    s_lshl_b32 s60, s60, 8
    s_add_u32 s63, s60, 8126464
    v_mov_b32 v245, s63
    global_load_dword v246, v245, s[22:23] sc1
    s_waitcnt vmcnt(10)
    v_mfma_f32_16x16x32_bf16 v[4:7], v[84:87], v[200:203], v[4:7]
    v_mfma_f32_16x16x32_bf16 v[8:11], v[84:87], v[204:207], v[8:11]
    v_mfma_f32_16x16x32_bf16 v[12:15], v[84:87], v[208:211], v[12:15]
    v_mfma_f32_16x16x32_bf16 v[16:19], v[84:87], v[212:215], v[16:19]
    v_mfma_f32_16x16x32_bf16 v[20:23], v[88:91], v[200:203], v[20:23]
    v_mfma_f32_16x16x32_bf16 v[24:27], v[88:91], v[204:207], v[24:27]
    v_mfma_f32_16x16x32_bf16 v[28:31], v[88:91], v[208:211], v[28:31]
    v_mfma_f32_16x16x32_bf16 v[32:35], v[88:91], v[212:215], v[32:35]
    v_mfma_f32_16x16x32_bf16 v[36:39], v[92:95], v[200:203], v[36:39]
    v_mfma_f32_16x16x32_bf16 v[40:43], v[92:95], v[204:207], v[40:43]
    v_mfma_f32_16x16x32_bf16 v[44:47], v[92:95], v[208:211], v[44:47]
    v_mfma_f32_16x16x32_bf16 v[48:51], v[92:95], v[212:215], v[48:51]
    v_mfma_f32_16x16x32_bf16 v[52:55], v[96:99], v[200:203], v[52:55]
    v_mfma_f32_16x16x32_bf16 v[56:59], v[96:99], v[204:207], v[56:59]
    v_mfma_f32_16x16x32_bf16 v[60:63], v[96:99], v[208:211], v[60:63]
    v_mfma_f32_16x16x32_bf16 v[64:67], v[96:99], v[212:215], v[64:67]
    v_mfma_f32_16x16x32_bf16 v[68:71], v[100:103], v[200:203], v[68:71]
    v_mfma_f32_16x16x32_bf16 v[72:75], v[100:103], v[204:207], v[72:75]
    v_mfma_f32_16x16x32_bf16 v[76:79], v[100:103], v[208:211], v[76:79]
    v_mfma_f32_16x16x32_bf16 v[80:83], v[100:103], v[212:215], v[80:83]
    s_add_u32 s59, s3, 8
    s_mul_i32 s59, s59, 40960
    buffer_load_dwordx4 v[216:219], v239, s[96:99], s59 offen offset:0 sc1
    buffer_load_dwordx4 v[220:223], v239, s[96:99], s59 offen offset:1024 sc1
    buffer_load_dwordx4 v[224:227], v239, s[96:99], s59 offen offset:2048 sc1
    buffer_load_dwordx4 v[228:231], v239, s[96:99], s59 offen offset:3072 sc1
    buffer_load_dwordx4 v[232:235], v240, s[96:99], s59 offen offset:0 sc1
    s_waitcnt vmcnt(11)
    v_mfma_f32_16x16x32_bf16 v[4:7], v[144:147], v[128:131], v[4:7]
    v_mfma_f32_16x16x32_bf16 v[8:11], v[144:147], v[132:135], v[8:11]
    v_mfma_f32_16x16x32_bf16 v[12:15], v[144:147], v[136:139], v[12:15]
    v_mfma_f32_16x16x32_bf16 v[16:19], v[144:147], v[140:143], v[16:19]
    v_mfma_f32_16x16x32_bf16 v[20:23], v[148:151], v[128:131], v[20:23]
    v_mfma_f32_16x16x32_bf16 v[24:27], v[148:151], v[132:135], v[24:27]
    v_mfma_f32_16x16x32_bf16 v[28:31], v[148:151], v[136:139], v[28:31]
    v_mfma_f32_16x16x32_bf16 v[32:35], v[148:151], v[140:143], v[32:35]
    v_mfma_f32_16x16x32_bf16 v[36:39], v[152:155], v[128:131], v[36:39]
    v_mfma_f32_16x16x32_bf16 v[40:43], v[152:155], v[132:135], v[40:43]
    v_mfma_f32_16x16x32_bf16 v[44:47], v[152:155], v[136:139], v[44:47]
    v_mfma_f32_16x16x32_bf16 v[48:51], v[152:155], v[140:143], v[48:51]
    v_mfma_f32_16x16x32_bf16 v[52:55], v[156:159], v[128:131], v[52:55]
    v_mfma_f32_16x16x32_bf16 v[56:59], v[156:159], v[132:135], v[56:59]
    v_mfma_f32_16x16x32_bf16 v[60:63], v[156:159], v[136:139], v[60:63]
    v_mfma_f32_16x16x32_bf16 v[64:67], v[156:159], v[140:143], v[64:67]
    v_mfma_f32_16x16x32_bf16 v[68:71], v[160:163], v[128:131], v[68:71]
    v_mfma_f32_16x16x32_bf16 v[72:75], v[160:163], v[132:135], v[72:75]
    v_mfma_f32_16x16x32_bf16 v[76:79], v[160:163], v[136:139], v[76:79]
    v_mfma_f32_16x16x32_bf16 v[80:83], v[160:163], v[140:143], v[80:83]
    s_add_u32 s59, s3, 16
    s_mul_i32 s59, s59, 40960
    buffer_load_dwordx4 v[144:147], v239, s[96:99], s59 offen offset:0 sc1
    buffer_load_dwordx4 v[148:151], v239, s[96:99], s59 offen offset:1024 sc1
    buffer_load_dwordx4 v[152:155], v239, s[96:99], s59 offen offset:2048 sc1
    buffer_load_dwordx4 v[156:159], v239, s[96:99], s59 offen offset:3072 sc1
    buffer_load_dwordx4 v[160:163], v240, s[96:99], s59 offen offset:0 sc1
    s_nop 7
    v_mul_f32 v4, v241, v4
    v_mul_f32 v5, v241, v5
    v_mul_f32 v6, v241, v6
    v_mul_f32 v7, v241, v7
    v_mul_f32 v8, v242, v8
    v_mul_f32 v9, v242, v9
    v_mul_f32 v10, v242, v10
    v_mul_f32 v11, v242, v11
    v_mul_f32 v12, v243, v12
    v_mul_f32 v13, v243, v13
    v_mul_f32 v14, v243, v14
    v_mul_f32 v15, v243, v15
    v_mul_f32 v16, v244, v16
    v_mul_f32 v17, v244, v17
    v_mul_f32 v18, v244, v18
    v_mul_f32 v19, v244, v19
    v_mul_f32 v20, v241, v20
    v_mul_f32 v21, v241, v21
    v_mul_f32 v22, v241, v22
    v_mul_f32 v23, v241, v23
    v_mul_f32 v24, v242, v24
    v_mul_f32 v25, v242, v25
    v_mul_f32 v26, v242, v26
    v_mul_f32 v27, v242, v27
    v_mul_f32 v28, v243, v28
    v_mul_f32 v29, v243, v29
    v_mul_f32 v30, v243, v30
    v_mul_f32 v31, v243, v31
    v_mul_f32 v32, v244, v32
    v_mul_f32 v33, v244, v33
    v_mul_f32 v34, v244, v34
    v_mul_f32 v35, v244, v35
    v_mul_f32 v36, v241, v36
    v_mul_f32 v37, v241, v37
    v_mul_f32 v38, v241, v38
    v_mul_f32 v39, v241, v39
    v_mul_f32 v40, v242, v40
    v_mul_f32 v41, v242, v41
    v_mul_f32 v42, v242, v42
    v_mul_f32 v43, v242, v43
    v_mul_f32 v44, v243, v44
    v_mul_f32 v45, v243, v45
    v_mul_f32 v46, v243, v46
    v_mul_f32 v47, v243, v47
    v_mul_f32 v48, v244, v48
    v_mul_f32 v49, v244, v49
    v_mul_f32 v50, v244, v50
    v_mul_f32 v51, v244, v51
    v_mul_f32 v52, v241, v52
    v_mul_f32 v53, v241, v53
    v_mul_f32 v54, v241, v54
    v_mul_f32 v55, v241, v55
    v_mul_f32 v56, v242, v56
    v_mul_f32 v57, v242, v57
    v_mul_f32 v58, v242, v58
    v_mul_f32 v59, v242, v59
    v_mul_f32 v60, v243, v60
    v_mul_f32 v61, v243, v61
    v_mul_f32 v62, v243, v62
    v_mul_f32 v63, v243, v63
    v_mul_f32 v64, v244, v64
    v_mul_f32 v65, v244, v65
    v_mul_f32 v66, v244, v66
    v_mul_f32 v67, v244, v67
    v_mul_f32 v68, v241, v68
    v_mul_f32 v69, v241, v69
    v_mul_f32 v70, v241, v70
    v_mul_f32 v71, v241, v71
    v_mul_f32 v72, v242, v72
    v_mul_f32 v73, v242, v73
    v_mul_f32 v74, v242, v74
    v_mul_f32 v75, v242, v75
    v_mul_f32 v76, v243, v76
    v_mul_f32 v77, v243, v77
    v_mul_f32 v78, v243, v78
    v_mul_f32 v79, v243, v79
    v_mul_f32 v80, v244, v80
    v_mul_f32 v81, v244, v81
    v_mul_f32 v82, v244, v82
    v_mul_f32 v83, v244, v83
    s_waitcnt vmcnt(10)
    v_readfirstlane_b32 s60, v246
    s_cmp_ge_u32 s60, 32
    s_cbranch_scc1 p3o_48
    s_mov_b64 s[24:25], exec
    s_mov_b64 exec, 1
    v_mov_b32 v245, s63
    s_mov_b32 s26, 0x40000
pw_49:
    global_load_dword v246, v245, s[22:23] sc1
    s_waitcnt vmcnt(0)
    v_readfirstlane_b32 s27, v246
    s_sub_u32 s26, s26, 1
    s_cmp_eq_u32 s26, 0
    s_cbranch_scc1 pw_49_out
    s_cmp_ge_u32 s27, 32
    s_cbranch_scc1 pw_49_out
    s_sleep 4
    s_branch pw_49
pw_49_out:
    s_mov_b64 exec, s[24:25]
p3o_48:
    s_add_u32 s58, s3, 0
    s_mul_i32 s58, s58, 196608
    buffer_load_dwordx4 v[164:167], v237, s[68:71], s58 offen offset:0 sc1
    buffer_load_dwordx4 v[168:171], v237, s[68:71], s58 offen offset:256 sc1
    buffer_load_dwordx4 v[172:175], v237, s[68:71], s58 offen offset:1536 sc1
    buffer_load_dwordx4 v[176:179], v237, s[68:71], s58 offen offset:1792 sc1
    s_add_u32 s58, s3, 8
    s_mul_i32 s58, s58, 196608
    buffer_load_dwordx4 v[200:203], v237, s[68:71], s58 offen offset:0 sc1
    buffer_load_dwordx4 v[204:207], v237, s[68:71], s58 offen offset:256 sc1
    buffer_load_dwordx4 v[208:211], v237, s[68:71], s58 offen offset:1536 sc1
    buffer_load_dwordx4 v[212:215], v237, s[68:71], s58 offen offset:1792 sc1
    s_mul_i32 s58, s3, 393216
    buffer_load_dwordx4 v[128:131], v238, s[68:71], s58 offen offset:0 sc1
    buffer_load_dwordx4 v[132:135], v238, s[68:71], s58 offen offset:256 sc1
    buffer_load_dwordx4 v[136:139], v238, s[68:71], s58 offen offset:1536 sc1
    buffer_load_dwordx4 v[140:143], v238, s[68:71], s58 offen offset:1792 sc1
    s_waitcnt vmcnt(8)
    s_lshl_b32 s60, s3, 13
    v_lshlrev_b32 v104, 4, v1
    v_add_u32 v104, s60, v104
    v_add_u32 v105, 65536, v104
    v_add_u32 v106, 131072, v104
    s_and_b32 s61, s3, 3
    s_lshl_b32 s61, s61, 4
    s_lshl_b32 s62, s53, 6
    s_add_u32 s61, s61, s62
    v_add_u32 v107, s61, v2
    v_mul_u32_u24 v107, 1280, v107
    s_mul_i32 s61, s56, 160
    s_lshr_b32 s62, s3, 2
    s_lshl_b32 s62, s62, 5
    s_add_u32 s61, s61, s62
    v_lshlrev_b32 v108, 3, v3
    v_add3_u32 v107, v107, v108, s61
    v_mfma_f32_16x16x32_bf16 v[4:7], v[180:183], v[164:167], v[4:7]
    v_mfma_f32_16x16x32_bf16 v[8:11], v[180:183], v[168:171], v[8:11]
    v_mfma_f32_16x16x32_bf16 v[12:15], v[180:183], v[172:175], v[12:15]
    v_mfma_f32_16x16x32_bf16 v[16:19], v[180:183], v[176:179], v[16:19]
    v_mfma_f32_16x16x32_bf16 v[20:23], v[184:187], v[164:167], v[20:23]
    v_mfma_f32_16x16x32_bf16 v[24:27], v[184:187], v[168:171], v[24:27]
    v_mfma_f32_16x16x32_bf16 v[28:31], v[184:187], v[172:175], v[28:31]
    v_mfma_f32_16x16x32_bf16 v[32:35], v[184:187], v[176:179], v[32:35]
    v_mfma_f32_16x16x32_bf16 v[36:39], v[188:191], v[164:167], v[36:39]
    v_mfma_f32_16x16x32_bf16 v[40:43], v[188:191], v[168:171], v[40:43]
    v_mfma_f32_16x16x32_bf16 v[44:47], v[188:191], v[172:175], v[44:47]
    v_mfma_f32_16x16x32_bf16 v[48:51], v[188:191], v[176:179], v[48:51]
    v_mfma_f32_16x16x32_bf16 v[52:55], v[192:195], v[164:167], v[52:55]
    v_mfma_f32_16x16x32_bf16 v[56:59], v[192:195], v[168:171], v[56:59]
    v_mfma_f32_16x16x32_bf16 v[60:63], v[192:195], v[172:175], v[60:63]
    v_mfma_f32_16x16x32_bf16 v[64:67], v[192:195], v[176:179], v[64:67]
    v_mfma_f32_16x16x32_bf16 v[68:71], v[196:199], v[164:167], v[68:71]
    v_mfma_f32_16x16x32_bf16 v[72:75], v[196:199], v[168:171], v[72:75]
    v_mfma_f32_16x16x32_bf16 v[76:79], v[196:199], v[172:175], v[76:79]
    v_mfma_f32_16x16x32_bf16 v[80:83], v[196:199], v[176:179], v[80:83]
    s_waitcnt vmcnt(4)
    v_mfma_f32_16x16x32_bf16 v[4:7], v[216:219], v[200:203], v[4:7]
    v_mfma_f32_16x16x32_bf16 v[8:11], v[216:219], v[204:207], v[8:11]
    v_mfma_f32_16x16x32_bf16 v[12:15], v[216:219], v[208:211], v[12:15]
    v_mfma_f32_16x16x32_bf16 v[16:19], v[216:219], v[212:215], v[16:19]
    v_mfma_f32_16x16x32_bf16 v[20:23], v[220:223], v[200:203], v[20:23]
    v_mfma_f32_16x16x32_bf16 v[24:27], v[220:223], v[204:207], v[24:27]
    v_mfma_f32_16x16x32_bf16 v[28:31], v[220:223], v[208:211], v[28:31]
    v_mfma_f32_16x16x32_bf16 v[32:35], v[220:223], v[212:215], v[32:35]
    v_mfma_f32_16x16x32_bf16 v[36:39], v[224:227], v[200:203], v[36:39]
    v_mfma_f32_16x16x32_bf16 v[40:43], v[224:227], v[204:207], v[40:43]
    v_mfma_f32_16x16x32_bf16 v[44:47], v[224:227], v[208:211], v[44:47]
    v_mfma_f32_16x16x32_bf16 v[48:51], v[224:227], v[212:215], v[48:51]
    v_mfma_f32_16x16x32_bf16 v[52:55], v[228:231], v[200:203], v[52:55]
    v_mfma_f32_16x16x32_bf16 v[56:59], v[228:231], v[204:207], v[56:59]
    v_mfma_f32_16x16x32_bf16 v[60:63], v[228:231], v[208:211], v[60:63]
    v_mfma_f32_16x16x32_bf16 v[64:67], v[228:231], v[212:215], v[64:67]
    v_mfma_f32_16x16x32_bf16 v[68:71], v[232:235], v[200:203], v[68:71]
    v_mfma_f32_16x16x32_bf16 v[72:75], v[232:235], v[204:207], v[72:75]
    v_mfma_f32_16x16x32_bf16 v[76:79], v[232:235], v[208:211], v[76:79]
    v_mfma_f32_16x16x32_bf16 v[80:83], v[232:235], v[212:215], v[80:83]
    s_waitcnt vmcnt(0)
    v_mfma_f32_16x16x32_bf16 v[4:7], v[144:147], v[128:131], v[4:7]
    v_mfma_f32_16x16x32_bf16 v[8:11], v[144:147], v[132:135], v[8:11]
    v_mfma_f32_16x16x32_bf16 v[12:15], v[144:147], v[136:139], v[12:15]
    v_mfma_f32_16x16x32_bf16 v[16:19], v[144:147], v[140:143], v[16:19]
    v_mfma_f32_16x16x32_bf16 v[20:23], v[148:151], v[128:131], v[20:23]
    v_mfma_f32_16x16x32_bf16 v[24:27], v[148:151], v[132:135], v[24:27]
    v_mfma_f32_16x16x32_bf16 v[28:31], v[148:151], v[136:139], v[28:31]
    v_mfma_f32_16x16x32_bf16 v[32:35], v[148:151], v[140:143], v[32:35]
    v_mfma_f32_16x16x32_bf16 v[36:39], v[152:155], v[128:131], v[36:39]
    ds_write_b128 v253, v[4:7] offset:0
    v_mfma_f32_16x16x32_bf16 v[40:43], v[152:155], v[132:135], v[40:43]
    ds_write_b128 v253, v[8:11] offset:8192
    v_mfma_f32_16x16x32_bf16 v[44:47], v[152:155], v[136:139], v[44:47]
    ds_write_b128 v253, v[12:15] offset:16384
    v_mfma_f32_16x16x32_bf16 v[48:51], v[152:155], v[140:143], v[48:51]
    ds_write_b128 v253, v[16:19] offset:24576
    v_mfma_f32_16x16x32_bf16 v[52:55], v[156:159], v[128:131], v[52:55]
    ds_write_b128 v253, v[20:23] offset:32768
    v_mfma_f32_16x16x32_bf16 v[56:59], v[156:159], v[132:135], v[56:59]
    ds_write_b128 v253, v[24:27] offset:40960
    v_mfma_f32_16x16x32_bf16 v[60:63], v[156:159], v[136:139], v[60:63]
    ds_write_b128 v253, v[28:31] offset:49152
    v_mfma_f32_16x16x32_bf16 v[64:67], v[156:159], v[140:143], v[64:67]
    ds_write_b128 v253, v[32:35] offset:57344
    v_mfma_f32_16x16x32_bf16 v[68:71], v[160:163], v[128:131], v[68:71]
    ds_write_b128 v254, v[36:39] offset:0
    v_mfma_f32_16x16x32_bf16 v[72:75], v[160:163], v[132:135], v[72:75]
    ds_write_b128 v254, v[40:43] offset:8192
    v_mfma_f32_16x16x32_bf16 v[76:79], v[160:163], v[136:139], v[76:79]
    ds_write_b128 v254, v[44:47] offset:16384
    v_mfma_f32_16x16x32_bf16 v[80:83], v[160:163], v[140:143], v[80:83]
    ds_write_b128 v254, v[48:51] offset:24576
    s_nop 7
    ds_write_b128 v254, v[52:55] offset:32768
    ds_write_b128 v254, v[56:59] offset:40960
    ds_write_b128 v254, v[60:63] offset:49152
    ds_write_b128 v254, v[64:67] offset:57344
    ds_write_b128 v255, v[68:71] offset:0
    ds_write_b128 v255, v[72:75] offset:8192
    ds_write_b128 v255, v[76:79] offset:16384
    ds_write_b128 v255, v[80:83] offset:24576
    s_waitcnt lgkmcnt(0)
    s_barrier
    ds_read_b128 v[8:11], v104 offset:0
    ds_read_b128 v[12:15], v104 offset:1024
    ds_read_b128 v[16:19], v104 offset:2048
    ds_read_b128 v[20:23], v104 offset:3072
    ds_read_b128 v[24:27], v104 offset:4096
    ds_read_b128 v[28:31], v104 offset:5120
    ds_read_b128 v[32:35], v104 offset:6144
    ds_read_b128 v[36:39], v104 offset:7168
    ds_read_b128 v[40:43], v105 offset:0
    ds_read_b128 v[44:47], v105 offset:1024
    ds_read_b128 v[48:51], v105 offset:2048
    ds_read_b128 v[52:55], v105 offset:3072
    ds_read_b128 v[56:59], v105 offset:4096
    ds_read_b128 v[60:63], v105 offset:5120
    ds_read_b128 v[64:67], v105 offset:6144
    ds_read_b128 v[68:71], v105 offset:7168
    s_cmp_ge_u32 s3, 4
    s_cbranch_scc1 p3t_50_two
    s_waitcnt lgkmcnt(8)
    v_add_f32 v8, v8, v12
    v_add_f32 v16, v16, v20
    v_add_f32 v24, v24, v28
    v_add_f32 v32, v32, v36
    v_add_f32 v9, v9, v13
    v_add_f32 v17, v17, v21
    v_add_f32 v25, v25, v29
    v_add_f32 v33, v33, v37
    v_add_f32 v10, v10, v14
    v_add_f32 v18, v18, v22
    v_add_f32 v26, v26, v30
    v_add_f32 v34, v34, v38
    v_add_f32 v11, v11, v15
    v_add_f32 v19, v19, v23
    v_add_f32 v27, v27, v31
    v_add_f32 v35, v35, v39
    v_add_f32 v8, v8, v16
    v_add_f32 v24, v24, v32
    v_add_f32 v9, v9, v17
    v_add_f32 v25, v25, v33
    v_add_f32 v10, v10, v18
    v_add_f32 v26, v26, v34
    v_add_f32 v11, v11, v19
    v_add_f32 v27, v27, v35
    v_add_f32 v8, v8, v24
    v_add_f32 v9, v9, v25
    v_add_f32 v10, v10, v26
    v_add_f32 v11, v11, v27
    v_cvt_pk_bf16_f32 v12, v8, v9
    v_cvt_pk_bf16_f32 v13, v10, v11
    buffer_store_dwordx2 v[12:13], v107, s[28:31], 0 offen offset:0
    ds_read_b128 v[72:75], v106 offset:0
    ds_read_b128 v[76:79], v106 offset:1024
    ds_read_b128 v[80:83], v106 offset:2048
    ds_read_b128 v[84:87], v106 offset:3072
    ds_read_b128 v[88:91], v106 offset:4096
    ds_read_b128 v[92:95], v106 offset:5120
    ds_read_b128 v[96:99], v106 offset:6144
    ds_read_b128 v[100:103], v106 offset:7168
    s_waitcnt lgkmcnt(8)
    v_add_f32 v40, v40, v44
    v_add_f32 v48, v48, v52
    v_add_f32 v56, v56, v60
    v_add_f32 v64, v64, v68
    v_add_f32 v41, v41, v45
    v_add_f32 v49, v49, v53
    v_add_f32 v57, v57, v61
    v_add_f32 v65, v65, v69
    v_add_f32 v42, v42, v46
    v_add_f32 v50, v50, v54
    v_add_f32 v58, v58, v62
    v_add_f32 v66, v66, v70
    v_add_f32 v43, v43, v47
    v_add_f32 v51, v51, v55
    v_add_f32 v59, v59, v63
    v_add_f32 v67, v67, v71
    v_add_f32 v40, v40, v48
    v_add_f32 v56, v56, v64
    v_add_f32 v41, v41, v49
    v_add_f32 v57, v57, v65
    v_add_f32 v42, v42, v50
    v_add_f32 v58, v58, v66
    v_add_f32 v43, v43, v51
    v_add_f32 v59, v59, v67
    v_add_f32 v40, v40, v56
    v_add_f32 v41, v41, v57
    v_add_f32 v42, v42, v58
    v_add_f32 v43, v43, v59
    v_cvt_pk_bf16_f32 v44, v40, v41
    v_cvt_pk_bf16_f32 v45, v42, v43
    buffer_store_dwordx2 v[44:45], v107, s[28:31], 0 offen offset:64
    s_waitcnt lgkmcnt(0)
    v_add_f32 v72, v72, v76
    v_add_f32 v80, v80, v84
    v_add_f32 v88, v88, v92
    v_add_f32 v96, v96, v100
    v_add_f32 v73, v73, v77
    v_add_f32 v81, v81, v85
    v_add_f32 v89, v89, v93
    v_add_f32 v97, v97, v101
    v_add_f32 v74, v74, v78
    v_add_f32 v82, v82, v86
    v_add_f32 v90, v90, v94
    v_add_f32 v98, v98, v102
    v_add_f32 v75, v75, v79
    v_add_f32 v83, v83, v87
    v_add_f32 v91, v91, v95
    v_add_f32 v99, v99, v103
    v_add_f32 v72, v72, v80
    v_add_f32 v88, v88, v96
    v_add_f32 v73, v73, v81
    v_add_f32 v89, v89, v97
    v_add_f32 v74, v74, v82
    v_add_f32 v90, v90, v98
    v_add_f32 v75, v75, v83
    v_add_f32 v91, v91, v99
    v_add_f32 v72, v72, v88
    v_add_f32 v73, v73, v89
    v_add_f32 v74, v74, v90
    v_add_f32 v75, v75, v91
    v_cvt_pk_bf16_f32 v76, v72, v73
    v_cvt_pk_bf16_f32 v77, v74, v75
    buffer_store_dwordx2 v[76:77], v107, s[28:31], 0 offen offset:128
    s_branch after_p3
p3t_50_two:
    s_waitcnt lgkmcnt(8)
    v_add_f32 v8, v8, v12
    v_add_f32 v16, v16, v20
    v_add_f32 v24, v24, v28
    v_add_f32 v32, v32, v36
    v_add_f32 v9, v9, v13
    v_add_f32 v17, v17, v21
    v_add_f32 v25, v25, v29
    v_add_f32 v33, v33, v37
    v_add_f32 v10, v10, v14
    v_add_f32 v18, v18, v22
    v_add_f32 v26, v26, v30
    v_add_f32 v34, v34, v38
    v_add_f32 v11, v11, v15
    v_add_f32 v19, v19, v23
    v_add_f32 v27, v27, v31
    v_add_f32 v35, v35, v39
    v_add_f32 v8, v8, v16
    v_add_f32 v24, v24, v32
    v_add_f32 v9, v9, v17
    v_add_f32 v25, v25, v33
    v_add_f32 v10, v10, v18
    v_add_f32 v26, v26, v34
    v_add_f32 v11, v11, v19
    v_add_f32 v27, v27, v35
    v_add_f32 v8, v8, v24
    v_add_f32 v9, v9, v25
    v_add_f32 v10, v10, v26
    v_add_f32 v11, v11, v27
    v_cvt_pk_bf16_f32 v12, v8, v9
    v_cvt_pk_bf16_f32 v13, v10, v11
    buffer_store_dwordx2 v[12:13], v107, s[28:31], 0 offen offset:0
    s_waitcnt lgkmcnt(0)
    v_add_f32 v40, v40, v44
    v_add_f32 v48, v48, v52
    v_add_f32 v56, v56, v60
    v_add_f32 v64, v64, v68
    v_add_f32 v41, v41, v45
    v_add_f32 v49, v49, v53
    v_add_f32 v57, v57, v61
    v_add_f32 v65, v65, v69
    v_add_f32 v42, v42, v46
    v_add_f32 v50, v50, v54
    v_add_f32 v58, v58, v62
    v_add_f32 v66, v66, v70
    v_add_f32 v43, v43, v47
    v_add_f32 v51, v51, v55
    v_add_f32 v59, v59, v63
    v_add_f32 v67, v67, v71
    v_add_f32 v40, v40, v48
    v_add_f32 v56, v56, v64
    v_add_f32 v41, v41, v49
    v_add_f32 v57, v57, v65
    v_add_f32 v42, v42, v50
    v_add_f32 v58, v58, v66
    v_add_f32 v43, v43, v51
    v_add_f32 v59, v59, v67
    v_add_f32 v40, v40, v56
    v_add_f32 v41, v41, v57
    v_add_f32 v42, v42, v58
    v_add_f32 v43, v43, v59
    v_cvt_pk_bf16_f32 v44, v40, v41
    v_cvt_pk_bf16_f32 v45, v42, v43
    buffer_store_dwordx2 v[44:45], v107, s[28:31], 0 offen offset:64
    s_branch after_p3
after_p3:
gated_mix__mha_block__swiglu_ffn__prompt_kernel_end:
    s_endpgm
.section .rodata,"a"
.p2align 6
.amdhsa_kernel gated_mix__mha_block__swiglu_ffn__prompt_kernel
  .amdhsa_next_free_vgpr 256
  .amdhsa_next_free_sgpr 100
  .amdhsa_accum_offset 256
  .amdhsa_group_segment_fixed_size 0
  .amdhsa_kernarg_size 88
  .amdhsa_user_sgpr_count 2
  .amdhsa_user_sgpr_kernarg_segment_ptr 1
  .amdhsa_system_sgpr_workgroup_id_x 1
  .amdhsa_float_denorm_mode_32 3
  .amdhsa_float_denorm_mode_16_64 3
.end_amdhsa_kernel
```
